```python
import torch

def _softmax(x, axis=-1):
    return torch.softmax(x, dim=axis)
def _gelu(x):
    return torch.nn.functional.gelu(x, approximate="tanh")
def _silu(x):
    return torch.nn.functional.silu(x)
def _sigmoid(x):
    return torch.sigmoid(x)
def _layernorm(x, axis=-1, eps=1e-5):
    m = x.mean(dim=axis, keepdim=True)
    v = x.var(dim=axis, keepdim=True, unbiased=False)
    return (x - m) / torch.sqrt(v + eps)
def _scatter_add(tgt, idx, src, axis=0):
    return tgt.clone().index_add_(axis, idx, src)
def _segment_sum(src, seg, n):
    out = torch.zeros((n,) + src.shape[1:], dtype=src.dtype)
    return out.index_add_(0, seg, src)
def _pad(x, pw):
    flat = tuple(v for pair in reversed(pw) for v in pair)
    return torch.nn.functional.pad(x, flat)

kernel_name = 'sequential_preLN__spectral_gfnet__glu_gated_glu__prompt'

def setup_inputs():

    _w = (lambda a: (lambda t: t.to(torch.bfloat16) if t.is_floating_point() else t)(torch.as_tensor(a)))
    def _A_setup():
        B, S, D = 1, 2048, 576
        Df = D // 2 + 1
        return {
            "x": _w((lambda *s: torch.randn(*s, dtype=torch.bfloat16) * 0.05)(B, S, D)),
            "w_r": _w((lambda *s: torch.randn(*s, dtype=torch.bfloat16) * 0.4)(S, Df) * 0.02),
            "w_i": _w((lambda *s: torch.randn(*s, dtype=torch.bfloat16) * 0.4)(S, Df) * 0.02),
        }
    _A_in = _A_setup()

    def _B_setup():
        B, S, D, F = 1, 2048, 576, 4608
        return {
            "x": _w((lambda *s: torch.randn(*s, dtype=torch.bfloat16) * 0.05)(B, S, D)),
            "w_gate": _w((lambda *s: torch.randn(*s, dtype=torch.bfloat16) * 0.05)(D, F)),
            "w_up": _w((lambda *s: torch.randn(*s, dtype=torch.bfloat16) * 0.05)(D, F)),
            "w_down": _w((lambda *s: torch.randn(*s, dtype=torch.bfloat16) * 0.05)(F, D)),
        }
    _B_in = _B_setup()

    return {
        "A_x": _A_in["x"],
        "A_w_r": _A_in["w_r"],
        "A_w_i": _A_in["w_i"],
        "B_x": _B_in["x"],
        "B_w_gate": _B_in["w_gate"],
        "B_w_up": _B_in["w_up"],
        "B_w_down": _B_in["w_down"],
    }

def reference(A_x, A_w_r, A_w_i, B_x, B_w_gate, B_w_up, B_w_down):
    def _A_ref(x, w_r, w_i):
        B, S, D = x.shape
        X = (lambda x, axes=(-2,-1): torch.fft.rfft2(x.float(), dim=axes))(x, axes=(-2, -1))
        W = w_r + 1j * w_i
        X = X * W
        y = (lambda x, s, axes=(-2,-1): torch.fft.irfft2(x, s=s, dim=axes).to(torch.bfloat16))(X, (S, D), axes=(-2, -1))
        return y

    def _B_ref(x, w_gate, w_up, w_down):
        g = torch.einsum("bsd,df->bsf", x, w_gate)
        u = torch.einsum("bsd,df->bsf", x, w_up)
        h = _sigmoid(g) * u
        return torch.einsum("bsf,fd->bsd", h, w_down)

    x = A_x
    h = x + _A_ref(_layernorm(x, axis=-1), A_w_r, A_w_i)
    h2 = h + _B_ref(_layernorm(h, axis=-1), B_w_gate, B_w_up, B_w_down)
    return h2
```

```asm
; @launch kernel=kg_kernel grid=(256,1,1) block=(512,1,1) lds=147456
; @launch kernel=k4_kernel grid=(256,1,1) block=(256,1,1) lds=163840
.amdgcn_target "amdgcn-amd-amdhsa--gfx950"
.text
.globl kg_kernel
.p2align 8
.type kg_kernel,@function
kg_kernel:
    s_cmp_ge_u32 s2, 145
    s_cbranch_scc1 kg_kernel_pp
    s_load_dwordx4 s[32:35], s[0:1], 0
    s_load_dwordx2 s[36:37], s[0:1], 16
    s_load_dwordx4 s[40:43], s[0:1], 64
    v_lshrrev_b32 v1, 6, v0
    v_lshlrev_b32 v13, 4, v0
    v_readfirstlane_b32 s3, v1
    v_and_b32 v0, 63, v0
    s_getpc_b64 s[58:59]
    s_cmp_lg_u32 s3, 0
    s_cbranch_scc1 kg_kernel_np
    v_lshlrev_b32 v1, 7, v0
    v_min_u32 v1, kg_kernel_ms-kg_kernel-256, v1
    global_load_dword v255, v1, s[58:59]
kg_kernel_np:
    s_mov_b32 s24, 0xffff0000
    s_mov_b32 s26, 0x80008000
    s_mov_b32 s25, 0x3ae38e39
    v_and_b32 v14, 15, v0
    v_lshrrev_b32 v15, 4, v0
    s_and_b32 s4, s3, 3
    s_lshr_b32 s5, s3, 2
    s_cmp_ge_u32 s2, 128
    s_cbranch_scc1 kg_kernel_xa
    v_and_b32 v2, 31, v0
    v_lshrrev_b32 v3, 5, v0
    s_lshl_b32 s20, s3, 1
    v_add_u32 v3, s20, v3
    s_lshr_b32 s20, s2, 5
    s_lshl_b32 s20, s20, 9
    s_and_b32 s21, s2, 31
    s_add_u32 s20, s20, s21
    s_lshl_b32 s21, s3, 6
    s_add_u32 s20, s20, s21
    s_mul_i32 s20, s20, 1152
    s_mov_b32 s7, 1024
    v_lshlrev_b32 v52, 4, v0
    v_cmp_lt_u32 vcc, 7, v0
    v_mov_b32 v53, 35712
    v_mov_b32 v55, 2146435072
    v_cndmask_b32 v53, 0, v53, vcc
    v_add3_u32 v53, v53, v52, s7
    v_cmp_gt_u32 vcc, 16, v0
    v_add_u32 v54, 37760, v52
    s_mul_i32 s6, s3, 3072
    v_cndmask_b32 v54, v55, v54, vcc
    s_waitcnt lgkmcnt(0)
    s_mov_b32 s8, s32
    s_mov_b32 s9, s33
    s_mov_b32 s10, 2359296
    s_mov_b32 s11, 0x20000
    s_add_u32 m0, s6, 40960
    s_nop 0
    buffer_load_dwordx4 v52, s[8:11], s20 offen  lds
    s_add_u32 m0, s6, 41984
    s_nop 0
    buffer_load_dwordx4 v53, s[8:11], s20 offen  lds
    s_add_u32 m0, s6, 43008
    s_nop 0
    buffer_load_dwordx4 v54, s[8:11], s20 offen  lds
    s_lshl_b32 s21, s2, 2
    s_add_u32 s21, s21, s4
    s_mul_i32 s21, s21, 2312
    v_add_u32 v56, 0, v0
    v_mul_u32_u24 v57, 1821, v56
    v_lshrrev_b32 v57, 16, v57
    v_mul_u32_u24 v57, 2, v57
    v_lshl_add_u32 v58, v56, 4, v57
    v_add_u32 v56, 64, v0
    v_mul_u32_u24 v57, 1821, v56
    v_lshrrev_b32 v57, 16, v57
    v_mul_u32_u24 v57, 2, v57
    v_lshl_add_u32 v59, v56, 4, v57
    v_add_u32 v56, 128, v0
    v_mul_u32_u24 v57, 1821, v56
    v_lshrrev_b32 v57, 16, v57
    v_mul_u32_u24 v57, 2, v57
    v_lshl_add_u32 v60, v56, 4, v57
    v_cndmask_b32 v60, v55, v60, vcc
    v_and_b32 v61, 3, v0
    v_mul_u32_u24 v61, 578, v61
    v_add_u32 v61, 576, v61
    s_cmp_lg_u32 s5, 0
    s_cselect_b32 s16, s36, s34
    s_cselect_b32 s17, s37, s35
    s_mov_b32 s18, 1183744
    s_mov_b32 s19, 0x20000
    s_add_u32 m0, s6, 98304
    s_nop 0
    buffer_load_dwordx4 v58, s[16:19], s21 offen  lds
    s_add_u32 m0, s6, 99328
    s_nop 0
    buffer_load_dwordx4 v59, s[16:19], s21 offen  lds
    s_add_u32 m0, s6, 100352
    s_nop 0
    buffer_load_dwordx4 v60, s[16:19], s21 offen  lds
    buffer_load_ushort v112, v61, s[16:19], s21 offen
    s_mov_b32 s12, s42
    s_mov_b32 s13, s43
    s_mov_b32 s14, 268435456
    s_mov_b32 s15, 0x20000
    s_mov_b32 s44, s40
    s_mov_b32 s45, s41
    s_mov_b32 s46, 256
    s_mov_b32 s47, 0x20000
    v_lshlrev_b32 v54, 1, v2
    v_mul_u32_u24 v55, 57, v54
    v_lshrrev_b32 v55, 9, v55
    v_mul_u32_u24 v55, 9, v55
    v_sub_u32 v54, v55, v54
    v_lshlrev_b32 v54, 7, v54
    v_add_u32 v4, 0, v54
    v_add_u32 v55, 1152, v54
    v_min_u32 v4, v4, v55
    v_add_u32 v5, 128, v54
    v_add_u32 v55, 1280, v54
    v_min_u32 v5, v5, v55
    v_add_u32 v6, 256, v54
    v_add_u32 v55, 1408, v54
    v_min_u32 v6, v6, v55
    v_add_u32 v7, 384, v54
    v_add_u32 v55, 1536, v54
    v_min_u32 v7, v7, v55
    v_add_u32 v8, 512, v54
    v_add_u32 v55, 1664, v54
    v_min_u32 v8, v8, v55
    v_add_u32 v9, 640, v54
    v_add_u32 v55, 1792, v54
    v_min_u32 v9, v9, v55
    v_add_u32 v10, 768, v54
    v_add_u32 v55, 1920, v54
    v_min_u32 v10, v10, v55
    v_add_u32 v11, 896, v54
    v_add_u32 v55, 2048, v54
    v_min_u32 v11, v11, v55
    v_add_u32 v12, 1024, v54
    v_add_u32 v55, 2176, v54
    v_min_u32 v12, v12, v55
    v_lshrrev_b32 v54, 5, v0
    v_mul_u32_u24 v54, 1152, v54
    v_lshl_add_u32 v54, v2, 2, v54
    s_add_u32 s20, s6, 40960
    v_add_u32 v54, s20, v54
    v_add_u32 v16, v54, v4
    v_add_u32 v17, v54, v5
    v_add_u32 v18, v54, v6
    v_add_u32 v19, v54, v7
    v_add_u32 v20, v54, v8
    v_add_u32 v21, v54, v9
    v_add_u32 v22, v54, v10
    v_add_u32 v23, v54, v11
    v_add_u32 v24, v54, v12
    v_and_b32 v64, 15, v0
    s_lshl_b32 s31, s4, 4
    v_add_u32 v64, s31, v64
    v_and_b32 v67, 1, v64
    v_mul_lo_u32 v67, v67, s26
    v_cvt_f32_u32 v64, v64
    v_mul_f32 v64, 0x3c800000, v64
    v_lshrrev_b32 v65, 4, v0
    v_lshlrev_b32 v65, 3, v65
    v_cvt_f32_u32 v65, v65
    v_mul_f32 v65, v65, v64
    v_fmamk_f32 v68, v64, 0x00000000, v65
    v_fmamk_f32 v69, v64, 0x3f800000, v65
    v_fmamk_f32 v70, v64, 0x40000000, v65
    v_fmamk_f32 v71, v64, 0x40400000, v65
    v_fmamk_f32 v72, v64, 0x40800000, v65
    v_fmamk_f32 v73, v64, 0x40a00000, v65
    v_fmamk_f32 v74, v64, 0x40c00000, v65
    v_fmamk_f32 v75, v64, 0x40e00000, v65
    v_fract_f32 v68, v68
    v_fract_f32 v69, v69
    v_fract_f32 v70, v70
    v_fract_f32 v71, v71
    v_fract_f32 v72, v72
    v_fract_f32 v73, v73
    v_fract_f32 v74, v74
    v_fract_f32 v75, v75
    v_cos_f32 v76, v68
    v_cos_f32 v77, v69
    v_cos_f32 v78, v70
    v_cos_f32 v79, v71
    v_cos_f32 v80, v72
    v_cos_f32 v81, v73
    v_cos_f32 v82, v74
    v_cos_f32 v83, v75
    v_sin_f32 v68, v68
    v_sin_f32 v69, v69
    v_sin_f32 v70, v70
    v_sin_f32 v71, v71
    v_sin_f32 v72, v72
    v_sin_f32 v73, v73
    v_sin_f32 v74, v74
    v_sin_f32 v75, v75
    v_cvt_pk_bf16_f32 v28, v76, v77
    v_cvt_pk_bf16_f32 v29, v78, v79
    v_cvt_pk_bf16_f32 v30, v80, v81
    v_cvt_pk_bf16_f32 v31, v82, v83
    v_cvt_pk_bf16_f32 v36, v68, v69
    v_cvt_pk_bf16_f32 v37, v70, v71
    v_cvt_pk_bf16_f32 v38, v72, v73
    v_cvt_pk_bf16_f32 v39, v74, v75
    v_xor_b32 v32, v67, v28
    v_xor_b32 v40, v67, v36
    v_xor_b32 v33, v67, v29
    v_xor_b32 v41, v67, v37
    v_xor_b32 v34, v67, v30
    v_xor_b32 v42, v67, v38
    v_xor_b32 v35, v67, v31
    v_xor_b32 v43, v67, v39
    v_xor_b32 v44, s26, v36
    v_xor_b32 v45, s26, v37
    v_xor_b32 v46, s26, v38
    v_xor_b32 v47, s26, v39
    v_xor_b32 v48, s26, v40
    v_xor_b32 v49, s26, v41
    v_xor_b32 v50, s26, v42
    v_xor_b32 v51, s26, v43
    s_mov_b32 s48, 0x3f441b7d
    s_mov_b32 s49, 0x3e31d0d4
    s_mov_b32 s50, 0xbf708fb2
    s_mov_b32 s51, 0x3f248dbb
    s_mov_b32 s52, 0x3f7c1c5c
    s_mov_b32 s53, 0x3eaf1d44
    s_mov_b32 s54, 0x3f5db3d7
    s_mov_b32 s55, 0xbf000000
    v_mul_u32_u24 v54, 1312, v3
    v_lshl_add_u32 v54, v2, 2, v54
    v_mul_u32_u24 v55, 1312, v14
    v_lshl_add_u32 v55, v15, 4, v55
    s_lshl_b32 s20, s5, 9
    v_add_u32 v56, s20, v55
    v_and_b32 v64, 3, v0
    s_lshl_b32 s20, s3, 2
    v_add_u32 v64, s20, v64
    v_lshlrev_b32 v113, 5, v64
    v_add_u32 v113, 122880, v113
    s_waitcnt vmcnt(4)
    ds_read_b32 v16, v16
    ds_read_b32 v17, v17
    ds_read_b32 v18, v18
    ds_read_b32 v19, v19
    ds_read_b32 v20, v20
    ds_read_b32 v21, v21
    ds_read_b32 v22, v22
    ds_read_b32 v23, v23
    ds_read_b32 v24, v24
    s_waitcnt lgkmcnt(0)
    v_lshlrev_b32 v64, 16, v16
    v_and_b32 v67, s24, v16
    v_lshlrev_b32 v66, 16, v17
    v_and_b32 v69, s24, v17
    v_lshlrev_b32 v68, 16, v18
    v_and_b32 v71, s24, v18
    v_lshlrev_b32 v70, 16, v19
    v_and_b32 v73, s24, v19
    v_lshlrev_b32 v72, 16, v20
    v_and_b32 v75, s24, v20
    v_lshlrev_b32 v74, 16, v21
    v_and_b32 v77, s24, v21
    v_lshlrev_b32 v76, 16, v22
    v_and_b32 v79, s24, v22
    v_lshlrev_b32 v78, 16, v23
    v_and_b32 v81, s24, v23
    v_lshlrev_b32 v80, 16, v24
    v_and_b32 v65, s24, v24
    v_pk_add_f32 v[100:101], v[64:65], v[66:67] neg_lo:[0,0] neg_hi:[0,0]
    v_pk_add_f32 v[102:103], v[68:69], v[70:71] neg_lo:[0,0] neg_hi:[0,0]
    v_pk_add_f32 v[104:105], v[72:73], v[74:75] neg_lo:[0,0] neg_hi:[0,0]
    v_pk_add_f32 v[100:101], v[100:101], v[76:77] neg_lo:[0,0] neg_hi:[0,0]
    v_pk_add_f32 v[102:103], v[102:103], v[78:79] neg_lo:[0,0] neg_hi:[0,0]
    v_pk_add_f32 v[104:105], v[104:105], v[80:81] neg_lo:[0,0] neg_hi:[0,0]
    v_pk_add_f32 v[100:101], v[100:101], v[102:103] neg_lo:[0,0] neg_hi:[0,0]
    v_pk_add_f32 v[100:101], v[100:101], v[104:105] neg_lo:[0,0] neg_hi:[0,0]
    v_add_f32 v100, v100, v101
    s_nop 1
    v_add_f32_dpp v100, v100, v100 quad_perm:[1,0,3,2] row_mask:0xf bank_mask:0xf
    s_nop 1
    v_add_f32_dpp v100, v100, v100 quad_perm:[2,3,0,1] row_mask:0xf bank_mask:0xf
    s_nop 1
    v_add_f32_dpp v100, v100, v100 row_half_mirror row_mask:0xf bank_mask:0xf
    s_nop 1
    v_add_f32_dpp v100, v100, v100 row_mirror row_mask:0xf bank_mask:0xf
    v_mov_b32 v101, v100
    s_nop 1
    v_permlane16_swap_b32 v101, v100
    s_nop 0
    v_add_f32 v100, v100, v101
    v_mul_f32 v100, s25, v100
    v_pk_add_f32 v[64:65], v[64:65], v[100:101] op_sel_hi:[1,0] neg_lo:[0,1] neg_hi:[0,1]
    v_pk_add_f32 v[66:67], v[66:67], v[100:101] op_sel_hi:[1,0] neg_lo:[0,1] neg_hi:[0,1]
    v_pk_add_f32 v[68:69], v[68:69], v[100:101] op_sel_hi:[1,0] neg_lo:[0,1] neg_hi:[0,1]
    v_pk_add_f32 v[70:71], v[70:71], v[100:101] op_sel_hi:[1,0] neg_lo:[0,1] neg_hi:[0,1]
    v_pk_add_f32 v[72:73], v[72:73], v[100:101] op_sel_hi:[1,0] neg_lo:[0,1] neg_hi:[0,1]
    v_pk_add_f32 v[74:75], v[74:75], v[100:101] op_sel_hi:[1,0] neg_lo:[0,1] neg_hi:[0,1]
    v_pk_add_f32 v[76:77], v[76:77], v[100:101] op_sel_hi:[1,0] neg_lo:[0,1] neg_hi:[0,1]
    v_pk_add_f32 v[78:79], v[78:79], v[100:101] op_sel_hi:[1,0] neg_lo:[0,1] neg_hi:[0,1]
    v_pk_add_f32 v[80:81], v[80:81], v[100:101] op_sel_hi:[1,0] neg_lo:[0,1] neg_hi:[0,1]
    v_pk_mul_f32 v[102:103], v[64:65], v[64:65]
    v_pk_mul_f32 v[104:105], v[66:67], v[66:67]
    v_pk_fma_f32 v[102:103], v[68:69], v[68:69], v[102:103]
    v_pk_fma_f32 v[104:105], v[70:71], v[70:71], v[104:105]
    v_pk_fma_f32 v[102:103], v[72:73], v[72:73], v[102:103]
    v_pk_fma_f32 v[104:105], v[74:75], v[74:75], v[104:105]
    v_pk_fma_f32 v[102:103], v[76:77], v[76:77], v[102:103]
    v_pk_fma_f32 v[104:105], v[78:79], v[78:79], v[104:105]
    v_pk_fma_f32 v[102:103], v[80:81], v[80:81], v[102:103]
    v_pk_add_f32 v[102:103], v[102:103], v[104:105] neg_lo:[0,0] neg_hi:[0,0]
    v_add_f32 v102, v102, v103
    v_cvt_pk_bf16_f32 v101, v100, v100
    v_and_b32 v101, s24, v101
    v_sub_f32 v100, v100, v101
    s_nop 1
    v_add_f32_dpp v102, v102, v102 quad_perm:[1,0,3,2] row_mask:0xf bank_mask:0xf
    s_nop 1
    v_add_f32_dpp v102, v102, v102 quad_perm:[2,3,0,1] row_mask:0xf bank_mask:0xf
    s_nop 1
    v_add_f32_dpp v102, v102, v102 row_half_mirror row_mask:0xf bank_mask:0xf
    s_nop 1
    v_add_f32_dpp v102, v102, v102 row_mirror row_mask:0xf bank_mask:0xf
    v_mov_b32 v103, v102
    s_nop 1
    v_permlane16_swap_b32 v103, v102
    s_nop 0
    v_add_f32 v102, v102, v103
    v_mul_f32 v102, s25, v102
    v_cvt_pk_bf16_f32 v102, v102, v102
    v_and_b32 v102, s24, v102
    v_add_f32 v102, 0x3727c5ac, v102
    v_cvt_pk_bf16_f32 v102, v102, v102
    v_and_b32 v102, s24, v102
    v_sqrt_f32 v102, v102
    s_nop 0
    v_cvt_pk_bf16_f32 v102, v102, v102
    v_and_b32 v102, s24, v102
    v_rcp_f32 v102, v102
    s_nop 0
    v_mul_f32 v100, v100, v102
    v_pk_fma_f32 v[64:65], v[64:65], v[102:103], v[100:101] op_sel_hi:[1,0,0]
    v_pk_fma_f32 v[66:67], v[66:67], v[102:103], v[100:101] op_sel_hi:[1,0,0]
    v_pk_fma_f32 v[68:69], v[68:69], v[102:103], v[100:101] op_sel_hi:[1,0,0]
    v_pk_fma_f32 v[70:71], v[70:71], v[102:103], v[100:101] op_sel_hi:[1,0,0]
    v_pk_fma_f32 v[72:73], v[72:73], v[102:103], v[100:101] op_sel_hi:[1,0,0]
    v_pk_fma_f32 v[74:75], v[74:75], v[102:103], v[100:101] op_sel_hi:[1,0,0]
    v_pk_fma_f32 v[76:77], v[76:77], v[102:103], v[100:101] op_sel_hi:[1,0,0]
    v_pk_fma_f32 v[78:79], v[78:79], v[102:103], v[100:101] op_sel_hi:[1,0,0]
    v_pk_fma_f32 v[80:81], v[80:81], v[102:103], v[100:101] op_sel_hi:[1,0,0]
    v_pk_add_f32 v[82:83], v[66:67], v[80:81] neg_lo:[0,0] neg_hi:[0,0]
    v_pk_add_f32 v[90:91], v[66:67], v[80:81] neg_lo:[0,1] neg_hi:[0,1]
    v_pk_add_f32 v[84:85], v[68:69], v[78:79] neg_lo:[0,0] neg_hi:[0,0]
    v_pk_add_f32 v[92:93], v[68:69], v[78:79] neg_lo:[0,1] neg_hi:[0,1]
    v_pk_add_f32 v[86:87], v[70:71], v[76:77] neg_lo:[0,0] neg_hi:[0,0]
    v_pk_add_f32 v[94:95], v[70:71], v[76:77] neg_lo:[0,1] neg_hi:[0,1]
    v_pk_add_f32 v[88:89], v[72:73], v[74:75] neg_lo:[0,0] neg_hi:[0,0]
    v_pk_add_f32 v[96:97], v[72:73], v[74:75] neg_lo:[0,1] neg_hi:[0,1]
    v_pk_fma_f32 v[100:101], v[86:87], s[54:55], v[64:65] op_sel:[0,1,0] op_sel_hi:[1,1,1] neg_lo:[0,0,0] neg_hi:[0,0,0]
    v_pk_mul_f32 v[102:103], v[94:95], s[54:55] op_sel:[0,0] op_sel_hi:[1,0] neg_lo:[1,0] neg_hi:[1,0]
    v_pk_add_f32 v[104:105], v[82:83], v[84:85] neg_lo:[0,0] neg_hi:[0,0]
    v_pk_fma_f32 v[68:69], v[82:83], s[48:49], v[100:101] op_sel:[0,0,0] op_sel_hi:[1,0,1] neg_lo:[0,0,0] neg_hi:[0,0,0]
    v_pk_fma_f32 v[70:71], v[82:83], s[48:49], v[100:101] op_sel:[0,1,0] op_sel_hi:[1,1,1] neg_lo:[0,0,0] neg_hi:[0,0,0]
    v_pk_fma_f32 v[98:99], v[82:83], s[50:51], v[100:101] op_sel:[0,0,0] op_sel_hi:[1,0,1] neg_lo:[0,0,0] neg_hi:[0,0,0]
    v_pk_add_f32 v[104:105], v[104:105], v[88:89] neg_lo:[0,0] neg_hi:[0,0]
    v_pk_fma_f32 v[74:75], v[90:91], s[50:51], v[102:103] op_sel:[0,1,0] op_sel_hi:[1,1,1] neg_lo:[1,0,0] neg_hi:[1,0,0]
    v_pk_fma_f32 v[76:77], v[90:91], s[52:53], v[102:103] op_sel:[0,0,0] op_sel_hi:[1,0,1] neg_lo:[1,0,1] neg_hi:[1,0,1]
    v_pk_fma_f32 v[80:81], v[90:91], s[52:53], v[102:103] op_sel:[0,1,0] op_sel_hi:[1,1,1] neg_lo:[1,0,0] neg_hi:[1,0,0]
    v_pk_add_f32 v[100:101], v[64:65], v[86:87] neg_lo:[0,0] neg_hi:[0,0]
    v_pk_add_f32 v[102:103], v[90:91], v[92:93] neg_lo:[0,1] neg_hi:[0,1]
    v_pk_fma_f32 v[68:69], v[84:85], s[48:49], v[68:69] op_sel:[0,1,0] op_sel_hi:[1,1,1] neg_lo:[0,0,0] neg_hi:[0,0,0]
    v_pk_fma_f32 v[70:71], v[84:85], s[50:51], v[70:71] op_sel:[0,0,0] op_sel_hi:[1,0,1] neg_lo:[0,0,0] neg_hi:[0,0,0]
    v_pk_fma_f32 v[98:99], v[84:85], s[48:49], v[98:99] op_sel:[0,0,0] op_sel_hi:[1,0,1] neg_lo:[0,0,0] neg_hi:[0,0,0]
    v_pk_fma_f32 v[74:75], v[92:93], s[52:53], v[74:75] op_sel:[0,0,0] op_sel_hi:[1,0,1] neg_lo:[1,0,0] neg_hi:[1,0,0]
    v_pk_fma_f32 v[76:77], v[92:93], s[52:53], v[76:77] op_sel:[0,1,0] op_sel_hi:[1,1,1] neg_lo:[1,0,0] neg_hi:[1,0,0]
    v_pk_fma_f32 v[80:81], v[92:93], s[50:51], v[80:81] op_sel:[0,1,0] op_sel_hi:[1,1,1] neg_lo:[0,0,0] neg_hi:[0,0,0]
    v_pk_fma_f32 v[68:69], v[88:89], s[50:51], v[68:69] op_sel:[0,0,0] op_sel_hi:[1,0,1] neg_lo:[0,0,0] neg_hi:[0,0,0]
    v_pk_fma_f32 v[70:71], v[88:89], s[48:49], v[70:71] op_sel:[0,0,0] op_sel_hi:[1,0,1] neg_lo:[0,0,0] neg_hi:[0,0,0]
    v_pk_fma_f32 v[98:99], v[88:89], s[48:49], v[98:99] op_sel:[0,1,0] op_sel_hi:[1,1,1] neg_lo:[0,0,0] neg_hi:[0,0,0]
    v_pk_fma_f32 v[74:75], v[96:97], s[52:53], v[74:75] op_sel:[0,1,0] op_sel_hi:[1,1,1] neg_lo:[1,0,0] neg_hi:[1,0,0]
    v_pk_fma_f32 v[76:77], v[96:97], s[50:51], v[76:77] op_sel:[0,1,0] op_sel_hi:[1,1,1] neg_lo:[0,0,0] neg_hi:[0,0,0]
    v_pk_fma_f32 v[80:81], v[96:97], s[52:53], v[80:81] op_sel:[0,0,0] op_sel_hi:[1,0,1] neg_lo:[0,0,0] neg_hi:[0,0,0]
    v_pk_add_f32 v[102:103], v[102:103], v[96:97] neg_lo:[0,0] neg_hi:[0,0]
    v_pk_fma_f32 v[72:73], v[104:105], s[54:55], v[100:101] op_sel:[0,1,0] op_sel_hi:[1,1,1] neg_lo:[0,0,0] neg_hi:[0,0,0]
    v_pk_add_f32 v[66:67], v[100:101], v[104:105] neg_lo:[0,0] neg_hi:[0,0]
    v_pk_mul_f32 v[78:79], v[102:103], s[54:55] op_sel:[0,0] op_sel_hi:[1,0] neg_lo:[1,0] neg_hi:[1,0]
    v_cvt_pk_bf16_f32 v66, v66, v67
    v_cvt_pk_bf16_f32 v68, v68, v69
    v_cvt_pk_bf16_f32 v74, v74, v75
    v_cvt_pk_bf16_f32 v70, v70, v71
    v_cvt_pk_bf16_f32 v76, v76, v77
    v_cvt_pk_bf16_f32 v72, v72, v73
    v_cvt_pk_bf16_f32 v78, v78, v79
    v_cvt_pk_bf16_f32 v98, v98, v99
    v_cvt_pk_bf16_f32 v80, v80, v81
    ds_write_b32 v54, v66 offset:0
    ds_write_b32 v54, v68 offset:128
    ds_write_b32 v54, v74 offset:256
    ds_write_b32 v54, v70 offset:384
    ds_write_b32 v54, v76 offset:512
    ds_write_b32 v54, v72 offset:640
    ds_write_b32 v54, v78 offset:768
    ds_write_b32 v54, v98 offset:896
    ds_write_b32 v54, v80 offset:1024
    buffer_load_dwordx2 v[110:111], off, s[44:47], 0 sc1
    s_waitcnt vmcnt(1)
    ds_write_b16 v113, v112
    s_waitcnt lgkmcnt(0)
    s_barrier
    ds_read_b128 v[64:67], v56 offset:128
    ds_read_b128 v[68:71], v56 offset:192
    ds_read_b128 v[72:75], v56 offset:256
    ds_read_b128 v[76:79], v56 offset:320
    ds_read_b128 v[80:83], v56 offset:384
    ds_read_b128 v[84:87], v56 offset:448
    ds_read_b128 v[88:91], v56 offset:512
    ds_read_b128 v[92:95], v56 offset:576
    ds_read_b128 v[96:99], v55 offset:0
    ds_read_b128 v[100:103], v55 offset:64
    s_mul_i32 s23, s2, 18560
    s_lshl_b32 s22, s3, 10
    s_add_u32 s23, s23, s22
    s_add_u32 s23, s23, 4194432
    s_add_u32 s22, s23, 8192
    s_add_u32 s21, s23, 16384
    s_lshl_b32 s30, s4, 4
    v_add_u32 v146, s30, v14
    v_mul_u32_u24 v147, 9, v146
    s_lshl_b32 s30, s5, 7
    v_add_u32 v148, s30, v147
    v_lshlrev_b32 v1, 3, v15
    v_add_u32 v1, 20992, v1
    v_add_u32 v144, 64, v148
    v_subrev_u32 v145, 576, v144
    v_min_u32 v144, v144, v145
    v_sub_u32 v145, 576, v144
    v_cmp_lt_u32 vcc, v145, v144
    v_min_u32 v144, v144, v145
    v_mov_b32 v145, s26
    s_waitcnt lgkmcnt(6)
    v_mfma_f32_16x16x32_bf16 v[120:123], v[64:67], v[28:31], 0
    v_cndmask_b32 v60, 0, v145, vcc
    v_lshl_add_u32 v57, v144, 6, v1
    v_add_u32 v144, 128, v148
    v_mfma_f32_16x16x32_bf16 v[124:127], v[72:75], v[28:31], 0
    v_subrev_u32 v145, 576, v144
    v_min_u32 v144, v144, v145
    v_sub_u32 v145, 576, v144
    v_mfma_f32_16x16x32_bf16 v[120:123], v[68:71], v[32:35], v[120:123]
    v_cmp_lt_u32 vcc, v145, v144
    v_min_u32 v144, v144, v145
    v_mov_b32 v145, s26
    v_mfma_f32_16x16x32_bf16 v[124:127], v[76:79], v[32:35], v[124:127]
    v_cndmask_b32 v61, 0, v145, vcc
    v_lshl_add_u32 v58, v144, 6, v1
    s_lshl_b32 s30, s5, 5
    v_mfma_f32_16x16x32_bf16 v[120:123], v[72:75], v[36:39], v[120:123]
    v_lshl_add_u32 v59, v147, 6, v1
    v_add_u32 v59, s30, v59
    v_lshlrev_b32 v145, 3, v0
    v_mfma_f32_16x16x32_bf16 v[124:127], v[64:67], v[44:47], v[124:127]
    v_add_u32 v145, 39424, v145
    v_cmp_lt_u32 vcc, 31, v146
    s_lshl_b32 s30, s5, 6
    v_mfma_f32_16x16x32_bf16 v[120:123], v[76:79], v[40:43], v[120:123]
    v_add_u32 v144, s30, v146
    v_cndmask_b32 v59, v59, v145, vcc
    v_cmp_eq_u32 vcc, 64, v144
    v_mfma_f32_16x16x32_bf16 v[124:127], v[68:71], v[48:51], v[124:127]
    s_nop 1
    v_cndmask_b32 v59, v59, v145, vcc
    v_cmp_eq_u32 vcc, 32, v144
    s_waitcnt lgkmcnt(2)
    v_mfma_f32_16x16x32_bf16 v[128:131], v[80:83], v[28:31], 0
    v_add_u32 v145, 32, v1
    s_nop 0
    v_cndmask_b32 v59, v59, v145, vcc
    v_mfma_f32_16x16x32_bf16 v[132:135], v[88:91], v[28:31], 0
    v_bfe_u32 v144, v0, 2, 2
    v_and_b32 v145, 3, v0
    v_lshlrev_b32 v145, 3, v145
    v_mfma_f32_16x16x32_bf16 v[128:131], v[84:87], v[32:35], v[128:131]
    v_mul_u32_u24 v62, 576, v144
    v_mul_u32_u24 v146, 6144, v15
    v_add3_u32 v62, v62, v146, v145
    v_mfma_f32_16x16x32_bf16 v[132:135], v[92:95], v[32:35], v[132:135]
    s_lshl_b32 s30, s3, 5
    s_add_u32 s30, s30, 98304
    v_add_u32 v62, s30, v62
    v_mfma_f32_16x16x32_bf16 v[128:131], v[88:91], v[36:39], v[128:131]
    v_lshl_add_u32 v144, v15, 3, v144
    v_lshl_add_u32 v63, v144, 5, v145
    v_add_u32 v63, 122880, v63
    v_mfma_f32_16x16x32_bf16 v[132:135], v[80:83], v[44:47], v[132:135]
    v_lshlrev_b32 v52, 6, v14
    v_lshl_add_u32 v52, v15, 4, v52
    v_cmp_gt_u32 vcc, 2, v14
    v_mfma_f32_16x16x32_bf16 v[128:131], v[92:95], v[40:43], v[128:131]
    v_mov_b32 v144, 2146435072
    s_cmp_eq_u32 s3, 2
    s_cselect_b64 s[6:7], 0, -1
    v_mfma_f32_16x16x32_bf16 v[132:135], v[84:87], v[48:51], v[132:135]
    s_or_b64 vcc, vcc, s[6:7]
    v_cndmask_b32 v53, v144, v52, vcc
    s_waitcnt lgkmcnt(0)
    ds_read_b64_tr_b16 v[144:145], v62 offset:0
    ds_read_b64_tr_b16 v[146:147], v62 offset:3072
    ds_read_b64_tr_b16 v[148:149], v62 offset:256
    ds_read_b64_tr_b16 v[150:151], v62 offset:3328
    s_cmp_lg_u32 s5, 0
    s_cbranch_scc1 kg_kernel_a5
    v_mfma_f32_16x16x32_bf16 v[136:139], v[96:99], v[28:31], 0
    v_mfma_f32_16x16x32_bf16 v[136:139], v[100:103], v[32:35], v[136:139]
    s_branch kg_kernel_a6
kg_kernel_a5:
    v_mfma_f32_16x16x32_bf16 v[136:139], v[96:99], v[44:47], 0
    v_mfma_f32_16x16x32_bf16 v[136:139], v[100:103], v[48:51], v[136:139]
kg_kernel_a6:
    s_cmp_ge_u32 s3, 3
    s_cbranch_scc1 kg_kernel_a9
    s_cmp_eq_u32 s3, 2
    s_cbranch_scc1 kg_kernel_a8
    ds_read_b64_tr_b16 v[152:153], v62 offset:512
    ds_read_b64_tr_b16 v[154:155], v62 offset:3584
    s_branch kg_kernel_aa
kg_kernel_a8:
    ds_read_b64_tr_b16 v[152:153], v63 offset:0
    ds_read_b64_tr_b16 v[154:155], v63 offset:128
kg_kernel_aa:
    s_waitcnt lgkmcnt(0)
    buffer_store_dwordx4 v[152:155], v53, s[12:15], s21 offen sc1
kg_kernel_a9:
    s_waitcnt lgkmcnt(0)
    buffer_store_dwordx4 v[144:147], v52, s[12:15], s23 offen sc1
    buffer_store_dwordx4 v[148:151], v52, s[12:15], s22 offen sc1
    v_cvt_pk_bf16_f32 v64, v120, v121
    v_cvt_pk_bf16_f32 v65, v122, v123
    v_cvt_pk_bf16_f32 v66, v124, v125
    v_cvt_pk_bf16_f32 v67, v126, v127
    v_xor_b32 v66, v60, v66
    v_xor_b32 v67, v60, v67
    ds_write_b64 v57, v[64:65]
    ds_write_b64 v57, v[66:67] offset:32
    v_cvt_pk_bf16_f32 v68, v128, v129
    v_cvt_pk_bf16_f32 v69, v130, v131
    v_cvt_pk_bf16_f32 v70, v132, v133
    v_cvt_pk_bf16_f32 v71, v134, v135
    v_xor_b32 v70, v61, v70
    v_xor_b32 v71, v61, v71
    ds_write_b64 v58, v[68:69]
    ds_write_b64 v58, v[70:71] offset:32
    v_cvt_pk_bf16_f32 v72, v136, v137
    v_cvt_pk_bf16_f32 v73, v138, v139
    ds_write_b64 v59, v[72:73]
    s_mul_i32 s20, s2, 18432
    s_add_u32 s20, s20, 128
    s_add_u32 s21, s20, 8192
    s_add_u32 s22, s20, 16384
    s_waitcnt lgkmcnt(0)
    s_barrier
    ds_read_b128 v[64:67], v13 offset:20992
    ds_read_b128 v[68:71], v13 offset:29184
    s_cmp_ge_u32 s3, 2
    s_cbranch_scc1 kg_kernel_a7
    ds_read_b128 v[72:75], v13 offset:37376
    s_waitcnt lgkmcnt(0)
    buffer_store_dwordx4 v[72:75], v13, s[12:15], s22 offen sc1
kg_kernel_a7:
    s_waitcnt lgkmcnt(1)
    buffer_store_dwordx4 v[64:67], v13, s[12:15], s20 offen sc1
    s_waitcnt lgkmcnt(0)
    buffer_store_dwordx4 v[68:71], v13, s[12:15], s21 offen sc1
    s_branch kg_kernel_b0
kg_kernel_xa:
    s_waitcnt lgkmcnt(0)
    s_mov_b32 s12, s42
    s_mov_b32 s13, s43
    s_mov_b32 s14, 268435456
    s_mov_b32 s15, 0x20000
    s_mov_b32 s44, s40
    s_mov_b32 s45, s41
    s_mov_b32 s46, 256
    s_mov_b32 s47, 0x20000
    v_lshlrev_b32 v64, 3, v13
    v_min_u32 v64, k4_kernel_end-k4_kernel, v64
    v_add_u32 v64, k4_kernel-kg_kernel_np, v64
    global_load_dword v252, v64, s[58:59]
    v_and_b32 v64, 15, v0
    s_lshl_b32 s31, s4, 4
    v_add_u32 v64, s31, v64
    v_and_b32 v67, 1, v64
    v_mul_lo_u32 v67, v67, s26
    v_cvt_f32_u32 v64, v64
    v_mul_f32 v64, 0x3c800000, v64
    v_lshrrev_b32 v65, 4, v0
    v_lshlrev_b32 v65, 3, v65
    v_cvt_f32_u32 v65, v65
    v_mul_f32 v65, v65, v64
    v_fmamk_f32 v68, v64, 0x00000000, v65
    v_fmamk_f32 v69, v64, 0x3f800000, v65
    v_fmamk_f32 v70, v64, 0x40000000, v65
    v_fmamk_f32 v71, v64, 0x40400000, v65
    v_fmamk_f32 v72, v64, 0x40800000, v65
    v_fmamk_f32 v73, v64, 0x40a00000, v65
    v_fmamk_f32 v74, v64, 0x40c00000, v65
    v_fmamk_f32 v75, v64, 0x40e00000, v65
    v_fract_f32 v68, v68
    v_fract_f32 v69, v69
    v_fract_f32 v70, v70
    v_fract_f32 v71, v71
    v_fract_f32 v72, v72
    v_fract_f32 v73, v73
    v_fract_f32 v74, v74
    v_fract_f32 v75, v75
    v_cos_f32 v76, v68
    v_cos_f32 v77, v69
    v_cos_f32 v78, v70
    v_cos_f32 v79, v71
    v_cos_f32 v80, v72
    v_cos_f32 v81, v73
    v_cos_f32 v82, v74
    v_cos_f32 v83, v75
    v_sin_f32 v68, v68
    v_sin_f32 v69, v69
    v_sin_f32 v70, v70
    v_sin_f32 v71, v71
    v_sin_f32 v72, v72
    v_sin_f32 v73, v73
    v_sin_f32 v74, v74
    v_sin_f32 v75, v75
    v_cvt_pk_bf16_f32 v28, v76, v77
    v_cvt_pk_bf16_f32 v29, v78, v79
    v_cvt_pk_bf16_f32 v30, v80, v81
    v_cvt_pk_bf16_f32 v31, v82, v83
    v_cvt_pk_bf16_f32 v36, v68, v69
    v_cvt_pk_bf16_f32 v37, v70, v71
    v_cvt_pk_bf16_f32 v38, v72, v73
    v_cvt_pk_bf16_f32 v39, v74, v75
    v_xor_b32 v32, v67, v28
    v_xor_b32 v40, v67, v36
    v_xor_b32 v33, v67, v29
    v_xor_b32 v41, v67, v37
    v_xor_b32 v34, v67, v30
    v_xor_b32 v42, v67, v38
    v_xor_b32 v35, v67, v31
    v_xor_b32 v43, v67, v39
    v_xor_b32 v44, s26, v36
    v_xor_b32 v45, s26, v37
    v_xor_b32 v46, s26, v38
    v_xor_b32 v47, s26, v39
    v_xor_b32 v48, s26, v40
    v_xor_b32 v49, s26, v41
    v_xor_b32 v50, s26, v42
    v_xor_b32 v51, s26, v43
    buffer_load_dwordx2 v[110:111], off, s[44:47], 0 sc1
kg_kernel_b0:
    s_lshl_b32 s6, s2, 1
    s_add_u32 s6, s6, s5
    s_lshl_b32 s29, s2, 7
    s_cmp_eq_u32 s2, 144
    s_cselect_b32 s29, 0, s29
    s_cselect_b32 s30, 1, 0
    s_cmp_eq_u32 s6, 0
    s_cselect_b32 s7, 1, s30
    s_mul_i32 s20, s6, 7282
    s_lshr_b32 s20, s20, 16
    s_mul_i32 s20, s20, 9
    s_sub_u32 s20, s6, s20
    s_cmp_ge_u32 s20, 5
    s_cselect_b32 s27, 0x80008000, 0
    v_cvt_f32_u32 v76, v14
    v_mul_f32 v76, 0x3d000000, v76
    v_lshlrev_b32 v77, 2, v15
    v_cvt_f32_u32 v78, v77
    v_mul_f32 v77, v78, v76
    v_fmamk_f32 v80, v76, 0x00000000, v77
    v_fmamk_f32 v81, v76, 0x3f800000, v77
    v_fmamk_f32 v82, v76, 0x40000000, v77
    v_fmamk_f32 v83, v76, 0x40400000, v77
    v_fmamk_f32 v84, v76, 0x41800000, v77
    v_fmamk_f32 v85, v76, 0x41880000, v77
    v_fmamk_f32 v86, v76, 0x41900000, v77
    v_fmamk_f32 v87, v76, 0x41980000, v77
    v_fract_f32 v80, v80
    v_fract_f32 v81, v81
    v_fract_f32 v82, v82
    v_fract_f32 v83, v83
    v_fract_f32 v84, v84
    v_fract_f32 v85, v85
    v_fract_f32 v86, v86
    v_fract_f32 v87, v87
    v_cos_f32 v88, v80
    v_cos_f32 v89, v81
    v_cos_f32 v90, v82
    v_cos_f32 v91, v83
    v_cos_f32 v92, v84
    v_cos_f32 v93, v85
    v_cos_f32 v94, v86
    v_cos_f32 v95, v87
    v_sin_f32 v80, v80
    v_sin_f32 v81, v81
    v_sin_f32 v82, v82
    v_sin_f32 v83, v83
    v_sin_f32 v84, v84
    v_sin_f32 v85, v85
    v_sin_f32 v86, v86
    v_sin_f32 v87, v87
    s_mov_b32 s57, 262144
    s_waitcnt vmcnt(0)
    s_barrier
    s_cmp_lg_u32 s3, 0
    s_cbranch_scc1 kg_kernel_b1
kg_kernel_tga:
    v_readfirstlane_b32 s20, v111
    v_readfirstlane_b32 s56, v110
    s_cmp_eq_u32 s20, 1
    s_cbranch_scc1 kg_kernel_tgb
    s_sub_u32 s57, s57, 1
    s_cmp_lt_i32 s57, 0
    s_cbranch_scc1 kg_kernel_tgb
    buffer_load_dwordx2 v[110:111], off, s[44:47], 0 sc1
    s_waitcnt vmcnt(0)
    s_branch kg_kernel_tga
kg_kernel_tgb:
    s_cmp_ge_u32 s2, 128
    s_cbranch_scc1 kg_kernel_b1
    s_mul_i32 s20, s2, 64
    s_add_u32 s20, s20, 69271552
    v_mov_b32 v109, s56
    buffer_store_dword v109, off, s[12:15], s20 sc1
kg_kernel_b1:
    v_cvt_pk_bf16_f32 v144, v88, v89
    v_cvt_pk_bf16_f32 v145, v90, v91
    v_cvt_pk_bf16_f32 v146, v92, v93
    v_cvt_pk_bf16_f32 v147, v94, v95
    v_cvt_pk_bf16_f32 v152, v80, v81
    v_cvt_pk_bf16_f32 v153, v82, v83
    v_cvt_pk_bf16_f32 v154, v84, v85
    v_cvt_pk_bf16_f32 v155, v86, v87
    v_xor_b32 v148, 0x80000000, v144
    v_xor_b32 v156, 0x80000000, v152
    v_xor_b32 v149, 0x80000000, v145
    v_xor_b32 v157, 0x80000000, v153
    v_xor_b32 v150, 0x80000000, v146
    v_xor_b32 v158, 0x80000000, v154
    v_xor_b32 v151, 0x80000000, v147
    v_xor_b32 v159, 0x80000000, v155
    v_xor_b32 v160, s26, v152
    v_xor_b32 v161, s26, v153
    v_xor_b32 v162, s26, v154
    v_xor_b32 v163, s26, v155
    v_xor_b32 v164, s26, v156
    v_xor_b32 v165, s26, v157
    v_xor_b32 v166, s26, v158
    v_xor_b32 v167, s26, v159
    s_lshl_b32 s20, s4, 4
    v_add_u32 v76, s20, v14
    v_cvt_f32_u32 v76, v76
    v_mul_f32 v76, 0x3a000000, v76
    v_mul_f32 v77, v78, v76
    v_fmamk_f32 v176, v76, 0x00000000, v77
    v_fmamk_f32 v177, v76, 0x3f800000, v77
    v_fmamk_f32 v178, v76, 0x40000000, v77
    v_fmamk_f32 v179, v76, 0x40400000, v77
    v_fmamk_f32 v180, v76, 0x41800000, v77
    v_fmamk_f32 v181, v76, 0x41880000, v77
    v_fmamk_f32 v182, v76, 0x41900000, v77
    v_fmamk_f32 v183, v76, 0x41980000, v77
    v_cos_f32 v168, v176
    v_cos_f32 v169, v177
    v_cos_f32 v170, v178
    v_cos_f32 v171, v179
    v_cos_f32 v172, v180
    v_cos_f32 v173, v181
    v_cos_f32 v174, v182
    v_cos_f32 v175, v183
    v_sin_f32 v176, v176
    v_sin_f32 v177, v177
    v_sin_f32 v178, v178
    v_sin_f32 v179, v179
    v_sin_f32 v180, v180
    v_sin_f32 v181, v181
    v_sin_f32 v182, v182
    v_sin_f32 v183, v183
    v_cvt_f32_u32 v79, s20
    v_add_f32 v78, v78, v79
    v_add_u32 v76, 0, v14
    v_cvt_f32_u32 v76, v76
    v_mul_f32 v76, 0x3a000000, v76
    v_mul_f32 v77, v78, v76
    v_fmamk_f32 v192, v76, 0x00000000, v77
    v_fmamk_f32 v193, v76, 0x3f800000, v77
    v_fmamk_f32 v194, v76, 0x40000000, v77
    v_fmamk_f32 v195, v76, 0x40400000, v77
    v_add_u32 v76, 16, v14
    v_cvt_f32_u32 v76, v76
    v_mul_f32 v76, 0x3a000000, v76
    v_mul_f32 v77, v78, v76
    v_fmamk_f32 v196, v76, 0x00000000, v77
    v_fmamk_f32 v197, v76, 0x3f800000, v77
    v_fmamk_f32 v198, v76, 0x40000000, v77
    v_fmamk_f32 v199, v76, 0x40400000, v77
    v_cos_f32 v184, v192
    v_cos_f32 v185, v193
    v_cos_f32 v186, v194
    v_cos_f32 v187, v195
    v_cos_f32 v188, v196
    v_cos_f32 v189, v197
    v_cos_f32 v190, v198
    v_cos_f32 v191, v199
    v_sin_f32 v192, v192
    v_sin_f32 v193, v193
    v_sin_f32 v194, v194
    v_sin_f32 v195, v195
    v_sin_f32 v196, v196
    v_sin_f32 v197, v197
    v_sin_f32 v198, v198
    v_sin_f32 v199, v199
    s_mov_b32 s28, 0x35e38e39
    v_pk_mul_f32 v[184:185], v[184:185], s[28:29] op_sel:[0,0] op_sel_hi:[1,0] neg_lo:[0,0] neg_hi:[0,0]
    v_pk_mul_f32 v[186:187], v[186:187], s[28:29] op_sel:[0,0] op_sel_hi:[1,0] neg_lo:[0,0] neg_hi:[0,0]
    v_pk_mul_f32 v[188:189], v[188:189], s[28:29] op_sel:[0,0] op_sel_hi:[1,0] neg_lo:[0,0] neg_hi:[0,0]
    v_pk_mul_f32 v[190:191], v[190:191], s[28:29] op_sel:[0,0] op_sel_hi:[1,0] neg_lo:[0,0] neg_hi:[0,0]
    v_pk_mul_f32 v[192:193], v[192:193], s[28:29] op_sel:[0,0] op_sel_hi:[1,0] neg_lo:[0,0] neg_hi:[0,0]
    v_pk_mul_f32 v[194:195], v[194:195], s[28:29] op_sel:[0,0] op_sel_hi:[1,0] neg_lo:[0,0] neg_hi:[0,0]
    v_pk_mul_f32 v[196:197], v[196:197], s[28:29] op_sel:[0,0] op_sel_hi:[1,0] neg_lo:[0,0] neg_hi:[0,0]
    v_pk_mul_f32 v[198:199], v[198:199], s[28:29] op_sel:[0,0] op_sel_hi:[1,0] neg_lo:[0,0] neg_hi:[0,0]
    v_lshrrev_b32 v64, 3, v0
    v_and_b32 v65, 7, v0
    v_xor_b32 v65, v65, v64
    v_lshlrev_b32 v65, 4, v65
    s_lshl_b32 s20, s3, 4
    v_add_u32 v64, s20, v64
    v_mul_u32_u24 v52, 18432, v64
    v_add_u32 v52, v52, v65
    v_mul_u32_u24 v53, 18560, v64
    v_add_u32 v53, v53, v65
    v_and_b32 v64, 1, v15
    s_lshl_b32 s20, s5, 2
    v_or_b32 v64, s20, v64
    v_lshrrev_b32 v65, 1, v15
    v_lshl_add_u32 v66, v65, 5, v14
    v_and_b32 v67, 7, v14
    v_xor_b32 v67, v67, v64
    s_lshl_b32 s20, s30, 1
    v_xor_b32 v67, s20, v67
    v_lshlrev_b32 v67, 4, v67
    v_lshl_add_u32 v54, v66, 7, v67
    v_add_u32 v54, 65536, v54
    v_xor_b32 v55, 32, v54
    v_bfe_u32 v66, v0, 2, 2
    v_lshl_add_u32 v66, v15, 2, v66
    v_lshlrev_b32 v66, 2, v66
    v_add_u32 v66, s4, v66
    v_bfe_u32 v67, v0, 1, 1
    s_lshl_b32 s20, s5, 2
    v_or_b32 v67, s20, v67
    v_and_b32 v68, 7, v66
    v_xor_b32 v67, v67, v68
    v_lshlrev_b32 v67, 4, v67
    v_lshl_add_u32 v56, v66, 7, v67
    v_and_b32 v67, 1, v0
    v_lshl_add_u32 v56, v67, 3, v56
    v_add_u32 v56, 81920, v56
    v_xor_b32 v57, 32, v56
    s_mul_i32 s20, s5, 10240
    s_add_u32 s20, s20, 98304
    v_mul_u32_u24 v58, 160, v14
    v_add_u32 v58, s20, v58
    v_lshl_add_u32 v59, v15, 4, v58
    v_lshl_add_u32 v58, v15, 3, v58
    s_lshl_b32 s21, s4, 5
    v_add_u32 v58, s21, v58
    s_lshl_b32 s20, s4, 5
    v_add_u32 v66, s20, v14
    v_mul_u32_u24 v60, 18432, v66
    v_lshl_add_u32 v60, v65, 4, v60
    s_cmp_eq_u32 s7, 1
    s_cselect_b32 s20, 2146435072, 32
    v_and_b32 v64, 1, v15
    v_mul_lo_u32 v64, v64, s20
    v_add_u32 v60, v60, v64
    s_lshl_b32 s20, s5, 6
    s_lshl_b32 s21, s30, 5
    s_add_u32 s20, s20, s21
    s_and_b32 s21, s30, s5
    s_cselect_b32 s20, 1073217536, s20
    v_add_u32 v60, s20, v60
    s_cmp_lg_u32 s3, 0
    s_cbranch_scc1 kg_kernel_b2
    s_mov_b32 s20, 69271552
    s_mov_b32 s21, 69275648
    v_mul_u32_u24 v108, 64, v0
kg_kernel_gaa:
    buffer_load_dword v104, v108, s[12:15], s20 offen sc1
    buffer_load_dword v105, v108, s[12:15], s21 offen sc1
    s_waitcnt vmcnt(0)
    v_xor_b32 v104, s56, v104
    v_xor_b32 v105, s56, v105
    v_or_b32 v104, v104, v105
    v_cmp_ne_u32 vcc, 0, v104
    s_cbranch_vccz kg_kernel_gab
    s_sub_u32 s57, s57, 1
    s_cmp_lt_i32 s57, 0
    s_cbranch_scc1 kg_kernel_gab
    s_branch kg_kernel_gaa
kg_kernel_gab:
kg_kernel_b2:
    s_add_u32 s22, s29, 128
    s_add_u32 s21, s22, 147456
    s_lshl_b32 s23, s2, 7
    s_add_u32 s23, s23, 4194432
    s_add_u32 s31, s23, 148480
    s_lshl_b32 s20, s3, 11
    s_add_u32 m0, s20, 65536
    s_barrier
    buffer_load_dwordx4 v52, s[12:15], s22 offen sc1 lds
    s_add_u32 m0, s20, 66560
    s_nop 0
    buffer_load_dwordx4 v52, s[12:15], s21 offen sc1 lds
    s_add_u32 m0, s20, 81920
    s_nop 0
    buffer_load_dwordx4 v53, s[12:15], s23 offen sc1 lds
    s_add_u32 m0, s20, 82944
    s_nop 0
    buffer_load_dwordx4 v53, s[12:15], s31 offen sc1 lds
    s_add_u32 s22, s29, 8388608
    s_add_u32 s23, s22, 294912
    s_waitcnt vmcnt(2)
    s_barrier
    ds_read_b128 v[64:67], v54 offset:0
    ds_read_b128 v[68:71], v54 offset:8192
    ds_read_b128 v[72:75], v55 offset:0
    ds_read_b128 v[76:79], v55 offset:8192
    ds_read_b128 v[80:83], v54 offset:2048
    ds_read_b128 v[84:87], v54 offset:10240
    ds_read_b128 v[88:91], v55 offset:2048
    ds_read_b128 v[92:95], v55 offset:10240
    s_cmp_eq_u32 s7, 0
    s_cbranch_scc1 kg_kernel_b4
    s_waitcnt lgkmcnt(0)
    v_mov_b32 v72, 0
    v_mov_b32 v73, 0
    v_mov_b32 v74, 0
    v_mov_b32 v75, 0
    v_mov_b32 v76, 0
    v_mov_b32 v77, 0
    v_mov_b32 v78, 0
    v_mov_b32 v79, 0
    v_mov_b32 v88, 0
    v_mov_b32 v89, 0
    v_mov_b32 v90, 0
    v_mov_b32 v91, 0
    v_mov_b32 v92, 0
    v_mov_b32 v93, 0
    v_mov_b32 v94, 0
    v_mov_b32 v95, 0
    s_nop 1
kg_kernel_b4:
    s_waitcnt lgkmcnt(4)
    v_mfma_f32_16x16x32_bf16 v[104:107], v[64:67], v[28:31], 0
    v_mfma_f32_16x16x32_bf16 v[112:115], v[72:75], v[28:31], 0
    v_mfma_f32_16x16x32_bf16 v[104:107], v[68:71], v[32:35], v[104:107]
    v_mfma_f32_16x16x32_bf16 v[112:115], v[76:79], v[32:35], v[112:115]
    v_mfma_f32_16x16x32_bf16 v[104:107], v[72:75], v[36:39], v[104:107]
    v_mfma_f32_16x16x32_bf16 v[112:115], v[64:67], v[44:47], v[112:115]
    v_mfma_f32_16x16x32_bf16 v[104:107], v[76:79], v[40:43], v[104:107]
    v_mfma_f32_16x16x32_bf16 v[112:115], v[68:71], v[48:51], v[112:115]
    s_waitcnt lgkmcnt(0)
    v_mfma_f32_16x16x32_bf16 v[108:111], v[80:83], v[28:31], 0
    v_mfma_f32_16x16x32_bf16 v[116:119], v[88:91], v[28:31], 0
    v_mfma_f32_16x16x32_bf16 v[108:111], v[84:87], v[32:35], v[108:111]
    v_mfma_f32_16x16x32_bf16 v[116:119], v[92:95], v[32:35], v[116:119]
    v_mfma_f32_16x16x32_bf16 v[108:111], v[88:91], v[36:39], v[108:111]
    v_mfma_f32_16x16x32_bf16 v[116:119], v[80:83], v[44:47], v[116:119]
    v_mfma_f32_16x16x32_bf16 v[108:111], v[92:95], v[40:43], v[108:111]
    v_mfma_f32_16x16x32_bf16 v[116:119], v[84:87], v[48:51], v[116:119]
    s_waitcnt vmcnt(0)
    s_barrier
    ds_read_b64_tr_b16 v[96:97], v56
    ds_read_b64_tr_b16 v[98:99], v56 offset:8192
    ds_read_b64_tr_b16 v[100:101], v57
    ds_read_b64_tr_b16 v[102:103], v57 offset:8192
    s_nop 1
    v_pk_mul_f32 v[120:121], v[104:105], v[168:169]
    v_pk_mul_f32 v[128:129], v[112:113], v[168:169]
    v_pk_mul_f32 v[122:123], v[106:107], v[170:171]
    v_pk_mul_f32 v[130:131], v[114:115], v[170:171]
    v_pk_mul_f32 v[124:125], v[108:109], v[172:173]
    v_pk_mul_f32 v[132:133], v[116:117], v[172:173]
    v_pk_mul_f32 v[126:127], v[110:111], v[174:175]
    v_pk_mul_f32 v[134:135], v[118:119], v[174:175]
    v_pk_fma_f32 v[120:121], v[112:113], v[176:177], v[120:121] neg_lo:[0,0,0] neg_hi:[0,0,0]
    v_pk_fma_f32 v[128:129], v[104:105], v[176:177], v[128:129] neg_lo:[1,0,0] neg_hi:[1,0,0]
    v_pk_fma_f32 v[122:123], v[114:115], v[178:179], v[122:123] neg_lo:[0,0,0] neg_hi:[0,0,0]
    v_pk_fma_f32 v[130:131], v[106:107], v[178:179], v[130:131] neg_lo:[1,0,0] neg_hi:[1,0,0]
    v_pk_fma_f32 v[124:125], v[116:117], v[180:181], v[124:125] neg_lo:[0,0,0] neg_hi:[0,0,0]
    v_pk_fma_f32 v[132:133], v[108:109], v[180:181], v[132:133] neg_lo:[1,0,0] neg_hi:[1,0,0]
    v_pk_fma_f32 v[126:127], v[118:119], v[182:183], v[126:127] neg_lo:[0,0,0] neg_hi:[0,0,0]
    v_pk_fma_f32 v[134:135], v[110:111], v[182:183], v[134:135] neg_lo:[1,0,0] neg_hi:[1,0,0]
    v_cvt_pk_bf16_f32 v64, v120, v121
    v_cvt_pk_bf16_f32 v68, v128, v129
    v_cvt_pk_bf16_f32 v65, v122, v123
    v_cvt_pk_bf16_f32 v69, v130, v131
    v_cvt_pk_bf16_f32 v66, v124, v125
    v_cvt_pk_bf16_f32 v70, v132, v133
    v_cvt_pk_bf16_f32 v67, v126, v127
    v_cvt_pk_bf16_f32 v71, v134, v135
    s_nop 1
    v_mfma_f32_16x16x32_bf16 v[104:107], v[144:147], v[64:67], 0
    v_mfma_f32_16x16x32_bf16 v[112:115], v[144:147], v[68:71], 0
    v_mfma_f32_16x16x32_bf16 v[108:111], v[148:151], v[64:67], 0
    v_mfma_f32_16x16x32_bf16 v[116:119], v[148:151], v[68:71], 0
    v_mfma_f32_16x16x32_bf16 v[104:107], v[152:155], v[68:71], v[104:107]
    v_mfma_f32_16x16x32_bf16 v[112:115], v[160:163], v[64:67], v[112:115]
    v_mfma_f32_16x16x32_bf16 v[108:111], v[156:159], v[68:71], v[108:111]
    v_mfma_f32_16x16x32_bf16 v[116:119], v[164:167], v[64:67], v[116:119]
    s_waitcnt lgkmcnt(0)
    v_lshlrev_b32 v168, 16, v96
    v_and_b32 v169, s24, v96
    v_lshlrev_b32 v176, 16, v100
    v_and_b32 v177, s24, v100
    v_lshlrev_b32 v170, 16, v97
    v_and_b32 v171, s24, v97
    v_lshlrev_b32 v178, 16, v101
    v_and_b32 v179, s24, v101
    v_lshlrev_b32 v172, 16, v98
    v_and_b32 v173, s24, v98
    v_lshlrev_b32 v180, 16, v102
    v_and_b32 v181, s24, v102
    v_lshlrev_b32 v174, 16, v99
    v_and_b32 v175, s24, v99
    v_lshlrev_b32 v182, 16, v103
    v_and_b32 v183, s24, v103
    v_pk_mul_f32 v[120:121], v[104:105], v[168:169]
    v_pk_mul_f32 v[128:129], v[112:113], v[168:169]
    v_pk_mul_f32 v[122:123], v[106:107], v[170:171]
    v_pk_mul_f32 v[130:131], v[114:115], v[170:171]
    v_pk_mul_f32 v[124:125], v[108:109], v[172:173]
    v_pk_mul_f32 v[132:133], v[116:117], v[172:173]
    v_pk_mul_f32 v[126:127], v[110:111], v[174:175]
    v_pk_mul_f32 v[134:135], v[118:119], v[174:175]
    v_pk_fma_f32 v[120:121], v[112:113], v[176:177], v[120:121] neg_lo:[1,0,0] neg_hi:[1,0,0]
    v_pk_fma_f32 v[128:129], v[104:105], v[176:177], v[128:129] neg_lo:[0,0,0] neg_hi:[0,0,0]
    v_pk_fma_f32 v[122:123], v[114:115], v[178:179], v[122:123] neg_lo:[1,0,0] neg_hi:[1,0,0]
    v_pk_fma_f32 v[130:131], v[106:107], v[178:179], v[130:131] neg_lo:[0,0,0] neg_hi:[0,0,0]
    v_pk_fma_f32 v[124:125], v[116:117], v[180:181], v[124:125] neg_lo:[1,0,0] neg_hi:[1,0,0]
    v_pk_fma_f32 v[132:133], v[108:109], v[180:181], v[132:133] neg_lo:[0,0,0] neg_hi:[0,0,0]
    v_pk_fma_f32 v[126:127], v[118:119], v[182:183], v[126:127] neg_lo:[1,0,0] neg_hi:[1,0,0]
    v_pk_fma_f32 v[134:135], v[110:111], v[182:183], v[134:135] neg_lo:[0,0,0] neg_hi:[0,0,0]
    v_cvt_pk_bf16_f32 v64, v120, v121
    v_cvt_pk_bf16_f32 v68, v128, v129
    v_cvt_pk_bf16_f32 v65, v122, v123
    v_cvt_pk_bf16_f32 v69, v130, v131
    v_cvt_pk_bf16_f32 v66, v124, v125
    v_cvt_pk_bf16_f32 v70, v132, v133
    v_cvt_pk_bf16_f32 v67, v126, v127
    v_cvt_pk_bf16_f32 v71, v134, v135
    s_nop 1
    v_mfma_f32_16x16x32_bf16 v[104:107], v[64:67], v[144:147], 0
    v_mfma_f32_16x16x32_bf16 v[112:115], v[68:71], v[144:147], 0
    v_mfma_f32_16x16x32_bf16 v[108:111], v[64:67], v[148:151], 0
    v_mfma_f32_16x16x32_bf16 v[116:119], v[68:71], v[148:151], 0
    v_mfma_f32_16x16x32_bf16 v[104:107], v[68:71], v[160:163], v[104:107]
    v_mfma_f32_16x16x32_bf16 v[112:115], v[64:67], v[152:155], v[112:115]
    v_mfma_f32_16x16x32_bf16 v[108:111], v[68:71], v[164:167], v[108:111]
    v_mfma_f32_16x16x32_bf16 v[116:119], v[64:67], v[156:159], v[116:119]
    s_nop 7
    v_pk_mul_f32 v[120:121], v[104:105], v[184:185]
    v_pk_mul_f32 v[128:129], v[112:113], v[184:185]
    v_pk_mul_f32 v[122:123], v[106:107], v[186:187]
    v_pk_mul_f32 v[130:131], v[114:115], v[186:187]
    v_pk_mul_f32 v[124:125], v[108:109], v[188:189]
    v_pk_mul_f32 v[132:133], v[116:117], v[188:189]
    v_pk_mul_f32 v[126:127], v[110:111], v[190:191]
    v_pk_mul_f32 v[134:135], v[118:119], v[190:191]
    v_pk_fma_f32 v[120:121], v[112:113], v[192:193], v[120:121] neg_lo:[1,0,0] neg_hi:[1,0,0]
    v_pk_fma_f32 v[128:129], v[104:105], v[192:193], v[128:129] neg_lo:[0,0,0] neg_hi:[0,0,0]
    v_pk_fma_f32 v[122:123], v[114:115], v[194:195], v[122:123] neg_lo:[1,0,0] neg_hi:[1,0,0]
    v_pk_fma_f32 v[130:131], v[106:107], v[194:195], v[130:131] neg_lo:[0,0,0] neg_hi:[0,0,0]
    v_pk_fma_f32 v[124:125], v[116:117], v[196:197], v[124:125] neg_lo:[1,0,0] neg_hi:[1,0,0]
    v_pk_fma_f32 v[132:133], v[108:109], v[196:197], v[132:133] neg_lo:[0,0,0] neg_hi:[0,0,0]
    v_pk_fma_f32 v[126:127], v[118:119], v[198:199], v[126:127] neg_lo:[1,0,0] neg_hi:[1,0,0]
    v_pk_fma_f32 v[134:135], v[110:111], v[198:199], v[134:135] neg_lo:[0,0,0] neg_hi:[0,0,0]
    v_cvt_pk_bf16_f32 v64, v120, v121
    v_cvt_pk_bf16_f32 v68, v128, v129
    v_cvt_pk_bf16_f32 v65, v122, v123
    v_cvt_pk_bf16_f32 v69, v130, v131
    v_cvt_pk_bf16_f32 v66, v124, v125
    v_cvt_pk_bf16_f32 v70, v132, v133
    v_cvt_pk_bf16_f32 v67, v126, v127
    v_cvt_pk_bf16_f32 v71, v134, v135
    ds_write_b64 v58, v[64:65] offset:0
    ds_write_b64 v58, v[68:69] offset:5120
    ds_write_b64 v58, v[66:67] offset:2560
    ds_write_b64 v58, v[70:71] offset:7680
    s_waitcnt lgkmcnt(0)
    s_barrier
    ds_read_b128 v[64:67], v59 offset:0
    ds_read_b128 v[68:71], v59 offset:64
    ds_read_b128 v[72:75], v59 offset:5120
    ds_read_b128 v[76:79], v59 offset:5184
    ds_read_b128 v[80:83], v59 offset:2560
    ds_read_b128 v[84:87], v59 offset:2624
    ds_read_b128 v[88:91], v59 offset:7680
    ds_read_b128 v[92:95], v59 offset:7744
    s_waitcnt lgkmcnt(4)
    v_mfma_f32_16x16x32_bf16 v[104:107], v[28:31], v[64:67], 0
    v_mfma_f32_16x16x32_bf16 v[112:115], v[28:31], v[72:75], 0
    v_mfma_f32_16x16x32_bf16 v[104:107], v[32:35], v[68:71], v[104:107]
    v_mfma_f32_16x16x32_bf16 v[112:115], v[32:35], v[76:79], v[112:115]
    v_mfma_f32_16x16x32_bf16 v[104:107], v[44:47], v[72:75], v[104:107]
    v_mfma_f32_16x16x32_bf16 v[112:115], v[36:39], v[64:67], v[112:115]
    v_mfma_f32_16x16x32_bf16 v[104:107], v[48:51], v[76:79], v[104:107]
    v_mfma_f32_16x16x32_bf16 v[112:115], v[40:43], v[68:71], v[112:115]
    s_waitcnt lgkmcnt(0)
    v_mfma_f32_16x16x32_bf16 v[108:111], v[28:31], v[80:83], 0
    v_mfma_f32_16x16x32_bf16 v[116:119], v[28:31], v[88:91], 0
    v_mfma_f32_16x16x32_bf16 v[108:111], v[32:35], v[84:87], v[108:111]
    v_mfma_f32_16x16x32_bf16 v[116:119], v[32:35], v[92:95], v[116:119]
    v_mfma_f32_16x16x32_bf16 v[108:111], v[44:47], v[88:91], v[108:111]
    v_mfma_f32_16x16x32_bf16 v[116:119], v[36:39], v[80:83], v[116:119]
    v_mfma_f32_16x16x32_bf16 v[108:111], v[48:51], v[92:95], v[108:111]
    v_mfma_f32_16x16x32_bf16 v[116:119], v[40:43], v[84:87], v[116:119]
    v_cvt_pk_bf16_f32 v120, v104, v105
    v_cvt_pk_bf16_f32 v121, v106, v107
    v_cvt_pk_bf16_f32 v122, v112, v113
    v_cvt_pk_bf16_f32 v123, v114, v115
    v_xor_b32 v122, s27, v122
    v_xor_b32 v123, s27, v123
    s_nop 1
    v_permlane16_swap_b32 v120, v122
    v_permlane16_swap_b32 v121, v123
    buffer_store_dwordx4 v[120:123], v60, s[12:15], s22 offen sc1
    v_cvt_pk_bf16_f32 v124, v108, v109
    v_cvt_pk_bf16_f32 v125, v110, v111
    v_cvt_pk_bf16_f32 v126, v116, v117
    v_cvt_pk_bf16_f32 v127, v118, v119
    v_xor_b32 v126, s27, v126
    v_xor_b32 v127, s27, v127
    s_nop 1
    v_permlane16_swap_b32 v124, v126
    v_permlane16_swap_b32 v125, v127
    buffer_store_dwordx4 v[124:127], v60, s[12:15], s23 offen sc1
    s_endpgm
kg_kernel_ms:
    s_load_dwordx4 s[40:43], s[0:1], 64
    v_cmp_gt_u32 vcc, 64, v0
    s_cbranch_vccz kg_kernel_end
    s_waitcnt lgkmcnt(0)
    s_mov_b32 s12, s42
    s_mov_b32 s13, s43
    s_mov_b32 s14, 268435456
    s_mov_b32 s15, 0x20000
    s_mov_b32 s44, s40
    s_mov_b32 s45, s41
    s_mov_b32 s46, 256
    s_mov_b32 s47, 0x20000
    s_mov_b32 s57, 262144
    s_mov_b32 s20, 69402624
    buffer_load_dword v64, off, s[12:15], s20 sc1
    v_mov_b32 v65, 1
    s_waitcnt vmcnt(0)
    v_add_u32 v64, 1, v64
    buffer_store_dwordx2 v[64:65], off, s[44:47], 0 sc1
    buffer_store_dword v64, off, s[12:15], s20 sc1
    v_readfirstlane_b32 s56, v64
    v_and_b32 v66, 31, v0
    v_lshlrev_b32 v66, 7, v66
    v_mov_b32 v4, 0
    v_mov_b32 v5, 0
    v_mov_b32 v6, 0
    v_mov_b32 v7, 0
    v_lshlrev_b32 v3, 7, v0
    s_mov_b32 s20, 69730304
    buffer_store_dwordx4 v[4:7], v3, s[12:15], s20 offen
    s_mov_b32 s20, 69738496
    buffer_store_dwordx4 v[4:7], v3, s[12:15], s20 offen
    s_mov_b32 s20, 69746688
    buffer_store_dwordx4 v[4:7], v3, s[12:15], s20 offen
    s_mov_b32 s20, 69754880
    buffer_store_dwordx4 v[4:7], v3, s[12:15], s20 offen
    s_mov_b32 s20, 69763072
    buffer_store_dwordx4 v[4:7], v3, s[12:15], s20 offen
    s_mov_b32 s20, 69771264
    buffer_store_dwordx4 v[4:7], v3, s[12:15], s20 offen
    s_mov_b32 s20, 69779456
    buffer_store_dwordx4 v[4:7], v3, s[12:15], s20 offen
    s_mov_b32 s20, 69787648
    buffer_store_dwordx4 v[4:7], v3, s[12:15], s20 offen
    s_mov_b32 s20, 69795840
    buffer_store_dwordx4 v[4:7], v3, s[12:15], s20 offen
    s_mov_b32 s20, 69804032
    buffer_store_dwordx4 v[4:7], v3, s[12:15], s20 offen
    s_mov_b32 s20, 69812224
    buffer_store_dwordx4 v[4:7], v3, s[12:15], s20 offen
    s_mov_b32 s20, 69820416
    buffer_store_dwordx4 v[4:7], v3, s[12:15], s20 offen
    s_mov_b32 s20, 69828608
    buffer_store_dwordx4 v[4:7], v3, s[12:15], s20 offen
    s_mov_b32 s20, 69836800
    buffer_store_dwordx4 v[4:7], v3, s[12:15], s20 offen
    s_mov_b32 s20, 69844992
    buffer_store_dwordx4 v[4:7], v3, s[12:15], s20 offen
    s_mov_b32 s20, 69853184
    buffer_store_dwordx4 v[4:7], v3, s[12:15], s20 offen
    s_mov_b32 s20, 69861376
    buffer_store_dwordx4 v[4:7], v3, s[12:15], s20 offen
    v_lshlrev_b32 v3, 4, v0
    s_mov_b32 s20, 69894144
    buffer_store_dwordx4 v[4:7], v3, s[12:15], s20 offen
    s_mov_b32 s20, 69895168
    buffer_store_dwordx4 v[4:7], v3, s[12:15], s20 offen
    s_mov_b32 s20, 69896192
    buffer_store_dwordx4 v[4:7], v3, s[12:15], s20 offen
    s_mov_b32 s20, 69271552
    s_mov_b32 s21, 69275648
    v_mul_u32_u24 v108, 64, v0
kg_kernel_paa:
    buffer_load_dword v104, v108, s[12:15], s20 offen sc1
    buffer_load_dword v105, v108, s[12:15], s21 offen sc1
    s_waitcnt vmcnt(0)
    v_xor_b32 v104, s56, v104
    v_xor_b32 v105, s56, v105
    v_or_b32 v104, v104, v105
    v_cmp_ne_u32 vcc, 0, v104
    s_cbranch_vccz kg_kernel_pab
    s_sub_u32 s57, s57, 1
    s_cmp_lt_i32 s57, 0
    s_cbranch_scc0 kg_kernel_paa
kg_kernel_pab:
    s_mov_b32 s20, 69468160
    buffer_store_dword v64, v66, s[12:15], s20 offen sc1
    s_mov_b32 s3, 0
    s_endpgm
kg_kernel_pp:
    s_cmp_eq_u32 s2, 145
    s_cbranch_scc1 kg_kernel_ms
    s_cmp_ge_u32 s2, 256
    s_cbranch_scc1 kg_kernel_end
    s_load_dwordx4 s[32:35], s[0:1], 32
    s_load_dwordx2 s[36:37], s[0:1], 48
    s_load_dwordx2 s[38:39], s[0:1], 72
    v_lshrrev_b32 v1, 6, v0
    s_sub_u32 s31, s2, 146
    v_readfirstlane_b32 s18, v1
    v_and_b32 v2, 63, v0
    v_lshlrev_b32 v3, 4, v2
    v_add_u32 v4, 0, v2
    v_mul_u32_u24 v5, 58255, v4
    v_lshrrev_b32 v5, 22, v5
    v_mul_u32_u24 v6, 8064, v5
    v_lshl_add_u32 v8, v4, 4, v6
    v_add_u32 v4, 64, v2
    v_mul_u32_u24 v5, 58255, v4
    v_lshrrev_b32 v5, 22, v5
    v_mul_u32_u24 v6, 8064, v5
    v_lshl_add_u32 v9, v4, 4, v6
    v_add_u32 v4, 128, v2
    v_mul_u32_u24 v5, 58255, v4
    v_lshrrev_b32 v5, 22, v5
    v_mul_u32_u24 v6, 8064, v5
    v_lshl_add_u32 v10, v4, 4, v6
    v_add_u32 v4, 192, v2
    v_mul_u32_u24 v5, 58255, v4
    v_lshrrev_b32 v5, 22, v5
    v_mul_u32_u24 v6, 8064, v5
    v_lshl_add_u32 v11, v4, 4, v6
    v_add_u32 v4, 256, v2
    v_mul_u32_u24 v5, 58255, v4
    v_lshrrev_b32 v5, 22, v5
    v_mul_u32_u24 v6, 8064, v5
    v_lshl_add_u32 v12, v4, 4, v6
    v_add_u32 v4, 320, v2
    v_mul_u32_u24 v5, 58255, v4
    v_lshrrev_b32 v5, 22, v5
    v_mul_u32_u24 v6, 8064, v5
    v_lshl_add_u32 v13, v4, 4, v6
    v_add_u32 v4, 384, v2
    v_mul_u32_u24 v5, 58255, v4
    v_lshrrev_b32 v5, 22, v5
    v_mul_u32_u24 v6, 8064, v5
    v_lshl_add_u32 v14, v4, 4, v6
    v_add_u32 v4, 448, v2
    v_mul_u32_u24 v5, 58255, v4
    v_lshrrev_b32 v5, 22, v5
    v_mul_u32_u24 v6, 8064, v5
    v_lshl_add_u32 v15, v4, 4, v6
    v_add_u32 v4, 512, v2
    v_mul_u32_u24 v5, 58255, v4
    v_lshrrev_b32 v5, 22, v5
    v_mul_u32_u24 v6, 8064, v5
    v_lshl_add_u32 v16, v4, 4, v6
    s_and_b32 s3, s18, 3
    s_lshr_b32 s19, s18, 2
    s_lshl_b32 s31, s31, 1
    s_add_u32 s31, s31, s19
    s_mul_i32 s30, s19, 73728
    s_mul_i32 s21, s3, 9216
    s_add_u32 s21, s21, s30
    s_waitcnt lgkmcnt(0)
    s_mov_b32 s12, s38
    s_mov_b32 s13, s39
    s_mov_b32 s14, 268435456
    s_mov_b32 s15, 0x20000
    s_mov_b32 s4, s31
    s_cmp_ge_u32 s4, 144
    s_cselect_b32 s8, s34, s32
    s_cselect_b32 s9, s35, s33
    s_cselect_b32 s29, 144, 0
    s_sub_u32 s29, s4, s29
    s_mov_b32 s10, 5308416
    s_mov_b32 s11, 0x20000
    s_lshr_b32 s5, s29, 3
    s_and_b32 s6, s29, 7
    s_lshl_b32 s7, s5, 2
    s_add_u32 s7, s7, s3
    s_mul_i32 s7, s7, 73728
    s_mul_i32 s20, s6, 1152
    s_add_u32 s7, s7, s20
    s_add_u32 m0, s21, 0
    s_nop 0
    buffer_load_dwordx4 v8, s[8:11], s7 offen nt lds
    s_add_u32 m0, s21, 1024
    s_nop 0
    buffer_load_dwordx4 v9, s[8:11], s7 offen nt lds
    s_add_u32 m0, s21, 2048
    s_nop 0
    buffer_load_dwordx4 v10, s[8:11], s7 offen nt lds
    s_add_u32 m0, s21, 3072
    s_nop 0
    buffer_load_dwordx4 v11, s[8:11], s7 offen nt lds
    s_add_u32 m0, s21, 4096
    s_nop 0
    buffer_load_dwordx4 v12, s[8:11], s7 offen nt lds
    s_add_u32 m0, s21, 5120
    s_nop 0
    buffer_load_dwordx4 v13, s[8:11], s7 offen nt lds
    s_add_u32 m0, s21, 6144
    s_nop 0
    buffer_load_dwordx4 v14, s[8:11], s7 offen nt lds
    s_add_u32 m0, s21, 7168
    s_nop 0
    buffer_load_dwordx4 v15, s[8:11], s7 offen nt lds
    s_add_u32 m0, s21, 8192
    s_nop 0
    buffer_load_dwordx4 v16, s[8:11], s7 offen nt lds
    s_lshr_b32 s4, s31, 1
    s_mul_i32 s20, s19, 68
    s_add_u32 s20, s20, s4
    s_cmp_ge_u32 s20, 68
    s_cbranch_scc1 kg_kernel_p1
    s_add_u32 s4, s4, 220
    s_cmp_ge_u32 s4, 144
    s_cselect_b32 s8, s34, s32
    s_cselect_b32 s9, s35, s33
    s_cselect_b32 s29, 144, 0
    s_sub_u32 s29, s4, s29
    s_mov_b32 s10, 5308416
    s_mov_b32 s11, 0x20000
    s_lshr_b32 s5, s29, 3
    s_and_b32 s6, s29, 7
    s_lshl_b32 s7, s5, 2
    s_add_u32 s7, s7, s3
    s_mul_i32 s7, s7, 73728
    s_mul_i32 s20, s6, 1152
    s_add_u32 s7, s7, s20
    s_add_u32 m0, s21, 36864
    s_nop 0
    buffer_load_dwordx4 v8, s[8:11], s7 offen nt lds
    s_add_u32 m0, s21, 37888
    s_nop 0
    buffer_load_dwordx4 v9, s[8:11], s7 offen nt lds
    s_add_u32 m0, s21, 38912
    s_nop 0
    buffer_load_dwordx4 v10, s[8:11], s7 offen nt lds
    s_add_u32 m0, s21, 39936
    s_nop 0
    buffer_load_dwordx4 v11, s[8:11], s7 offen nt lds
    s_add_u32 m0, s21, 40960
    s_nop 0
    buffer_load_dwordx4 v12, s[8:11], s7 offen nt lds
    s_add_u32 m0, s21, 41984
    s_nop 0
    buffer_load_dwordx4 v13, s[8:11], s7 offen nt lds
    s_add_u32 m0, s21, 43008
    s_nop 0
    buffer_load_dwordx4 v14, s[8:11], s7 offen nt lds
    s_add_u32 m0, s21, 44032
    s_nop 0
    buffer_load_dwordx4 v15, s[8:11], s7 offen nt lds
    s_add_u32 m0, s21, 45056
    s_nop 0
    buffer_load_dwordx4 v16, s[8:11], s7 offen nt lds
kg_kernel_p1:
kg_kernel_p2:
    s_cmp_lg_u32 s18, 0
    s_cbranch_scc1 kg_kernel_h9
    s_load_dwordx2 s[40:41], s[0:1], 64
    s_mov_b32 s57, 262144
    s_waitcnt lgkmcnt(0)
    s_mov_b32 s44, s40
    s_mov_b32 s45, s41
    s_mov_b32 s46, 256
    s_mov_b32 s47, 0x20000
kg_kernel_ha:
    buffer_load_dwordx2 v[110:111], off, s[44:47], 0 sc1
    s_waitcnt vmcnt(0)
    v_readfirstlane_b32 s20, v111
    v_readfirstlane_b32 s56, v110
    s_cmp_eq_u32 s20, 1
    s_cbranch_scc1 kg_kernel_hb
    s_sub_u32 s57, s57, 1
    s_cmp_lt_i32 s57, 0
    s_cbranch_scc0 kg_kernel_ha
kg_kernel_hb:
    s_and_b32 s20, s2, 31
    s_lshl_b32 s20, s20, 7
    s_add_u32 s20, s20, 69468160
kg_kernel_hc:
    buffer_load_dword v104, off, s[12:15], s20 sc1
    s_waitcnt vmcnt(0)
    v_cmp_ne_u32 vcc, s56, v104
    s_cbranch_vccz kg_kernel_h9
    s_sub_u32 s57, s57, 1
    s_cmp_lt_i32 s57, 0
    s_cbranch_scc0 kg_kernel_hc
kg_kernel_h9:
    s_waitcnt vmcnt(0)
    s_barrier
    s_mov_b32 s4, s31
    v_lshrrev_b32 v4, 4, v2
    v_bfe_u32 v5, v2, 2, 2
    v_and_b32 v6, 3, v2
    v_lshl_add_u32 v4, v4, 3, v5
    v_mul_u32_u24 v4, 1152, v4
    v_lshl_add_u32 v4, v6, 3, v4
    s_mul_i32 s20, s3, 288
    s_add_u32 s20, s20, s30
    v_add_u32 v4, s20, v4
    s_cmp_ge_u32 s4, 144
    s_cselect_b32 s29, 144, 0
    s_cselect_b32 s28, 4096, 0
    s_sub_u32 s29, s4, s29
    s_lshr_b32 s5, s29, 3
    s_and_b32 s6, s29, 7
    s_lshr_b32 s20, s3, 1
    s_lshl_b32 s6, s6, 1
    s_add_u32 s6, s6, s20
    s_mul_i32 s6, s6, 999424
    s_add_u32 s6, s6, s28
    s_lshr_b32 s24, s5, 1
    s_lshl_b32 s24, s24, 13
    s_add_u32 s6, s6, s24
    s_and_b32 s20, s5, 1
    s_lshl_b32 s20, s20, 10
    s_add_u32 s6, s6, s20
    s_add_u32 s6, s6, 52428800
    s_and_b32 s22, s3, 1
    s_mul_i32 s22, s22, 9
    ds_read_b64_tr_b16 v[24:25], v4 offset:0
    ds_read_b64_tr_b16 v[26:27], v4 offset:4608
    ds_read_b64_tr_b16 v[28:29], v4 offset:32
    ds_read_b64_tr_b16 v[30:31], v4 offset:4640
    ds_read_b64_tr_b16 v[32:33], v4 offset:64
    ds_read_b64_tr_b16 v[34:35], v4 offset:4672
    ds_read_b64_tr_b16 v[36:37], v4 offset:96
    ds_read_b64_tr_b16 v[38:39], v4 offset:4704
    ds_read_b64_tr_b16 v[40:41], v4 offset:128
    ds_read_b64_tr_b16 v[42:43], v4 offset:4736
    ds_read_b64_tr_b16 v[44:45], v4 offset:160
    ds_read_b64_tr_b16 v[46:47], v4 offset:4768
    ds_read_b64_tr_b16 v[48:49], v4 offset:192
    ds_read_b64_tr_b16 v[50:51], v4 offset:4800
    s_waitcnt lgkmcnt(8)
    ds_read_b64_tr_b16 v[52:53], v4 offset:224
    ds_read_b64_tr_b16 v[54:55], v4 offset:4832
    ds_read_b64_tr_b16 v[56:57], v4 offset:256
    ds_read_b64_tr_b16 v[58:59], v4 offset:4864
    s_add_u32 s20, s22, 0
    s_lshr_b32 s25, s20, 1
    s_mul_i32 s23, s25, 73728
    s_lshl_b32 s26, s25, 13
    s_add_u32 s26, s26, s24
    s_cmp_lt_u32 s25, 2
    s_cselect_b32 s23, s26, s23
    s_and_b32 s20, s20, 1
    s_lshl_b32 s20, s20, 11
    s_add_u32 s20, s20, s23
    s_add_u32 s20, s20, s6
    s_waitcnt lgkmcnt(8)
    buffer_store_dwordx4 v[24:27], v3, s[12:15], s20 offen sc1
    s_add_u32 s20, s22, 1
    s_lshr_b32 s25, s20, 1
    s_mul_i32 s23, s25, 73728
    s_lshl_b32 s26, s25, 13
    s_add_u32 s26, s26, s24
    s_cmp_lt_u32 s25, 2
    s_cselect_b32 s23, s26, s23
    s_and_b32 s20, s20, 1
    s_lshl_b32 s20, s20, 11
    s_add_u32 s20, s20, s23
    s_add_u32 s20, s20, s6
    s_waitcnt lgkmcnt(8)
    buffer_store_dwordx4 v[28:31], v3, s[12:15], s20 offen sc1
    s_add_u32 s20, s22, 2
    s_lshr_b32 s25, s20, 1
    s_mul_i32 s23, s25, 73728
    s_lshl_b32 s26, s25, 13
    s_add_u32 s26, s26, s24
    s_cmp_lt_u32 s25, 2
    s_cselect_b32 s23, s26, s23
    s_and_b32 s20, s20, 1
    s_lshl_b32 s20, s20, 11
    s_add_u32 s20, s20, s23
    s_add_u32 s20, s20, s6
    s_waitcnt lgkmcnt(8)
    buffer_store_dwordx4 v[32:35], v3, s[12:15], s20 offen sc1
    s_add_u32 s20, s22, 3
    s_lshr_b32 s25, s20, 1
    s_mul_i32 s23, s25, 73728
    s_lshl_b32 s26, s25, 13
    s_add_u32 s26, s26, s24
    s_cmp_lt_u32 s25, 2
    s_cselect_b32 s23, s26, s23
    s_and_b32 s20, s20, 1
    s_lshl_b32 s20, s20, 11
    s_add_u32 s20, s20, s23
    s_add_u32 s20, s20, s6
    s_waitcnt lgkmcnt(8)
    buffer_store_dwordx4 v[36:39], v3, s[12:15], s20 offen sc1
    s_add_u32 s20, s22, 4
    s_lshr_b32 s25, s20, 1
    s_mul_i32 s23, s25, 73728
    s_lshl_b32 s26, s25, 13
    s_add_u32 s26, s26, s24
    s_cmp_lt_u32 s25, 2
    s_cselect_b32 s23, s26, s23
    s_and_b32 s20, s20, 1
    s_lshl_b32 s20, s20, 11
    s_add_u32 s20, s20, s23
    s_add_u32 s20, s20, s6
    s_waitcnt lgkmcnt(8)
    buffer_store_dwordx4 v[40:43], v3, s[12:15], s20 offen sc1
    s_add_u32 s20, s22, 5
    s_lshr_b32 s25, s20, 1
    s_mul_i32 s23, s25, 73728
    s_lshl_b32 s26, s25, 13
    s_add_u32 s26, s26, s24
    s_cmp_lt_u32 s25, 2
    s_cselect_b32 s23, s26, s23
    s_and_b32 s20, s20, 1
    s_lshl_b32 s20, s20, 11
    s_add_u32 s20, s20, s23
    s_add_u32 s20, s20, s6
    s_waitcnt lgkmcnt(6)
    buffer_store_dwordx4 v[44:47], v3, s[12:15], s20 offen sc1
    s_add_u32 s20, s22, 6
    s_lshr_b32 s25, s20, 1
    s_mul_i32 s23, s25, 73728
    s_lshl_b32 s26, s25, 13
    s_add_u32 s26, s26, s24
    s_cmp_lt_u32 s25, 2
    s_cselect_b32 s23, s26, s23
    s_and_b32 s20, s20, 1
    s_lshl_b32 s20, s20, 11
    s_add_u32 s20, s20, s23
    s_add_u32 s20, s20, s6
    s_waitcnt lgkmcnt(4)
    buffer_store_dwordx4 v[48:51], v3, s[12:15], s20 offen sc1
    s_add_u32 s20, s22, 7
    s_lshr_b32 s25, s20, 1
    s_mul_i32 s23, s25, 73728
    s_lshl_b32 s26, s25, 13
    s_add_u32 s26, s26, s24
    s_cmp_lt_u32 s25, 2
    s_cselect_b32 s23, s26, s23
    s_and_b32 s20, s20, 1
    s_lshl_b32 s20, s20, 11
    s_add_u32 s20, s20, s23
    s_add_u32 s20, s20, s6
    s_waitcnt lgkmcnt(2)
    buffer_store_dwordx4 v[52:55], v3, s[12:15], s20 offen sc1
    s_add_u32 s20, s22, 8
    s_lshr_b32 s25, s20, 1
    s_mul_i32 s23, s25, 73728
    s_lshl_b32 s26, s25, 13
    s_add_u32 s26, s26, s24
    s_cmp_lt_u32 s25, 2
    s_cselect_b32 s23, s26, s23
    s_and_b32 s20, s20, 1
    s_lshl_b32 s20, s20, 11
    s_add_u32 s20, s20, s23
    s_add_u32 s20, s20, s6
    s_waitcnt lgkmcnt(0)
    buffer_store_dwordx4 v[56:59], v3, s[12:15], s20 offen sc1
    s_waitcnt vmcnt(9)
    s_barrier
    s_lshr_b32 s4, s31, 1
    s_mul_i32 s20, s19, 68
    s_add_u32 s20, s20, s4
    s_cmp_ge_u32 s20, 68
    s_cbranch_scc1 kg_kernel_p3
    s_add_u32 s4, s4, 220
    v_lshrrev_b32 v4, 4, v2
    v_bfe_u32 v5, v2, 2, 2
    v_and_b32 v6, 3, v2
    v_lshl_add_u32 v4, v4, 3, v5
    v_mul_u32_u24 v4, 1152, v4
    v_lshl_add_u32 v4, v6, 3, v4
    s_mul_i32 s20, s3, 288
    s_add_u32 s20, s20, s30
    v_add_u32 v4, s20, v4
    s_cmp_ge_u32 s4, 144
    s_cselect_b32 s29, 144, 0
    s_cselect_b32 s28, 4096, 0
    s_sub_u32 s29, s4, s29
    s_lshr_b32 s5, s29, 3
    s_and_b32 s6, s29, 7
    s_lshr_b32 s20, s3, 1
    s_lshl_b32 s6, s6, 1
    s_add_u32 s6, s6, s20
    s_mul_i32 s6, s6, 999424
    s_add_u32 s6, s6, s28
    s_lshr_b32 s24, s5, 1
    s_lshl_b32 s24, s24, 13
    s_add_u32 s6, s6, s24
    s_and_b32 s20, s5, 1
    s_lshl_b32 s20, s20, 10
    s_add_u32 s6, s6, s20
    s_add_u32 s6, s6, 52428800
    s_and_b32 s22, s3, 1
    s_mul_i32 s22, s22, 9
    ds_read_b64_tr_b16 v[64:65], v4 offset:36864
    ds_read_b64_tr_b16 v[66:67], v4 offset:41472
    ds_read_b64_tr_b16 v[68:69], v4 offset:36896
    ds_read_b64_tr_b16 v[70:71], v4 offset:41504
    ds_read_b64_tr_b16 v[72:73], v4 offset:36928
    ds_read_b64_tr_b16 v[74:75], v4 offset:41536
    ds_read_b64_tr_b16 v[76:77], v4 offset:36960
    ds_read_b64_tr_b16 v[78:79], v4 offset:41568
    ds_read_b64_tr_b16 v[80:81], v4 offset:36992
    ds_read_b64_tr_b16 v[82:83], v4 offset:41600
    ds_read_b64_tr_b16 v[84:85], v4 offset:37024
    ds_read_b64_tr_b16 v[86:87], v4 offset:41632
    ds_read_b64_tr_b16 v[88:89], v4 offset:37056
    ds_read_b64_tr_b16 v[90:91], v4 offset:41664
    s_waitcnt lgkmcnt(8)
    ds_read_b64_tr_b16 v[92:93], v4 offset:37088
    ds_read_b64_tr_b16 v[94:95], v4 offset:41696
    ds_read_b64_tr_b16 v[96:97], v4 offset:37120
    ds_read_b64_tr_b16 v[98:99], v4 offset:41728
    s_add_u32 s20, s22, 0
    s_lshr_b32 s25, s20, 1
    s_mul_i32 s23, s25, 73728
    s_lshl_b32 s26, s25, 13
    s_add_u32 s26, s26, s24
    s_cmp_lt_u32 s25, 2
    s_cselect_b32 s23, s26, s23
    s_and_b32 s20, s20, 1
    s_lshl_b32 s20, s20, 11
    s_add_u32 s20, s20, s23
    s_add_u32 s20, s20, s6
    s_waitcnt lgkmcnt(8)
    buffer_store_dwordx4 v[64:67], v3, s[12:15], s20 offen sc1
    s_add_u32 s20, s22, 1
    s_lshr_b32 s25, s20, 1
    s_mul_i32 s23, s25, 73728
    s_lshl_b32 s26, s25, 13
    s_add_u32 s26, s26, s24
    s_cmp_lt_u32 s25, 2
    s_cselect_b32 s23, s26, s23
    s_and_b32 s20, s20, 1
    s_lshl_b32 s20, s20, 11
    s_add_u32 s20, s20, s23
    s_add_u32 s20, s20, s6
    s_waitcnt lgkmcnt(8)
    buffer_store_dwordx4 v[68:71], v3, s[12:15], s20 offen sc1
    s_add_u32 s20, s22, 2
    s_lshr_b32 s25, s20, 1
    s_mul_i32 s23, s25, 73728
    s_lshl_b32 s26, s25, 13
    s_add_u32 s26, s26, s24
    s_cmp_lt_u32 s25, 2
    s_cselect_b32 s23, s26, s23
    s_and_b32 s20, s20, 1
    s_lshl_b32 s20, s20, 11
    s_add_u32 s20, s20, s23
    s_add_u32 s20, s20, s6
    s_waitcnt lgkmcnt(8)
    buffer_store_dwordx4 v[72:75], v3, s[12:15], s20 offen sc1
    s_add_u32 s20, s22, 3
    s_lshr_b32 s25, s20, 1
    s_mul_i32 s23, s25, 73728
    s_lshl_b32 s26, s25, 13
    s_add_u32 s26, s26, s24
    s_cmp_lt_u32 s25, 2
    s_cselect_b32 s23, s26, s23
    s_and_b32 s20, s20, 1
    s_lshl_b32 s20, s20, 11
    s_add_u32 s20, s20, s23
    s_add_u32 s20, s20, s6
    s_waitcnt lgkmcnt(8)
    buffer_store_dwordx4 v[76:79], v3, s[12:15], s20 offen sc1
    s_add_u32 s20, s22, 4
    s_lshr_b32 s25, s20, 1
    s_mul_i32 s23, s25, 73728
    s_lshl_b32 s26, s25, 13
    s_add_u32 s26, s26, s24
    s_cmp_lt_u32 s25, 2
    s_cselect_b32 s23, s26, s23
    s_and_b32 s20, s20, 1
    s_lshl_b32 s20, s20, 11
    s_add_u32 s20, s20, s23
    s_add_u32 s20, s20, s6
    s_waitcnt lgkmcnt(8)
    buffer_store_dwordx4 v[80:83], v3, s[12:15], s20 offen sc1
    s_add_u32 s20, s22, 5
    s_lshr_b32 s25, s20, 1
    s_mul_i32 s23, s25, 73728
    s_lshl_b32 s26, s25, 13
    s_add_u32 s26, s26, s24
    s_cmp_lt_u32 s25, 2
    s_cselect_b32 s23, s26, s23
    s_and_b32 s20, s20, 1
    s_lshl_b32 s20, s20, 11
    s_add_u32 s20, s20, s23
    s_add_u32 s20, s20, s6
    s_waitcnt lgkmcnt(6)
    buffer_store_dwordx4 v[84:87], v3, s[12:15], s20 offen sc1
    s_add_u32 s20, s22, 6
    s_lshr_b32 s25, s20, 1
    s_mul_i32 s23, s25, 73728
    s_lshl_b32 s26, s25, 13
    s_add_u32 s26, s26, s24
    s_cmp_lt_u32 s25, 2
    s_cselect_b32 s23, s26, s23
    s_and_b32 s20, s20, 1
    s_lshl_b32 s20, s20, 11
    s_add_u32 s20, s20, s23
    s_add_u32 s20, s20, s6
    s_waitcnt lgkmcnt(4)
    buffer_store_dwordx4 v[88:91], v3, s[12:15], s20 offen sc1
    s_add_u32 s20, s22, 7
    s_lshr_b32 s25, s20, 1
    s_mul_i32 s23, s25, 73728
    s_lshl_b32 s26, s25, 13
    s_add_u32 s26, s26, s24
    s_cmp_lt_u32 s25, 2
    s_cselect_b32 s23, s26, s23
    s_and_b32 s20, s20, 1
    s_lshl_b32 s20, s20, 11
    s_add_u32 s20, s20, s23
    s_add_u32 s20, s20, s6
    s_waitcnt lgkmcnt(2)
    buffer_store_dwordx4 v[92:95], v3, s[12:15], s20 offen sc1
    s_add_u32 s20, s22, 8
    s_lshr_b32 s25, s20, 1
    s_mul_i32 s23, s25, 73728
    s_lshl_b32 s26, s25, 13
    s_add_u32 s26, s26, s24
    s_cmp_lt_u32 s25, 2
    s_cselect_b32 s23, s26, s23
    s_and_b32 s20, s20, 1
    s_lshl_b32 s20, s20, 11
    s_add_u32 s20, s20, s23
    s_add_u32 s20, s20, s6
    s_waitcnt lgkmcnt(0)
    buffer_store_dwordx4 v[96:99], v3, s[12:15], s20 offen sc1
kg_kernel_p3:
kg_kernel_p4:
    s_mov_b32 s3, s18
kg_kernel_end:
    s_endpgm
.globl k4_kernel
.p2align 8
.type k4_kernel,@function
k4_kernel:
    s_cmp_ge_u32 s2, 256
    s_cbranch_scc1 k4_kernel_end
    s_load_dwordx2 s[38:39], s[0:1], 72
    s_load_dwordx2 s[36:37], s[0:1], 56
    s_load_dwordx2 s[32:33], s[0:1], 0
    s_load_dwordx2 s[52:53], s[0:1], 48
    v_lshrrev_b32 v1, 6, v0
    v_lshlrev_b32 v21, 7, v0
    v_lshlrev_b32 v24, 4, v0
    v_readfirstlane_b32 s3, v1
    v_and_b32 v0, 63, v0
    s_getpc_b64 s[40:41]
    s_cmp_ge_u32 s3, 2
    s_cbranch_scc1 k4_kernel_np
    s_lshr_b32 s20, s2, 3
    s_mul_i32 s21, s20, 43
    s_lshr_b32 s21, s21, 8
    s_mul_i32 s21, s21, 6
    s_sub_u32 s20, s20, s21
    s_lshl_b32 s20, s20, 13
    s_mul_i32 s20, s20, s3
    v_add_u32 v21, s20, v21
    v_min_u32 v21, k4_kernel_end-k4_kernel-256, v21
    global_load_dword v248, v21, s[40:41]
k4_kernel_np:
    s_bfe_u32 s4, s2, 0x20001
    s_bfe_u32 s5, s2, 0x20003
    s_and_b32 s6, s2, 1
    s_lshl_b32 s6, s6, 3
    s_lshr_b32 s7, s2, 5
    s_add_u32 s6, s6, s7
    s_lshl_b32 s7, s4, 2
    s_add_u32 s7, s7, s5
    s_lshl_b32 s28, s3, 12
    v_lshlrev_b32 v2, 4, v0
    s_mul_i32 s44, s7, 999424
    s_add_u32 s44, s44, s28
    s_add_u32 s44, s44, 52428800
    v_add_u32 v5, s44, v2
    s_lshl_b32 s43, s6, 2
    s_add_u32 s43, s43, s3
    s_mul_i32 s45, s43, 36864
    s_add_u32 s44, s45, 16777216
    v_add_u32 v6, s44, v2
    s_getpc_b64 s[40:41]
    s_waitcnt lgkmcnt(0)
    s_mov_b32 s8, s38
    s_mov_b32 s9, s39
    s_mov_b32 s10, 268435456
    s_mov_b32 s11, 0x20000
    s_lshl_b32 s42, s6, 4
    s_add_u32 s42, s42, s7
    v_mov_b32 v47, v24
    s_lshr_b32 s20, s42, 1
    s_mul_i32 s20, s20, 18432
    s_and_b32 s21, s42, 1
    s_lshl_b32 s21, s21, 4
    s_add_u32 s20, s20, s21
    s_add_u32 s20, s20, 8388608
    s_lshl_b32 s22, s3, 10
    v_lshlrev_b32 v94, 1, v47
    s_add_u32 m0, s22, 114688
    s_add_u32 s21, s20, 8192
    buffer_load_dwordx4 v94, s[8:11], s20 offen lds
    s_add_u32 m0, s22, 118784
    s_nop 0
    buffer_load_dwordx4 v94, s[8:11], s21 offen lds
    s_cmp_lg_u32 s3, 0
    s_cbranch_scc1 k4_kernel_c1
    s_mov_b32 m0, 122880
    s_add_u32 s21, s20, 16384
    buffer_load_dwordx4 v94, s[8:11], s21 offen lds
k4_kernel_c1:
    s_lshl_b32 s22, s3, 10
    s_mov_b32 s16, s32
    s_mov_b32 s17, s33
    s_mov_b32 s18, 2359296
    s_mov_b32 s19, 0x20000
    s_lshr_b32 s20, s42, 6
    s_lshl_b32 s20, s20, 1
    s_and_b32 s21, s42, 1
    s_add_u32 s20, s20, s21
    s_lshl_b32 s20, s20, 8
    s_bfe_u32 s21, s42, 0x50001
    s_add_u32 s20, s20, s21
    s_mul_i32 s20, s20, 1152
    v_add_u32 v94, 0, v24
    v_mul_u32_u24 v95, 58255, v94
    v_lshrrev_b32 v95, 26, v95
    v_mul_u32_u24 v95, 35712, v95
    s_add_u32 m0, s22, 142464
    v_add_u32 v94, v94, v95
    buffer_load_dwordx4 v94, s[16:19], s20 offen lds
    v_add_u32 v94, 4096, v24
    v_mul_u32_u24 v95, 58255, v94
    v_lshrrev_b32 v95, 26, v95
    v_mul_u32_u24 v95, 35712, v95
    s_add_u32 m0, s22, 146560
    v_add_u32 v94, v94, v95
    buffer_load_dwordx4 v94, s[16:19], s20 offen lds
    s_cmp_lg_u32 s3, 0
    s_cbranch_scc1 k4_kernel_c3
    v_add_u32 v94, 8192, v24
    v_mul_u32_u24 v95, 58255, v94
    v_lshrrev_b32 v95, 26, v95
    v_mul_u32_u24 v95, 35712, v95
    s_add_u32 m0, s22, 150656
    v_add_u32 v94, v94, v95
    buffer_load_dwordx4 v94, s[16:19], s20 offen lds
k4_kernel_c3:
    s_mov_b32 s24, 0xffff0000
    s_mov_b32 s26, 0x80008000
    s_mov_b32 s25, 0x3ae38e39
    v_and_b32 v25, 31, v0
    v_lshrrev_b32 v26, 5, v0
    s_lshl_b32 s20, s3, 1
    v_add_u32 v26, s20, v26
    v_lshrrev_b32 v45, 4, v0
    s_mov_b32 s54, 5308416
    s_mov_b32 s55, 0x20000
    s_mul_i32 s21, s2, 36864
    s_mul_i32 s20, s3, 9216
    s_add_u32 s21, s21, s20
    s_mov_b32 s35, s20
    s_mov_b32 s33, s21
    v_add_u32 v196, 0, v2
    v_add_u32 v197, 1024, v2
    v_add_u32 v198, 2048, v2
    v_add_u32 v199, 3072, v2
    v_add_u32 v200, 4096, v2
    v_add_u32 v201, 5120, v2
    v_add_u32 v202, 6144, v2
    v_add_u32 v203, 7168, v2
    v_add_u32 v204, 8192, v2
    v_and_b32 v100, 15, v0
    s_lshl_b32 s23, s3, 4
    v_add_u32 v100, s23, v100
    v_and_b32 v103, 1, v100
    v_mul_lo_u32 v103, v103, s26
    v_cvt_f32_u32 v100, v100
    v_mul_f32 v100, 0x3c800000, v100
    v_lshrrev_b32 v101, 4, v0
    v_lshlrev_b32 v101, 3, v101
    v_cvt_f32_u32 v101, v101
    v_mul_f32 v101, v101, v100
    v_fmamk_f32 v104, v100, 0x00000000, v101
    v_fmamk_f32 v105, v100, 0x3f800000, v101
    v_fmamk_f32 v106, v100, 0x40000000, v101
    v_fmamk_f32 v107, v100, 0x40400000, v101
    v_fmamk_f32 v108, v100, 0x40800000, v101
    v_fmamk_f32 v109, v100, 0x40a00000, v101
    v_fmamk_f32 v110, v100, 0x40c00000, v101
    v_fmamk_f32 v111, v100, 0x40e00000, v101
    v_fract_f32 v104, v104
    v_fract_f32 v105, v105
    v_fract_f32 v106, v106
    v_fract_f32 v107, v107
    s_add_u32 m0, s28, 0
    s_mov_b32 s31, 0
    buffer_load_dwordx4 v5, s[8:11], s31 offen offset:0 lds
    v_fract_f32 v108, v108
    v_fract_f32 v109, v109
    v_fract_f32 v110, v110
    v_fract_f32 v111, v111
    v_cos_f32 v112, v104
    v_cos_f32 v113, v105
    v_cos_f32 v114, v106
    v_cos_f32 v115, v107
    v_cos_f32 v116, v108
    v_cos_f32 v117, v109
    v_cos_f32 v118, v110
    v_cos_f32 v119, v111
    v_sin_f32 v104, v104
    v_sin_f32 v105, v105
    buffer_load_dwordx4 v5, s[8:11], s31 offen offset:1024 lds
    v_sin_f32 v106, v106
    v_sin_f32 v107, v107
    v_sin_f32 v108, v108
    v_sin_f32 v109, v109
    v_sin_f32 v110, v110
    v_sin_f32 v111, v111
    v_cvt_pk_bf16_f32 v48, v112, v113
    v_cvt_pk_bf16_f32 v49, v114, v115
    v_cvt_pk_bf16_f32 v50, v116, v117
    v_cvt_pk_bf16_f32 v51, v118, v119
    v_cvt_pk_bf16_f32 v56, v104, v105
    v_cvt_pk_bf16_f32 v57, v106, v107
    v_cvt_pk_bf16_f32 v58, v108, v109
    v_cvt_pk_bf16_f32 v59, v110, v111
    v_xor_b32 v52, v103, v48
    v_xor_b32 v60, v103, v56
    v_xor_b32 v53, v103, v49
    v_xor_b32 v61, v103, v57
    v_xor_b32 v54, v103, v50
    buffer_load_dwordx4 v5, s[8:11], s31 offen offset:2048 lds
    v_xor_b32 v62, v103, v58
    v_xor_b32 v55, v103, v51
    v_xor_b32 v63, v103, v59
    v_xor_b32 v64, s26, v56
    v_xor_b32 v65, s26, v57
    v_xor_b32 v66, s26, v58
    v_xor_b32 v67, s26, v59
    v_xor_b32 v68, s26, v60
    v_xor_b32 v69, s26, v61
    v_xor_b32 v70, s26, v62
    v_xor_b32 v71, s26, v63
    v_lshlrev_b32 v94, 1, v25
    v_mul_u32_u24 v95, 57, v94
    v_lshrrev_b32 v95, 9, v95
    v_mul_u32_u24 v95, 9, v95
    v_sub_u32 v94, v95, v94
    v_lshlrev_b32 v94, 7, v94
    v_add_u32 v27, 0, v94
    v_add_u32 v95, 1152, v94
    v_min_u32 v27, v27, v95
    v_add_u32 v28, 128, v94
    v_add_u32 v95, 1280, v94
    v_min_u32 v28, v28, v95
    v_add_u32 v29, 256, v94
    buffer_load_dwordx4 v5, s[8:11], s31 offen offset:3072 lds
    v_add_u32 v95, 1408, v94
    v_min_u32 v29, v29, v95
    v_add_u32 v30, 384, v94
    v_add_u32 v95, 1536, v94
    v_min_u32 v30, v30, v95
    v_add_u32 v31, 512, v94
    v_add_u32 v95, 1664, v94
    v_min_u32 v31, v31, v95
    v_add_u32 v32, 640, v94
    v_add_u32 v95, 1792, v94
    v_min_u32 v32, v32, v95
    v_add_u32 v33, 768, v94
    v_add_u32 v95, 1920, v94
    v_min_u32 v33, v33, v95
    v_add_u32 v34, 896, v94
    v_add_u32 v95, 2048, v94
    v_min_u32 v34, v34, v95
    v_add_u32 v35, 1024, v94
    v_add_u32 v95, 2176, v94
    v_min_u32 v35, v35, v95
    v_mul_u32_u24 v94, 1152, v26
    v_lshl_add_u32 v94, v25, 2, v94
    v_add_u32 v94, 142464, v94
    v_add_u32 v36, v94, v27
    s_add_u32 m0, s28, 16384
    s_mov_b32 s31, 16384
    buffer_load_dwordx4 v5, s[8:11], s31 offen offset:0 lds
    v_add_u32 v37, v94, v28
    v_add_u32 v38, v94, v29
    v_add_u32 v39, v94, v30
    v_add_u32 v40, v94, v31
    v_add_u32 v41, v94, v32
    v_add_u32 v42, v94, v33
    v_add_u32 v43, v94, v34
    v_add_u32 v44, v94, v35
    s_mov_b32 s94, 0x3f441b7d
    s_mov_b32 s95, 0x3e31d0d4
    s_mov_b32 s96, 0xbf708fb2
    s_mov_b32 s97, 0x3f248dbb
    s_mov_b32 s98, 0x3f7c1c5c
    s_mov_b32 s99, 0x3eaf1d44
    s_mov_b32 s100, 0x3f5db3d7
    s_mov_b32 s101, 0xbf000000
    v_mov_b32 v73, v49
    v_mov_b32 v77, v65
    v_mov_b32 v74, v50
    v_mov_b32 v78, v66
    v_mov_b32 v75, v51
    v_mov_b32 v79, v67
    v_and_b32 v94, s24, v48
    v_or_b32 v94, 0x3f00, v94
    buffer_load_dwordx4 v5, s[8:11], s31 offen offset:1024 lds
    v_and_b32 v95, s24, v64
    v_and_b32 v46, 1, v0
    v_lshl_or_b32 v95, v46, 15, v95
    v_or_b32 v95, 0x3f00, v95
    v_cmp_gt_u32 vcc, 16, v0
    s_nop 1
    v_cndmask_b32 v72, v48, v94, vcc
    v_cndmask_b32 v76, v64, v95, vcc
    v_bfe_u32 v94, v0, 2, 2
    v_lshl_add_u32 v46, v45, 3, v94
    v_mul_u32_u24 v46, 9, v46
    v_and_b32 v94, 1, v0
    v_lshlrev_b32 v94, 3, v94
    v_add_u32 v94, 114688, v94
    v_add_u32 v95, 0, v46
    v_lshl_add_u32 v88, v95, 5, v94
    v_add_u32 v95, 36, v46
    v_lshl_add_u32 v89, v95, 5, v94
    v_bfe_u32 v95, v0, 1, 1
    v_lshl_add_u32 v46, v95, 6, v46
    v_add_u32 v80, 64, v46
    v_subrev_u32 v95, 576, v80
    v_min_u32 v80, v80, v95
    v_sub_u32 v95, 576, v80
    buffer_load_dwordx4 v5, s[8:11], s31 offen offset:2048 lds
    v_min_u32 v80, v80, v95
    v_lshl_add_u32 v80, v80, 5, v94
    v_add_u32 v81, 100, v46
    v_subrev_u32 v95, 576, v81
    v_min_u32 v81, v81, v95
    v_sub_u32 v95, 576, v81
    v_min_u32 v81, v81, v95
    v_lshl_add_u32 v81, v81, 5, v94
    v_add_u32 v82, 352, v46
    v_subrev_u32 v95, 576, v82
    v_min_u32 v82, v82, v95
    v_sub_u32 v95, 576, v82
    v_min_u32 v82, v82, v95
    v_lshl_add_u32 v82, v82, 5, v94
    v_add_u32 v83, 388, v46
    v_subrev_u32 v95, 576, v83
    v_min_u32 v83, v83, v95
    v_sub_u32 v95, 576, v83
    v_min_u32 v83, v83, v95
    v_lshl_add_u32 v83, v83, 5, v94
    v_add_u32 v84, 192, v46
    v_subrev_u32 v95, 576, v84
    v_min_u32 v84, v84, v95
    v_sub_u32 v95, 576, v84
    buffer_load_dwordx4 v5, s[8:11], s31 offen offset:3072 lds
    v_min_u32 v84, v84, v95
    v_lshl_add_u32 v84, v84, 5, v94
    v_add_u32 v85, 228, v46
    v_subrev_u32 v95, 576, v85
    v_min_u32 v85, v85, v95
    v_sub_u32 v95, 576, v85
    v_min_u32 v85, v85, v95
    v_lshl_add_u32 v85, v85, 5, v94
    v_add_u32 v86, 480, v46
    v_subrev_u32 v95, 576, v86
    v_min_u32 v86, v86, v95
    v_sub_u32 v95, 576, v86
    v_min_u32 v86, v86, v95
    v_lshl_add_u32 v86, v86, 5, v94
    v_add_u32 v87, 516, v46
    v_subrev_u32 v95, 576, v87
    v_min_u32 v87, v87, v95
    v_sub_u32 v95, 576, v87
    v_min_u32 v87, v87, v95
    v_lshl_add_u32 v87, v87, 5, v94
    v_and_b32 v94, 7, v0
    v_mul_u32_u24 v92, 2320, v94
    v_lshl_add_u32 v92, v45, 4, v92
    s_lshl_b32 s21, s3, 6
    s_add_u32 s21, s21, 123904
    s_add_u32 m0, s35, 65536
    s_nop 0
    buffer_load_dwordx4 v196, s[52:55], s33 offen nt lds
    v_add_u32 v92, s21, v92
    v_bfe_u32 v94, v0, 3, 1
    v_lshl_add_u32 v90, v94, 9, v92
    v_lshrrev_b32 v94, 2, v25
    v_xor_b32 v95, v94, v26
    v_lshlrev_b32 v95, 4, v95
    v_lshl_add_u32 v95, v94, 7, v95
    v_and_b32 v94, 3, v25
    v_lshl_add_u32 v95, v94, 2, v95
    v_add_u32 v95, 142464, v95
    v_lshl_add_u32 v27, v27, 3, v95
    v_lshl_add_u32 v28, v28, 3, v95
    s_add_u32 m0, s35, 66560
    s_nop 0
    buffer_load_dwordx4 v197, s[52:55], s33 offen nt lds
    v_lshl_add_u32 v29, v29, 3, v95
    v_lshl_add_u32 v30, v30, 3, v95
    v_lshl_add_u32 v31, v31, 3, v95
    v_lshl_add_u32 v32, v32, 3, v95
    v_lshl_add_u32 v33, v33, 3, v95
    v_lshl_add_u32 v34, v34, 3, v95
    v_lshl_add_u32 v35, v35, 3, v95
    v_mul_u32_u24 v91, 2320, v26
    v_lshl_add_u32 v91, v25, 3, v91
    v_add_u32 v91, 123904, v91
    v_lshrrev_b32 v94, 7, v24
    v_bfe_u32 v95, v24, 4, 3
    s_add_u32 m0, s35, 67584
    s_nop 0
    buffer_load_dwordx4 v198, s[52:55], s33 offen nt lds
    v_and_b32 v46, 7, v94
    v_xor_b32 v95, v95, v46
    v_lshlrev_b32 v95, 4, v95
    v_lshrrev_b32 v46, 2, v94
    v_lshl_add_u32 v95, v46, 11, v95
    v_and_b32 v46, 3, v94
    v_lshl_add_u32 v93, v46, 8, v95
    v_add_u32 v24, 142464, v24
    s_lshr_b32 s27, s42, 2
    s_mul_i32 s27, s27, 36864
    s_bfe_u32 s21, s42, 0x10001
    s_lshl_b32 s21, s21, 10
    s_add_u32 s27, s27, s21
    s_and_b32 s21, s42, 1
    s_lshl_b32 s21, s21, 7
    s_add_u32 s27, s27, s21
    s_waitcnt vmcnt(11)
    s_barrier
    ds_read_b64_tr_b16 v[100:101], v80 offset:0
    ds_read_b64_tr_b16 v[102:103], v81 offset:0
    ds_read_b64_tr_b16 v[104:105], v82 offset:0
    ds_read_b64_tr_b16 v[106:107], v83 offset:0
    ds_read_b64_tr_b16 v[108:109], v80 offset:16
    ds_read_b64_tr_b16 v[110:111], v81 offset:16
    ds_read_b64_tr_b16 v[112:113], v82 offset:16
    ds_read_b64_tr_b16 v[114:115], v83 offset:16
    ds_read_b64_tr_b16 v[116:117], v84 offset:0
    ds_read_b64_tr_b16 v[118:119], v85 offset:0
    ds_read_b64_tr_b16 v[120:121], v86 offset:0
    ds_read_b64_tr_b16 v[122:123], v87 offset:0
    ds_read_b64_tr_b16 v[124:125], v84 offset:16
    ds_read_b64_tr_b16 v[126:127], v85 offset:16
    ds_read_b64_tr_b16 v[128:129], v86 offset:16
    ds_read_b64_tr_b16 v[130:131], v87 offset:16
    ds_read_b64_tr_b16 v[132:133], v88 offset:0
    ds_read_b64_tr_b16 v[134:135], v89 offset:0
    ds_read_b64_tr_b16 v[136:137], v88 offset:16
    ds_read_b64_tr_b16 v[138:139], v89 offset:16
    s_waitcnt lgkmcnt(12)
    s_add_u32 m0, s35, 68608
    s_nop 0
    buffer_load_dwordx4 v199, s[52:55], s33 offen nt lds
    v_mfma_f32_16x16x32_bf16 v[140:143], v[48:51], v[100:103], 0
    ds_read_b32 v36, v36
    v_mfma_f32_16x16x32_bf16 v[144:147], v[48:51], v[108:111], 0
    ds_read_b32 v37, v37
    v_mfma_f32_16x16x32_bf16 v[140:143], v[52:55], v[104:107], v[140:143]
    ds_read_b32 v38, v38
    v_mfma_f32_16x16x32_bf16 v[144:147], v[52:55], v[112:115], v[144:147]
    ds_read_b32 v39, v39
    v_mfma_f32_16x16x32_bf16 v[140:143], v[64:67], v[108:111], v[140:143]
    ds_read_b32 v40, v40
    v_mfma_f32_16x16x32_bf16 v[144:147], v[56:59], v[100:103], v[144:147]
    ds_read_b32 v41, v41
    s_add_u32 m0, s35, 69632
    s_nop 0
    buffer_load_dwordx4 v200, s[52:55], s33 offen nt lds
    v_mfma_f32_16x16x32_bf16 v[140:143], v[68:71], v[112:115], v[140:143]
    ds_read_b32 v42, v42
    v_mfma_f32_16x16x32_bf16 v[144:147], v[60:63], v[104:107], v[144:147]
    ds_read_b32 v43, v43
    ds_read_b32 v44, v44
    s_waitcnt lgkmcnt(13)
    v_mfma_f32_16x16x32_bf16 v[148:151], v[48:51], v[116:119], 0
    v_mfma_f32_16x16x32_bf16 v[152:155], v[48:51], v[124:127], 0
    v_mfma_f32_16x16x32_bf16 v[148:151], v[52:55], v[120:123], v[148:151]
    v_mfma_f32_16x16x32_bf16 v[152:155], v[52:55], v[128:131], v[152:155]
    v_mfma_f32_16x16x32_bf16 v[148:151], v[64:67], v[124:127], v[148:151]
    v_mfma_f32_16x16x32_bf16 v[152:155], v[56:59], v[116:119], v[152:155]
    s_add_u32 m0, s35, 70656
    s_nop 0
    buffer_load_dwordx4 v201, s[52:55], s33 offen nt lds
    v_mfma_f32_16x16x32_bf16 v[148:151], v[68:71], v[128:131], v[148:151]
    v_mfma_f32_16x16x32_bf16 v[152:155], v[60:63], v[120:123], v[152:155]
    s_waitcnt lgkmcnt(9)
    v_mfma_f32_16x16x32_bf16 v[156:159], v[72:75], v[132:135], 0
    v_mfma_f32_16x16x32_bf16 v[156:159], v[76:79], v[136:139], v[156:159]
    ds_write_b128 v90, v[140:143] offset:256
    ds_write_b128 v90, v[144:147] offset:512
    s_nop 4
    ds_write_b128 v90, v[148:151] offset:1280
    ds_write_b128 v90, v[152:155] offset:1536
    s_nop 4
    ds_write_b128 v92, v[156:159]
    s_waitcnt lgkmcnt(5)
    s_add_u32 m0, s35, 71680
    s_nop 0
    buffer_load_dwordx4 v202, s[52:55], s33 offen nt lds
    v_lshlrev_b32 v160, 16, v36
    v_and_b32 v163, s24, v36
    v_lshlrev_b32 v162, 16, v37
    v_and_b32 v165, s24, v37
    v_lshlrev_b32 v164, 16, v38
    v_and_b32 v167, s24, v38
    v_lshlrev_b32 v166, 16, v39
    v_and_b32 v169, s24, v39
    v_lshlrev_b32 v168, 16, v40
    v_and_b32 v171, s24, v40
    v_lshlrev_b32 v170, 16, v41
    v_and_b32 v173, s24, v41
    s_add_u32 m0, s35, 72704
    s_nop 0
    buffer_load_dwordx4 v203, s[52:55], s33 offen nt lds
    v_lshlrev_b32 v172, 16, v42
    v_and_b32 v175, s24, v42
    v_lshlrev_b32 v174, 16, v43
    v_and_b32 v177, s24, v43
    v_lshlrev_b32 v176, 16, v44
    v_and_b32 v161, s24, v44
    s_waitcnt lgkmcnt(0)
    s_barrier
    ds_read_b64 v[100:101], v91 offset:0
    ds_read_b64 v[102:103], v91 offset:256
    ds_read_b64 v[104:105], v91 offset:512
    ds_read_b64 v[106:107], v91 offset:768
    ds_read_b64 v[108:109], v91 offset:1024
    ds_read_b64 v[110:111], v91 offset:1280
    ds_read_b64 v[112:113], v91 offset:1536
    ds_read_b64 v[114:115], v91 offset:1792
    ds_read_b64 v[116:117], v91 offset:2048
    s_waitcnt lgkmcnt(0)
    s_add_u32 m0, s35, 73728
    s_nop 0
    buffer_load_dwordx4 v204, s[52:55], s33 offen nt lds
    v_pk_fma_f32 v[136:137], v[110:111], s[100:101], v[100:101] op_sel:[0,1,0] op_sel_hi:[1,1,1] neg_lo:[0,0,0] neg_hi:[0,0,0]
    v_pk_mul_f32 v[138:139], v[112:113], s[100:101] op_sel:[0,0] op_sel_hi:[1,0] neg_lo:[0,0] neg_hi:[0,0]
    v_pk_add_f32 v[140:141], v[102:103], v[106:107] neg_lo:[0,0] neg_hi:[0,0]
    v_pk_fma_f32 v[120:121], v[102:103], s[94:95], v[136:137] op_sel:[0,0,0] op_sel_hi:[1,0,1] neg_lo:[0,0,0] neg_hi:[0,0,0]
    v_pk_fma_f32 v[122:123], v[102:103], s[94:95], v[136:137] op_sel:[0,1,0] op_sel_hi:[1,1,1] neg_lo:[0,0,0] neg_hi:[0,0,0]
    v_pk_fma_f32 v[126:127], v[102:103], s[96:97], v[136:137] op_sel:[0,0,0] op_sel_hi:[1,0,1] neg_lo:[0,0,0] neg_hi:[0,0,0]
    v_pk_add_f32 v[140:141], v[140:141], v[114:115] neg_lo:[0,0] neg_hi:[0,0]
    v_pk_fma_f32 v[128:129], v[104:105], s[96:97], v[138:139] op_sel:[0,1,0] op_sel_hi:[1,1,1] neg_lo:[0,0,0] neg_hi:[0,0,0]
    v_pk_fma_f32 v[130:131], v[104:105], s[98:99], v[138:139] op_sel:[0,0,0] op_sel_hi:[1,0,1] neg_lo:[0,0,1] neg_hi:[0,0,1]
    v_pk_fma_f32 v[134:135], v[104:105], s[98:99], v[138:139] op_sel:[0,1,0] op_sel_hi:[1,1,1] neg_lo:[0,0,0] neg_hi:[0,0,0]
    v_pk_add_f32 v[136:137], v[100:101], v[110:111] neg_lo:[0,0] neg_hi:[0,0]
    v_pk_add_f32 v[138:139], v[104:105], v[108:109] neg_lo:[0,1] neg_hi:[0,1]
    v_pk_fma_f32 v[120:121], v[106:107], s[94:95], v[120:121] op_sel:[0,1,0] op_sel_hi:[1,1,1] neg_lo:[0,0,0] neg_hi:[0,0,0]
    v_pk_fma_f32 v[122:123], v[106:107], s[96:97], v[122:123] op_sel:[0,0,0] op_sel_hi:[1,0,1] neg_lo:[0,0,0] neg_hi:[0,0,0]
    v_pk_fma_f32 v[126:127], v[106:107], s[94:95], v[126:127] op_sel:[0,0,0] op_sel_hi:[1,0,1] neg_lo:[0,0,0] neg_hi:[0,0,0]
    v_pk_fma_f32 v[128:129], v[108:109], s[98:99], v[128:129] op_sel:[0,0,0] op_sel_hi:[1,0,1] neg_lo:[0,0,0] neg_hi:[0,0,0]
    v_pk_fma_f32 v[130:131], v[108:109], s[98:99], v[130:131] op_sel:[0,1,0] op_sel_hi:[1,1,1] neg_lo:[0,0,0] neg_hi:[0,0,0]
    v_pk_fma_f32 v[134:135], v[108:109], s[96:97], v[134:135] op_sel:[0,1,0] op_sel_hi:[1,1,1] neg_lo:[1,0,0] neg_hi:[1,0,0]
    v_pk_fma_f32 v[120:121], v[114:115], s[96:97], v[120:121] op_sel:[0,0,0] op_sel_hi:[1,0,1] neg_lo:[0,0,0] neg_hi:[0,0,0]
    v_pk_fma_f32 v[122:123], v[114:115], s[94:95], v[122:123] op_sel:[0,0,0] op_sel_hi:[1,0,1] neg_lo:[0,0,0] neg_hi:[0,0,0]
    v_pk_fma_f32 v[126:127], v[114:115], s[94:95], v[126:127] op_sel:[0,1,0] op_sel_hi:[1,1,1] neg_lo:[0,0,0] neg_hi:[0,0,0]
    v_pk_fma_f32 v[128:129], v[116:117], s[98:99], v[128:129] op_sel:[0,1,0] op_sel_hi:[1,1,1] neg_lo:[0,0,0] neg_hi:[0,0,0]
    v_pk_fma_f32 v[130:131], v[116:117], s[96:97], v[130:131] op_sel:[0,1,0] op_sel_hi:[1,1,1] neg_lo:[1,0,0] neg_hi:[1,0,0]
    v_pk_fma_f32 v[134:135], v[116:117], s[98:99], v[134:135] op_sel:[0,0,0] op_sel_hi:[1,0,1] neg_lo:[1,0,0] neg_hi:[1,0,0]
    s_add_u32 m0, s28, 32768
    s_mov_b32 s31, 32768
    buffer_load_dwordx4 v5, s[8:11], s31 offen offset:0 lds
    v_pk_add_f32 v[138:139], v[138:139], v[116:117] neg_lo:[0,0] neg_hi:[0,0]
    v_pk_fma_f32 v[124:125], v[140:141], s[100:101], v[136:137] op_sel:[0,1,0] op_sel_hi:[1,1,1] neg_lo:[0,0,0] neg_hi:[0,0,0]
    v_pk_add_f32 v[118:119], v[136:137], v[140:141] neg_lo:[0,0] neg_hi:[0,0]
    v_pk_mul_f32 v[132:133], v[138:139], s[100:101] op_sel:[0,0] op_sel_hi:[1,0] neg_lo:[0,0] neg_hi:[0,0]
    v_pk_add_f32 v[102:103], v[120:121], v[128:129] neg_lo:[0,1] neg_hi:[0,1]
    v_pk_add_f32 v[116:117], v[120:121], v[128:129] neg_lo:[0,0] neg_hi:[0,0]
    v_pk_add_f32 v[104:105], v[122:123], v[130:131] neg_lo:[0,1] neg_hi:[0,1]
    v_pk_add_f32 v[114:115], v[122:123], v[130:131] neg_lo:[0,0] neg_hi:[0,0]
    v_pk_add_f32 v[106:107], v[124:125], v[132:133] neg_lo:[0,1] neg_hi:[0,1]
    v_pk_add_f32 v[112:113], v[124:125], v[132:133] neg_lo:[0,0] neg_hi:[0,0]
    v_pk_add_f32 v[108:109], v[126:127], v[134:135] neg_lo:[0,1] neg_hi:[0,1]
    v_pk_add_f32 v[110:111], v[126:127], v[134:135] neg_lo:[0,0] neg_hi:[0,0]
    v_pk_add_f32 v[160:161], v[160:161], v[118:119] neg_lo:[0,0] neg_hi:[0,0]
    v_pk_add_f32 v[162:163], v[162:163], v[102:103] neg_lo:[0,0] neg_hi:[0,0]
    v_pk_add_f32 v[164:165], v[164:165], v[104:105] neg_lo:[0,0] neg_hi:[0,0]
    v_pk_add_f32 v[166:167], v[166:167], v[106:107] neg_lo:[0,0] neg_hi:[0,0]
    v_pk_add_f32 v[168:169], v[168:169], v[108:109] neg_lo:[0,0] neg_hi:[0,0]
    v_pk_add_f32 v[170:171], v[170:171], v[110:111] neg_lo:[0,0] neg_hi:[0,0]
    v_pk_add_f32 v[172:173], v[172:173], v[112:113] neg_lo:[0,0] neg_hi:[0,0]
    v_pk_add_f32 v[174:175], v[174:175], v[114:115] neg_lo:[0,0] neg_hi:[0,0]
    v_pk_add_f32 v[176:177], v[176:177], v[116:117] neg_lo:[0,0] neg_hi:[0,0]
    v_cvt_pk_bf16_f32 v36, v160, v163
    v_cvt_pk_bf16_f32 v37, v162, v165
    v_cvt_pk_bf16_f32 v38, v164, v167
    buffer_load_dwordx4 v5, s[8:11], s31 offen offset:1024 lds
    v_cvt_pk_bf16_f32 v39, v166, v169
    v_cvt_pk_bf16_f32 v40, v168, v171
    v_cvt_pk_bf16_f32 v41, v170, v173
    v_cvt_pk_bf16_f32 v42, v172, v175
    v_cvt_pk_bf16_f32 v43, v174, v177
    v_cvt_pk_bf16_f32 v44, v176, v161
    ds_write_b32 v27, v36
    ds_write_b32 v28, v37
    ds_write_b32 v29, v38
    ds_write_b32 v30, v39
    ds_write_b32 v31, v40
    ds_write_b32 v32, v41
    ds_write_b32 v33, v42
    ds_write_b32 v34, v43
    ds_write_b32 v35, v44
    v_lshlrev_b32 v160, 16, v36
    v_and_b32 v161, s24, v36
    v_lshlrev_b32 v162, 16, v37
    v_and_b32 v163, s24, v37
    v_lshlrev_b32 v164, 16, v38
    v_and_b32 v165, s24, v38
    v_lshlrev_b32 v166, 16, v39
    v_and_b32 v167, s24, v39
    v_lshlrev_b32 v168, 16, v40
    buffer_load_dwordx4 v5, s[8:11], s31 offen offset:2048 lds
    v_and_b32 v169, s24, v40
    v_lshlrev_b32 v170, 16, v41
    v_and_b32 v171, s24, v41
    v_lshlrev_b32 v172, 16, v42
    v_and_b32 v173, s24, v42
    v_lshlrev_b32 v174, 16, v43
    v_and_b32 v175, s24, v43
    v_lshlrev_b32 v176, 16, v44
    v_and_b32 v177, s24, v44
    v_pk_add_f32 v[136:137], v[160:161], v[162:163] neg_lo:[0,0] neg_hi:[0,0]
    v_pk_add_f32 v[138:139], v[164:165], v[166:167] neg_lo:[0,0] neg_hi:[0,0]
    v_pk_add_f32 v[140:141], v[168:169], v[170:171] neg_lo:[0,0] neg_hi:[0,0]
    v_pk_add_f32 v[136:137], v[136:137], v[172:173] neg_lo:[0,0] neg_hi:[0,0]
    v_pk_add_f32 v[138:139], v[138:139], v[174:175] neg_lo:[0,0] neg_hi:[0,0]
    v_pk_add_f32 v[140:141], v[140:141], v[176:177] neg_lo:[0,0] neg_hi:[0,0]
    v_pk_add_f32 v[136:137], v[136:137], v[138:139] neg_lo:[0,0] neg_hi:[0,0]
    v_pk_add_f32 v[136:137], v[136:137], v[140:141] neg_lo:[0,0] neg_hi:[0,0]
    v_add_f32 v136, v136, v137
    s_nop 1
    v_add_f32_dpp v136, v136, v136 quad_perm:[1,0,3,2] row_mask:0xf bank_mask:0xf
    s_nop 1
    v_add_f32_dpp v136, v136, v136 quad_perm:[2,3,0,1] row_mask:0xf bank_mask:0xf
    s_nop 1
    v_add_f32_dpp v136, v136, v136 row_half_mirror row_mask:0xf bank_mask:0xf
    s_nop 1
    buffer_load_dwordx4 v5, s[8:11], s31 offen offset:3072 lds
    v_add_f32_dpp v136, v136, v136 row_mirror row_mask:0xf bank_mask:0xf
    v_mov_b32 v137, v136
    s_nop 1
    v_permlane16_swap_b32 v137, v136
    s_nop 0
    v_add_f32 v136, v136, v137
    v_mul_f32 v136, s25, v136
    v_pk_add_f32 v[160:161], v[160:161], v[136:137] op_sel_hi:[1,0] neg_lo:[0,1] neg_hi:[0,1]
    v_pk_add_f32 v[162:163], v[162:163], v[136:137] op_sel_hi:[1,0] neg_lo:[0,1] neg_hi:[0,1]
    v_pk_add_f32 v[164:165], v[164:165], v[136:137] op_sel_hi:[1,0] neg_lo:[0,1] neg_hi:[0,1]
    v_pk_add_f32 v[166:167], v[166:167], v[136:137] op_sel_hi:[1,0] neg_lo:[0,1] neg_hi:[0,1]
    v_pk_add_f32 v[168:169], v[168:169], v[136:137] op_sel_hi:[1,0] neg_lo:[0,1] neg_hi:[0,1]
    v_pk_add_f32 v[170:171], v[170:171], v[136:137] op_sel_hi:[1,0] neg_lo:[0,1] neg_hi:[0,1]
    v_pk_add_f32 v[172:173], v[172:173], v[136:137] op_sel_hi:[1,0] neg_lo:[0,1] neg_hi:[0,1]
    v_pk_add_f32 v[174:175], v[174:175], v[136:137] op_sel_hi:[1,0] neg_lo:[0,1] neg_hi:[0,1]
    v_pk_add_f32 v[176:177], v[176:177], v[136:137] op_sel_hi:[1,0] neg_lo:[0,1] neg_hi:[0,1]
    v_pk_mul_f32 v[138:139], v[160:161], v[160:161]
    v_pk_mul_f32 v[140:141], v[162:163], v[162:163]
    v_pk_fma_f32 v[138:139], v[164:165], v[164:165], v[138:139]
    v_pk_fma_f32 v[140:141], v[166:167], v[166:167], v[140:141]
    v_pk_fma_f32 v[138:139], v[168:169], v[168:169], v[138:139]
    v_pk_fma_f32 v[140:141], v[170:171], v[170:171], v[140:141]
    v_pk_fma_f32 v[138:139], v[172:173], v[172:173], v[138:139]
    v_pk_fma_f32 v[140:141], v[174:175], v[174:175], v[140:141]
    s_add_u32 m0, s28, 49152
    s_mov_b32 s31, 49152
    buffer_load_dwordx4 v5, s[8:11], s31 offen offset:0 lds
    v_pk_fma_f32 v[138:139], v[176:177], v[176:177], v[138:139]
    v_pk_add_f32 v[138:139], v[138:139], v[140:141] neg_lo:[0,0] neg_hi:[0,0]
    v_add_f32 v138, v138, v139
    v_cvt_pk_bf16_f32 v137, v136, v136
    v_and_b32 v137, s24, v137
    v_sub_f32 v136, v136, v137
    s_nop 1
    v_add_f32_dpp v138, v138, v138 quad_perm:[1,0,3,2] row_mask:0xf bank_mask:0xf
    s_nop 1
    v_add_f32_dpp v138, v138, v138 quad_perm:[2,3,0,1] row_mask:0xf bank_mask:0xf
    s_nop 1
    v_add_f32_dpp v138, v138, v138 row_half_mirror row_mask:0xf bank_mask:0xf
    s_nop 1
    v_add_f32_dpp v138, v138, v138 row_mirror row_mask:0xf bank_mask:0xf
    v_mov_b32 v139, v138
    s_nop 1
    v_permlane16_swap_b32 v139, v138
    s_nop 0
    v_add_f32 v138, v138, v139
    v_mul_f32 v138, s25, v138
    v_cvt_pk_bf16_f32 v138, v138, v138
    v_and_b32 v138, s24, v138
    v_add_f32 v138, 0x3727c5ac, v138
    v_cvt_pk_bf16_f32 v138, v138, v138
    buffer_load_dwordx4 v5, s[8:11], s31 offen offset:1024 lds
    v_and_b32 v138, s24, v138
    v_sqrt_f32 v138, v138
    s_nop 0
    v_cvt_pk_bf16_f32 v138, v138, v138
    v_and_b32 v138, s24, v138
    v_rcp_f32 v138, v138
    s_nop 0
    v_mul_f32 v138, 0xbfb8aa3b, v138
    v_mul_f32 v136, v136, v138
    v_pk_fma_f32 v[160:161], v[160:161], v[138:139], v[136:137] op_sel_hi:[1,0,0]
    v_pk_fma_f32 v[162:163], v[162:163], v[138:139], v[136:137] op_sel_hi:[1,0,0]
    v_pk_fma_f32 v[164:165], v[164:165], v[138:139], v[136:137] op_sel_hi:[1,0,0]
    v_pk_fma_f32 v[166:167], v[166:167], v[138:139], v[136:137] op_sel_hi:[1,0,0]
    v_pk_fma_f32 v[168:169], v[168:169], v[138:139], v[136:137] op_sel_hi:[1,0,0]
    v_pk_fma_f32 v[170:171], v[170:171], v[138:139], v[136:137] op_sel_hi:[1,0,0]
    v_pk_fma_f32 v[172:173], v[172:173], v[138:139], v[136:137] op_sel_hi:[1,0,0]
    v_pk_fma_f32 v[174:175], v[174:175], v[138:139], v[136:137] op_sel_hi:[1,0,0]
    v_pk_fma_f32 v[176:177], v[176:177], v[138:139], v[136:137] op_sel_hi:[1,0,0]
    v_cvt_pk_bf16_f32 v100, v160, v161
    v_cvt_pk_bf16_f32 v101, v162, v163
    v_cvt_pk_bf16_f32 v102, v164, v165
    v_cvt_pk_bf16_f32 v103, v166, v167
    v_cvt_pk_bf16_f32 v104, v168, v169
    v_cvt_pk_bf16_f32 v105, v170, v171
    buffer_load_dwordx4 v5, s[8:11], s31 offen offset:2048 lds
    v_cvt_pk_bf16_f32 v106, v172, v173
    v_cvt_pk_bf16_f32 v107, v174, v175
    v_cvt_pk_bf16_f32 v108, v176, v177
    ds_write_b32 v27, v100 offset:9216
    ds_write_b32 v28, v101 offset:9216
    ds_write_b32 v29, v102 offset:9216
    ds_write_b32 v30, v103 offset:9216
    ds_write_b32 v31, v104 offset:9216
    ds_write_b32 v32, v105 offset:9216
    ds_write_b32 v33, v106 offset:9216
    ds_write_b32 v34, v107 offset:9216
    ds_write_b32 v35, v108 offset:9216
    s_waitcnt lgkmcnt(0)
    s_barrier
    ds_read_b128 v[120:123], v24 offset:9216
    ds_read_b128 v[124:127], v24 offset:13312
    ds_read_b128 v[204:207], v24 offset:0
    ds_read_b128 v[208:211], v24 offset:4096
    s_cmp_lg_u32 s3, 0
    s_cbranch_scc1 k4_kernel_c2
    ds_read_b128 v[212:215], v24 offset:8192
    ds_read_b128 v[132:135], v24 offset:17408
    s_waitcnt lgkmcnt(0)
    s_add_u32 s22, s27, 16809984
    buffer_store_dwordx4 v[132:135], v93, s[8:11], s22 offen sc1
k4_kernel_c2:
    s_waitcnt lgkmcnt(0)
    s_add_u32 s22, s27, 16777216
    buffer_store_dwordx4 v[120:123], v93, s[8:11], s22 offen sc1
    s_add_u32 s22, s27, 16793600
    buffer_store_dwordx4 v[124:127], v93, s[8:11], s22 offen sc1
    v_mov_b32 v254, v93
    s_add_u32 s16, s27, 12582912
    s_add_u32 s17, s27, 12599296
    s_add_u32 s18, s27, 12615680
    s_cmp_eq_u32 s3, 0
    s_cselect_b32 s18, s18, 0x7ff00000
    s_mov_b32 s12, s36
    s_mov_b32 s13, s37
    s_mov_b32 s14, 2359296
    s_mov_b32 s15, 0x20000
    s_bfe_u32 s20, s2, 0x40003
    s_cmp_eq_u32 s20, s3
    s_cselect_b32 s20, 128, 0
    v_mul_lo_u32 v250, v0, s20
    s_getpc_b64 s[40:41]
k4_kernel_pc:
    s_mov_b32 s34, 0x40000
    s_mov_b32 s30, 0xbfb8aa3b
    v_add_u32 v3, 0x10000, v2
    v_add_u32 v4, 0x20000, v2
    s_mul_i32 s46, s5, 9216
    s_add_u32 s50, s45, s46
    s_add_u32 s50, s50, 20971520
    s_mul_i32 s44, s4, 2359296
    s_add_u32 s44, s44, s50
    v_add_u32 v7, s44, v2
    s_lshl_b32 s44, s6, 4
    s_lshl_b32 s46, s4, 2
    s_add_u32 s44, s44, s46
    s_lshl_b32 s44, s44, 2
    s_add_u32 s44, s44, s3
    s_mul_i32 s44, s44, 18432
    s_add_u32 s44, s44, 33554432
    s_mul_i32 s46, s5, 73728
    s_add_u32 s46, s46, s44
    v_add_u32 v8, s46, v2
    s_add_u32 s46, s5, 1
    s_and_b32 s46, s46, 3
    s_mul_i32 s46, s46, 73728
    s_add_u32 s46, s46, s44
    v_add_u32 v10, s46, v2
    s_add_u32 s46, s5, 2
    s_and_b32 s46, s46, 3
    s_mul_i32 s46, s46, 73728
    s_add_u32 s46, s46, s44
    v_add_u32 v11, s46, v2
    s_add_u32 s46, s5, 3
    s_and_b32 s46, s46, 3
    s_mul_i32 s46, s46, 73728
    s_add_u32 s46, s46, s44
    v_add_u32 v12, s46, v2
    s_lshl_b32 s44, s6, 2
    s_add_u32 s46, s44, s4
    s_lshl_b32 s46, s46, 2
    s_add_u32 s46, s46, s3
    s_lshl_b32 s46, s46, 7
    s_add_u32 s46, s46, 69730304
    v_mov_b32 v9, s46
    s_lshl_b32 s47, s5, 2
    v_mov_b32 v13, 1
    s_add_u32 s46, s44, s5
    s_lshl_b32 s46, s46, 2
    s_add_u32 s46, s46, s3
    s_lshl_b32 s46, s46, 7
    s_add_u32 s46, s46, 69828608
    v_mov_b32 v1, s46
    s_lshl_b32 s51, s4, 2
    v_add_u32 v14, 32768, v9
    v_add_u32 v15, 65536, v9
    s_lshl_b32 s44, s6, 2
    s_add_u32 s46, s44, s4
    s_lshl_b32 s46, s46, 7
    s_add_u32 s46, s46, s47
    s_add_u32 s46, s46, 69861376
    s_add_u32 s44, s44, s3
    s_lshl_b32 s44, s44, 7
    s_add_u32 s44, s44, 69861376
    v_lshrrev_b32 v100, 4, v0
    v_bfe_u32 v101, v0, 2, 2
    v_and_b32 v102, 3, v0
    v_lshl_add_u32 v100, v100, 2, v101
    v_mul_u32_u24 v100, 1152, v100
    v_lshl_add_u32 v100, v102, 3, v100
    s_mul_i32 s20, s3, 288
    s_add_u32 s20, s20, 65536
    v_add_u32 v100, s20, v100
    s_mul_i32 s52, s2, 7282
    s_lshr_b32 s52, s52, 16
    s_mul_i32 s53, s52, 9
    s_sub_u32 s53, s2, s53
    s_and_b32 s20, s52, 3
    s_sub_u32 s20, s20, s3
    s_and_b32 s20, s20, 3
    s_mul_i32 s24, s20, 4
    s_add_u32 s24, s24, 4
    s_mul_i32 s25, s20, 3
    s_add_u32 s25, s25, 14
    s_mul_i32 s26, s20, 2
    s_add_u32 s26, s26, 21
    s_mov_b32 s22, s24
    s_cmp_ge_u32 s53, 4
    s_cselect_b32 s22, s25, s22
    s_cmp_ge_u32 s53, 7
    s_cselect_b32 s22, s26, s22
    s_cmp_eq_u32 s53, 8
    s_cselect_b32 s23, 12, 0
    s_cmp_eq_u32 s20, 0
    s_cselect_b32 s22, s23, s22
    s_add_u32 s22, s22, s53
    s_lshr_b32 s23, s22, 1
    s_mul_i32 s24, s23, 7
    s_add_u32 s24, s24, 0
    s_mov_b32 s27, 2048
    s_add_u32 s25, s23, 90
    s_cmp_ge_u32 s23, 15
    s_cselect_b32 s24, s25, s24
    s_cselect_b32 s27, 6144, s27
    s_lshl_b32 s26, s23, 1
    s_add_u32 s26, s26, 126
    s_mul_i32 s25, s23, 9
    s_cmp_lt_u32 s23, 0
    s_cselect_b32 s24, s25, s24
    s_add_u32 s25, s25, 7
    s_cmp_lt_u32 s23, 0
    s_cselect_b32 s26, s25, s26
    s_and_b32 s22, s22, 1
    s_lshl_b32 s22, s22, 10
    s_lshr_b32 s54, s52, 2
    s_and_b32 s52, s52, 12
    s_add_u32 s52, s52, s3
    s_mul_i32 s53, s52, 999424
    s_add_u32 s53, s53, s22
    s_add_u32 s53, s53, 53092352
    s_lshl_b32 s24, s24, 11
    s_add_u32 s24, s24, s53
    s_lshl_b32 s26, s26, 11
    s_add_u32 s26, s26, s53
    s_add_u32 s22, s54, 0
    s_and_b32 s22, s22, 3
    s_lshl_b32 s22, s22, 6
    v_add_u32 v104, s22, v100
    s_add_u32 s22, s54, 1
    s_and_b32 s22, s22, 3
    s_lshl_b32 s22, s22, 6
    v_add_u32 v105, s22, v100
    s_add_u32 s22, s54, 2
    s_and_b32 s22, s22, 3
    s_lshl_b32 s22, s22, 6
    v_add_u32 v106, s22, v100
    s_add_u32 s22, s54, 3
    s_and_b32 s22, s22, 3
    s_lshl_b32 s22, s22, 6
    v_add_u32 v107, s22, v100
    s_mul_i32 s23, s27, 0
    s_add_u32 s23, s23, s24
    v_writelane_b32 v249, s23, 0
    s_mul_i32 s23, s27, 1
    s_add_u32 s23, s23, s24
    v_writelane_b32 v249, s23, 1
    s_mul_i32 s23, s27, 2
    s_add_u32 s23, s23, s24
    v_writelane_b32 v249, s23, 2
    s_mul_i32 s23, s27, 3
    s_add_u32 s23, s23, s24
    v_writelane_b32 v249, s23, 3
    s_mul_i32 s23, s27, 4
    s_add_u32 s23, s23, s24
    v_writelane_b32 v249, s23, 4
    s_mul_i32 s23, s27, 5
    s_add_u32 s23, s23, s24
    v_writelane_b32 v249, s23, 5
    s_mul_i32 s23, s27, 6
    s_add_u32 s23, s23, s24
    v_writelane_b32 v249, s23, 6
    s_add_u32 s23, s26, 0
    v_writelane_b32 v249, s23, 7
    s_add_u32 s23, s26, 2048
    v_writelane_b32 v249, s23, 8
    v_add_u32 v110, 256, v100
    v_add_u32 v120, 18688, v100
    v_add_u32 v111, 0, v105
    v_add_u32 v121, 18432, v105
    v_add_u32 v112, 32, v105
    v_add_u32 v122, 18464, v105
    v_add_u32 v113, 0, v106
    v_add_u32 v123, 18432, v106
    v_add_u32 v114, 32, v106
    v_add_u32 v124, 18464, v106
    v_add_u32 v115, 0, v107
    v_add_u32 v125, 18432, v107
    v_add_u32 v116, 32, v107
    v_add_u32 v126, 18464, v107
    v_add_u32 v117, 0, v104
    v_add_u32 v127, 18432, v104
    v_add_u32 v118, 32, v104
    v_add_u32 v128, 18464, v104
    s_cmp_lt_u32 s2, 144
    s_cselect_b32 s24, 0, 0x7ff00000
    v_add_u32 v248, s24, v2
    s_lshl_b32 s35, s2, 4
    s_add_u32 s35, s35, 69894144
    s_cmp_eq_u32 s3, 0
    s_cselect_b32 s35, s35, 0x7ff00000
    s_mul_i32 s20, s4, 576
    s_add_u32 s20, s20, 69894144
    v_min_u32 v255, 35, v0
    v_lshlrev_b32 v255, 4, v255
    v_add_u32 v255, s20, v255
    s_waitcnt vmcnt(0)
    s_barrier
    s_cmp_lg_u32 s3, 0
    s_cbranch_scc1 k4_kernel_fc0
    buffer_store_dword v13, off, s[8:11], s46 sc1
k4_kernel_fc0:
    ds_read_b64_tr_b16 a[144:145], v110
    ds_read_b64_tr_b16 a[146:147], v120
    ds_read_b64_tr_b16 a[148:149], v111
    ds_read_b64_tr_b16 a[150:151], v121
    ds_read_b64_tr_b16 a[152:153], v112
    ds_read_b64_tr_b16 a[154:155], v122
    ds_read_b64_tr_b16 a[156:157], v113
    ds_read_b64_tr_b16 a[158:159], v123
    ds_read_b64_tr_b16 a[160:161], v114
    ds_read_b64_tr_b16 a[162:163], v124
    ds_read_b64_tr_b16 a[164:165], v115
    ds_read_b64_tr_b16 a[166:167], v125
    ds_read_b64_tr_b16 a[168:169], v116
    ds_read_b64_tr_b16 a[170:171], v126
    ds_read_b64_tr_b16 a[172:173], v117
    ds_read_b64_tr_b16 a[174:175], v127
    ds_read_b64_tr_b16 a[176:177], v118
    ds_read_b64_tr_b16 a[178:179], v128
    buffer_load_dwordx4 v5, s[8:11], s31 offen offset:3072 lds
    s_waitcnt lgkmcnt(0)
    s_barrier
    s_add_u32 m0, s28, 65536
    s_mov_b32 s31, 65536
    buffer_load_dwordx4 v5, s[8:11], s31 offen offset:0 lds
    buffer_load_dwordx4 v5, s[8:11], s31 offen offset:1024 lds
    buffer_load_dwordx4 v5, s[8:11], s31 offen offset:2048 lds
    buffer_load_dwordx4 v5, s[8:11], s31 offen offset:3072 lds
    s_add_u32 m0, s28, 81920
    s_mov_b32 s31, 81920
    buffer_load_dwordx4 v5, s[8:11], s31 offen offset:0 lds
    buffer_load_dwordx4 v5, s[8:11], s31 offen offset:1024 lds
    buffer_load_dwordx4 v5, s[8:11], s31 offen offset:2048 lds
    buffer_load_dwordx4 v5, s[8:11], s31 offen offset:3072 lds
    s_add_u32 m0, s28, 98304
    s_mov_b32 s31, 98304
    buffer_load_dwordx4 v5, s[8:11], s31 offen offset:0 lds
    buffer_load_dwordx4 v5, s[8:11], s31 offen offset:1024 lds
    buffer_load_dwordx4 v5, s[8:11], s31 offen offset:2048 lds
    buffer_load_dwordx4 v5, s[8:11], s31 offen offset:3072 lds
k4_kernel_fca:
    buffer_load_dwordx4 v[16:19], off, s[8:11], s44 sc1
    s_waitcnt vmcnt(0)
    v_and_b32 v20, v16, v17
    v_and_b32 v21, v18, v19
    v_and_b32 v20, v20, v21
    v_cmp_ne_u32 vcc, 0, v20
    s_cbranch_vccnz k4_kernel_fcb
    s_sub_u32 s34, s34, 1
    s_cmp_lt_i32 s34, 0
    s_cbranch_scc0 k4_kernel_fca
k4_kernel_fcb:
    s_mov_b32 s29, 0
    buffer_load_dwordx4 a[0:3], v6, s[8:11], s29 offen offset:0 sc1
    buffer_load_dwordx4 a[4:7], v6, s[8:11], s29 offen offset:1024 sc1
    buffer_load_dwordx4 a[8:11], v6, s[8:11], s29 offen offset:2048 sc1
    buffer_load_dwordx4 a[12:15], v6, s[8:11], s29 offen offset:3072 sc1
    s_mov_b32 s29, 4096
    buffer_load_dwordx4 a[16:19], v6, s[8:11], s29 offen offset:0 sc1
    buffer_load_dwordx4 a[20:23], v6, s[8:11], s29 offen offset:1024 sc1
    buffer_load_dwordx4 a[24:27], v6, s[8:11], s29 offen offset:2048 sc1
    buffer_load_dwordx4 a[28:31], v6, s[8:11], s29 offen offset:3072 sc1
    s_mov_b32 s29, 8192
    buffer_load_dwordx4 a[32:35], v6, s[8:11], s29 offen offset:0 sc1
    buffer_load_dwordx4 a[36:39], v6, s[8:11], s29 offen offset:1024 sc1
    buffer_load_dwordx4 a[40:43], v6, s[8:11], s29 offen offset:2048 sc1
    buffer_load_dwordx4 a[44:47], v6, s[8:11], s29 offen offset:3072 sc1
    s_mov_b32 s29, 12288
    buffer_load_dwordx4 a[48:51], v6, s[8:11], s29 offen offset:0 sc1
    buffer_load_dwordx4 a[52:55], v6, s[8:11], s29 offen offset:1024 sc1
    s_cmp_eq_u32 s3, 0
    s_cselect_b32 s33, s46, 0x7ff00000
    s_mov_b32 s32, s44
    v_mov_b32 v253, 3
    s_barrier
    ds_read_b128 v[24:27], v2 offset:0
    ds_read_b128 v[28:31], v2 offset:1024
    ds_read_b128 v[32:35], v2 offset:2048
    ds_read_b128 v[36:39], v2 offset:3072
    ds_read_b128 v[40:43], v2 offset:4096
    ds_read_b128 v[44:47], v2 offset:5120
    ds_read_b128 v[48:51], v2 offset:6144
    ds_read_b128 v[52:55], v2 offset:7168
    s_waitcnt vmcnt(10)
    s_waitcnt lgkmcnt(4)
    v_mfma_f32_16x16x32_bf16 v[72:75], v[24:27], a[0:3], 0
    ds_read_b128 v[56:59], v2 offset:8192
    ds_read_b128 v[60:63], v2 offset:9216
    v_mfma_f32_16x16x32_bf16 v[72:75], v[28:31], a[8:11], v[72:75]
    buffer_load_dwordx4 a[56:59], v6, s[8:11], s29 offen offset:2048 sc1
    v_mfma_f32_16x16x32_bf16 v[76:79], v[24:27], a[4:7], 0
    v_mfma_f32_16x16x32_bf16 v[76:79], v[28:31], a[12:15], v[76:79]
    v_mfma_f32_16x16x32_bf16 v[80:83], v[32:35], a[0:3], 0
    ds_read_b128 v[64:67], v2 offset:10240
    ds_read_b128 v[68:71], v2 offset:11264
    v_mfma_f32_16x16x32_bf16 v[80:83], v[36:39], a[8:11], v[80:83]
    v_mfma_f32_16x16x32_bf16 v[84:87], v[32:35], a[4:7], 0
    buffer_load_dwordx4 a[60:63], v6, s[8:11], s29 offen offset:3072 sc1
    v_mfma_f32_16x16x32_bf16 v[84:87], v[36:39], a[12:15], v[84:87]
    s_waitcnt lgkmcnt(4)
    v_mfma_f32_16x16x32_bf16 v[88:91], v[40:43], a[0:3], 0
    ds_read_b128 v[24:27], v2 offset:12288
    ds_read_b128 v[28:31], v2 offset:13312
    v_mfma_f32_16x16x32_bf16 v[88:91], v[44:47], a[8:11], v[88:91]
    v_mfma_f32_16x16x32_bf16 v[92:95], v[40:43], a[4:7], 0
    v_mfma_f32_16x16x32_bf16 v[92:95], v[44:47], a[12:15], v[92:95]
    s_mov_b32 s29, 16384
    buffer_load_dwordx4 a[64:67], v6, s[8:11], s29 offen offset:0 sc1
    v_mfma_f32_16x16x32_bf16 v[96:99], v[48:51], a[0:3], 0
    ds_read_b128 v[32:35], v2 offset:14336
    ds_read_b128 v[36:39], v2 offset:15360
    v_mfma_f32_16x16x32_bf16 v[96:99], v[52:55], a[8:11], v[96:99]
    v_mfma_f32_16x16x32_bf16 v[100:103], v[48:51], a[4:7], 0
    v_mfma_f32_16x16x32_bf16 v[100:103], v[52:55], a[12:15], v[100:103]
    s_waitcnt lgkmcnt(4)
    v_mfma_f32_16x16x32_bf16 v[104:107], v[56:59], a[0:3], 0
    s_barrier
    ds_read_b128 v[40:43], v2 offset:16384
    ds_read_b128 v[44:47], v2 offset:17408
    v_mfma_f32_16x16x32_bf16 v[104:107], v[60:63], a[8:11], v[104:107]
    buffer_load_dwordx4 a[68:71], v6, s[8:11], s29 offen offset:1024 sc1
    v_mfma_f32_16x16x32_bf16 v[108:111], v[56:59], a[4:7], 0
    v_mfma_f32_16x16x32_bf16 v[108:111], v[60:63], a[12:15], v[108:111]
    v_mfma_f32_16x16x32_bf16 v[112:115], v[64:67], a[0:3], 0
    ds_read_b128 v[48:51], v2 offset:18432
    ds_read_b128 v[52:55], v2 offset:19456
    v_mfma_f32_16x16x32_bf16 v[112:115], v[68:71], a[8:11], v[112:115]
    v_mfma_f32_16x16x32_bf16 v[116:119], v[64:67], a[4:7], 0
    buffer_load_dwordx4 a[72:75], v6, s[8:11], s29 offen offset:2048 sc1
    v_mfma_f32_16x16x32_bf16 v[116:119], v[68:71], a[12:15], v[116:119]
    s_waitcnt lgkmcnt(4)
    v_mfma_f32_16x16x32_bf16 v[120:123], v[24:27], a[0:3], 0
    ds_read_b128 v[56:59], v2 offset:20480
    ds_read_b128 v[60:63], v2 offset:21504
    v_mfma_f32_16x16x32_bf16 v[120:123], v[28:31], a[8:11], v[120:123]
    v_mfma_f32_16x16x32_bf16 v[124:127], v[24:27], a[4:7], 0
    v_mfma_f32_16x16x32_bf16 v[124:127], v[28:31], a[12:15], v[124:127]
    buffer_load_dwordx4 a[76:79], v6, s[8:11], s29 offen offset:3072 sc1
    v_mfma_f32_16x16x32_bf16 v[128:131], v[32:35], a[0:3], 0
    ds_read_b128 v[64:67], v2 offset:22528
    ds_read_b128 v[68:71], v2 offset:23552
    v_mfma_f32_16x16x32_bf16 v[128:131], v[36:39], a[8:11], v[128:131]
    v_mfma_f32_16x16x32_bf16 v[132:135], v[32:35], a[4:7], 0
    v_mfma_f32_16x16x32_bf16 v[132:135], v[36:39], a[12:15], v[132:135]
    s_waitcnt vmcnt(12)
    s_waitcnt lgkmcnt(4)
    v_mfma_f32_16x16x32_bf16 v[72:75], v[40:43], a[16:19], v[72:75]
    ds_read_b128 v[24:27], v2 offset:24576
    ds_read_b128 v[28:31], v2 offset:25600
    v_mfma_f32_16x16x32_bf16 v[72:75], v[44:47], a[24:27], v[72:75]
    s_mov_b32 s29, 20480
    buffer_load_dwordx4 a[80:83], v6, s[8:11], s29 offen offset:0 sc1
    v_mfma_f32_16x16x32_bf16 v[76:79], v[40:43], a[20:23], v[76:79]
    v_mfma_f32_16x16x32_bf16 v[76:79], v[44:47], a[28:31], v[76:79]
    v_mfma_f32_16x16x32_bf16 v[80:83], v[48:51], a[16:19], v[80:83]
    ds_read_b128 v[32:35], v2 offset:26624
    ds_read_b128 v[36:39], v2 offset:27648
    v_mfma_f32_16x16x32_bf16 v[80:83], v[52:55], a[24:27], v[80:83]
    v_mfma_f32_16x16x32_bf16 v[84:87], v[48:51], a[20:23], v[84:87]
    buffer_load_dwordx4 a[84:87], v6, s[8:11], s29 offen offset:1024 sc1
    v_mfma_f32_16x16x32_bf16 v[84:87], v[52:55], a[28:31], v[84:87]
    s_waitcnt lgkmcnt(4)
    v_mfma_f32_16x16x32_bf16 v[88:91], v[56:59], a[16:19], v[88:91]
    ds_read_b128 v[40:43], v2 offset:28672
    ds_read_b128 v[44:47], v2 offset:29696
    v_mfma_f32_16x16x32_bf16 v[88:91], v[60:63], a[24:27], v[88:91]
    v_mfma_f32_16x16x32_bf16 v[92:95], v[56:59], a[20:23], v[92:95]
    v_mfma_f32_16x16x32_bf16 v[92:95], v[60:63], a[28:31], v[92:95]
    buffer_load_dwordx4 a[88:91], v6, s[8:11], s29 offen offset:2048 sc1
    v_mfma_f32_16x16x32_bf16 v[96:99], v[64:67], a[16:19], v[96:99]
    ds_read_b128 v[48:51], v2 offset:30720
    ds_read_b128 v[52:55], v2 offset:31744
    v_mfma_f32_16x16x32_bf16 v[96:99], v[68:71], a[24:27], v[96:99]
    v_mfma_f32_16x16x32_bf16 v[100:103], v[64:67], a[20:23], v[100:103]
    v_mfma_f32_16x16x32_bf16 v[100:103], v[68:71], a[28:31], v[100:103]
    s_waitcnt lgkmcnt(4)
    v_mfma_f32_16x16x32_bf16 v[104:107], v[24:27], a[16:19], v[104:107]
    s_barrier
    ds_read_b128 v[56:59], v2 offset:32768
    ds_read_b128 v[60:63], v2 offset:33792
    v_mfma_f32_16x16x32_bf16 v[104:107], v[28:31], a[24:27], v[104:107]
    buffer_load_dwordx4 a[92:95], v6, s[8:11], s29 offen offset:3072 sc1
    v_mfma_f32_16x16x32_bf16 v[108:111], v[24:27], a[20:23], v[108:111]
    v_mfma_f32_16x16x32_bf16 v[108:111], v[28:31], a[28:31], v[108:111]
    v_mfma_f32_16x16x32_bf16 v[112:115], v[32:35], a[16:19], v[112:115]
    ds_read_b128 v[64:67], v2 offset:34816
    ds_read_b128 v[68:71], v2 offset:35840
    v_mfma_f32_16x16x32_bf16 v[112:115], v[36:39], a[24:27], v[112:115]
    v_mfma_f32_16x16x32_bf16 v[116:119], v[32:35], a[20:23], v[116:119]
    s_mov_b32 s29, 24576
    buffer_load_dwordx4 a[96:99], v6, s[8:11], s29 offen offset:0 sc1
    v_mfma_f32_16x16x32_bf16 v[116:119], v[36:39], a[28:31], v[116:119]
    s_waitcnt lgkmcnt(4)
    v_mfma_f32_16x16x32_bf16 v[120:123], v[40:43], a[16:19], v[120:123]
    ds_read_b128 v[24:27], v2 offset:36864
    ds_read_b128 v[28:31], v2 offset:37888
    v_mfma_f32_16x16x32_bf16 v[120:123], v[44:47], a[24:27], v[120:123]
    v_mfma_f32_16x16x32_bf16 v[124:127], v[40:43], a[20:23], v[124:127]
    v_mfma_f32_16x16x32_bf16 v[124:127], v[44:47], a[28:31], v[124:127]
    buffer_load_dwordx4 a[100:103], v6, s[8:11], s29 offen offset:1024 sc1
    v_mfma_f32_16x16x32_bf16 v[128:131], v[48:51], a[16:19], v[128:131]
    ds_read_b128 v[32:35], v2 offset:38912
    ds_read_b128 v[36:39], v2 offset:39936
    v_mfma_f32_16x16x32_bf16 v[128:131], v[52:55], a[24:27], v[128:131]
    v_mfma_f32_16x16x32_bf16 v[132:135], v[48:51], a[20:23], v[132:135]
    v_mfma_f32_16x16x32_bf16 v[132:135], v[52:55], a[28:31], v[132:135]
    s_waitcnt vmcnt(14)
    s_waitcnt lgkmcnt(4)
    v_mfma_f32_16x16x32_bf16 v[72:75], v[56:59], a[32:35], v[72:75]
    ds_read_b128 v[40:43], v2 offset:40960
    ds_read_b128 v[44:47], v2 offset:41984
    v_mfma_f32_16x16x32_bf16 v[72:75], v[60:63], a[40:43], v[72:75]
    buffer_load_dwordx4 a[104:107], v6, s[8:11], s29 offen offset:2048 sc1
    v_mfma_f32_16x16x32_bf16 v[76:79], v[56:59], a[36:39], v[76:79]
    v_mfma_f32_16x16x32_bf16 v[76:79], v[60:63], a[44:47], v[76:79]
    v_mfma_f32_16x16x32_bf16 v[80:83], v[64:67], a[32:35], v[80:83]
    ds_read_b128 v[48:51], v2 offset:43008
    ds_read_b128 v[52:55], v2 offset:44032
    v_mfma_f32_16x16x32_bf16 v[80:83], v[68:71], a[40:43], v[80:83]
    v_mfma_f32_16x16x32_bf16 v[84:87], v[64:67], a[36:39], v[84:87]
    buffer_load_dwordx4 a[108:111], v6, s[8:11], s29 offen offset:3072 sc1
    v_mfma_f32_16x16x32_bf16 v[84:87], v[68:71], a[44:47], v[84:87]
    s_waitcnt lgkmcnt(4)
    v_mfma_f32_16x16x32_bf16 v[88:91], v[24:27], a[32:35], v[88:91]
    ds_read_b128 v[56:59], v2 offset:45056
    ds_read_b128 v[60:63], v2 offset:46080
    v_mfma_f32_16x16x32_bf16 v[88:91], v[28:31], a[40:43], v[88:91]
    v_mfma_f32_16x16x32_bf16 v[92:95], v[24:27], a[36:39], v[92:95]
    v_mfma_f32_16x16x32_bf16 v[92:95], v[28:31], a[44:47], v[92:95]
    s_mov_b32 s29, 28672
    buffer_load_dwordx4 a[112:115], v6, s[8:11], s29 offen offset:0 sc1
    v_mfma_f32_16x16x32_bf16 v[96:99], v[32:35], a[32:35], v[96:99]
    ds_read_b128 v[64:67], v2 offset:47104
    ds_read_b128 v[68:71], v2 offset:48128
    v_mfma_f32_16x16x32_bf16 v[96:99], v[36:39], a[40:43], v[96:99]
    v_mfma_f32_16x16x32_bf16 v[100:103], v[32:35], a[36:39], v[100:103]
    v_mfma_f32_16x16x32_bf16 v[100:103], v[36:39], a[44:47], v[100:103]
    s_waitcnt lgkmcnt(4)
    v_mfma_f32_16x16x32_bf16 v[104:107], v[40:43], a[32:35], v[104:107]
    s_barrier
    ds_read_b128 v[24:27], v2 offset:49152
    ds_read_b128 v[28:31], v2 offset:50176
    v_mfma_f32_16x16x32_bf16 v[104:107], v[44:47], a[40:43], v[104:107]
    buffer_load_dwordx4 a[116:119], v6, s[8:11], s29 offen offset:1024 sc1
    v_mfma_f32_16x16x32_bf16 v[108:111], v[40:43], a[36:39], v[108:111]
    v_mfma_f32_16x16x32_bf16 v[108:111], v[44:47], a[44:47], v[108:111]
    v_mfma_f32_16x16x32_bf16 v[112:115], v[48:51], a[32:35], v[112:115]
    ds_read_b128 v[32:35], v2 offset:51200
    ds_read_b128 v[36:39], v2 offset:52224
    v_mfma_f32_16x16x32_bf16 v[112:115], v[52:55], a[40:43], v[112:115]
    v_mfma_f32_16x16x32_bf16 v[116:119], v[48:51], a[36:39], v[116:119]
    buffer_load_dwordx4 a[120:123], v6, s[8:11], s29 offen offset:2048 sc1
    v_mfma_f32_16x16x32_bf16 v[116:119], v[52:55], a[44:47], v[116:119]
    s_waitcnt lgkmcnt(4)
    v_mfma_f32_16x16x32_bf16 v[120:123], v[56:59], a[32:35], v[120:123]
    ds_read_b128 v[40:43], v2 offset:53248
    ds_read_b128 v[44:47], v2 offset:54272
    v_mfma_f32_16x16x32_bf16 v[120:123], v[60:63], a[40:43], v[120:123]
    v_mfma_f32_16x16x32_bf16 v[124:127], v[56:59], a[36:39], v[124:127]
    v_mfma_f32_16x16x32_bf16 v[124:127], v[60:63], a[44:47], v[124:127]
    buffer_load_dwordx4 a[124:127], v6, s[8:11], s29 offen offset:3072 sc1
    v_mfma_f32_16x16x32_bf16 v[128:131], v[64:67], a[32:35], v[128:131]
    ds_read_b128 v[48:51], v2 offset:55296
    ds_read_b128 v[52:55], v2 offset:56320
    v_mfma_f32_16x16x32_bf16 v[128:131], v[68:71], a[40:43], v[128:131]
    v_mfma_f32_16x16x32_bf16 v[132:135], v[64:67], a[36:39], v[132:135]
    v_mfma_f32_16x16x32_bf16 v[132:135], v[68:71], a[44:47], v[132:135]
    s_waitcnt vmcnt(16)
    s_waitcnt lgkmcnt(4)
    v_mfma_f32_16x16x32_bf16 v[72:75], v[24:27], a[48:51], v[72:75]
    ds_read_b128 v[56:59], v2 offset:57344
    ds_read_b128 v[60:63], v2 offset:58368
    v_mfma_f32_16x16x32_bf16 v[72:75], v[28:31], a[56:59], v[72:75]
    s_mov_b32 s29, 32768
    buffer_load_dwordx4 a[128:131], v6, s[8:11], s29 offen offset:0 sc1
    v_mfma_f32_16x16x32_bf16 v[76:79], v[24:27], a[52:55], v[76:79]
    v_readlane_b32 s23, v249, 0
    v_mfma_f32_16x16x32_bf16 v[76:79], v[28:31], a[60:63], v[76:79]
    s_nop 0
    v_mfma_f32_16x16x32_bf16 v[80:83], v[32:35], a[48:51], v[80:83]
    ds_read_b128 v[64:67], v2 offset:59392
    ds_read_b128 v[68:71], v2 offset:60416
    v_mfma_f32_16x16x32_bf16 v[80:83], v[36:39], a[56:59], v[80:83]
    s_nop 0
    v_mfma_f32_16x16x32_bf16 v[84:87], v[32:35], a[52:55], v[84:87]
    buffer_load_dwordx4 a[132:135], v6, s[8:11], s29 offen offset:1024 sc1
    v_mfma_f32_16x16x32_bf16 v[84:87], v[36:39], a[60:63], v[84:87]
    s_waitcnt lgkmcnt(4)
    v_mfma_f32_16x16x32_bf16 v[88:91], v[40:43], a[48:51], v[88:91]
    ds_read_b128 v[24:27], v2 offset:61440
    ds_read_b128 v[28:31], v2 offset:62464
    v_mfma_f32_16x16x32_bf16 v[88:91], v[44:47], a[56:59], v[88:91]
    v_add_u32 v251, k4_kernel_j105-k4_kernel_pc, v250
    v_min_u32 v251, k4_kernel_end-k4_kernel_pc, v251
    global_load_dword v252, v251, s[40:41]
    v_mfma_f32_16x16x32_bf16 v[92:95], v[40:43], a[52:55], v[92:95]
    buffer_store_dwordx4 a[144:147], v248, s[8:11], s23 offen sc1
    v_mfma_f32_16x16x32_bf16 v[92:95], v[44:47], a[60:63], v[92:95]
    buffer_load_dwordx4 a[136:139], v6, s[8:11], s29 offen offset:2048 sc1
    v_mfma_f32_16x16x32_bf16 v[96:99], v[48:51], a[48:51], v[96:99]
    ds_read_b128 v[32:35], v2 offset:63488
    ds_read_b128 v[36:39], v2 offset:64512
    v_mfma_f32_16x16x32_bf16 v[96:99], v[52:55], a[56:59], v[96:99]
    v_mfma_f32_16x16x32_bf16 v[100:103], v[48:51], a[52:55], v[100:103]
    v_mfma_f32_16x16x32_bf16 v[100:103], v[52:55], a[60:63], v[100:103]
    s_waitcnt lgkmcnt(4)
    v_mfma_f32_16x16x32_bf16 v[104:107], v[56:59], a[48:51], v[104:107]
    s_barrier
    ds_read_b128 v[40:43], v3 offset:0
    ds_read_b128 v[44:47], v3 offset:1024
    v_mfma_f32_16x16x32_bf16 v[104:107], v[60:63], a[56:59], v[104:107]
    buffer_load_dwordx4 a[140:143], v6, s[8:11], s29 offen offset:3072 sc1
    v_mfma_f32_16x16x32_bf16 v[108:111], v[56:59], a[52:55], v[108:111]
    s_add_u32 m0, s28, 114688
    s_mov_b32 s31, 114688
    v_mfma_f32_16x16x32_bf16 v[108:111], v[60:63], a[60:63], v[108:111]
    v_readlane_b32 s23, v249, 1
    v_mfma_f32_16x16x32_bf16 v[112:115], v[64:67], a[48:51], v[112:115]
    ds_read_b128 v[48:51], v3 offset:2048
    ds_read_b128 v[52:55], v3 offset:3072
    v_mfma_f32_16x16x32_bf16 v[112:115], v[68:71], a[56:59], v[112:115]
    s_nop 0
    v_mfma_f32_16x16x32_bf16 v[116:119], v[64:67], a[52:55], v[116:119]
    buffer_load_dwordx4 v5, s[8:11], s31 offen offset:0 lds
    v_mfma_f32_16x16x32_bf16 v[116:119], v[68:71], a[60:63], v[116:119]
    s_nop 0
    s_waitcnt lgkmcnt(4)
    v_mfma_f32_16x16x32_bf16 v[120:123], v[24:27], a[48:51], v[120:123]
    ds_read_b128 v[56:59], v3 offset:4096
    ds_read_b128 v[60:63], v3 offset:5120
    v_mfma_f32_16x16x32_bf16 v[120:123], v[28:31], a[56:59], v[120:123]
    buffer_store_dwordx4 a[148:151], v248, s[8:11], s23 offen sc1
    v_mfma_f32_16x16x32_bf16 v[124:127], v[24:27], a[52:55], v[124:127]
    v_mfma_f32_16x16x32_bf16 v[124:127], v[28:31], a[60:63], v[124:127]
    buffer_load_dwordx4 v5, s[8:11], s31 offen offset:1024 lds
    v_mfma_f32_16x16x32_bf16 v[128:131], v[32:35], a[48:51], v[128:131]
    ds_read_b128 v[64:67], v3 offset:6144
    ds_read_b128 v[68:71], v3 offset:7168
    v_mfma_f32_16x16x32_bf16 v[128:131], v[36:39], a[56:59], v[128:131]
    v_mfma_f32_16x16x32_bf16 v[132:135], v[32:35], a[52:55], v[132:135]
    v_mfma_f32_16x16x32_bf16 v[132:135], v[36:39], a[60:63], v[132:135]
    s_waitcnt vmcnt(21)
    s_waitcnt lgkmcnt(4)
    v_mfma_f32_16x16x32_bf16 v[72:75], v[40:43], a[64:67], v[72:75]
    ds_read_b128 v[24:27], v3 offset:8192
    ds_read_b128 v[28:31], v3 offset:9216
    v_mfma_f32_16x16x32_bf16 v[72:75], v[44:47], a[72:75], v[72:75]
    buffer_load_dwordx4 v5, s[8:11], s31 offen offset:2048 lds
    v_mfma_f32_16x16x32_bf16 v[76:79], v[40:43], a[68:71], v[76:79]
    v_readlane_b32 s23, v249, 2
    v_mfma_f32_16x16x32_bf16 v[76:79], v[44:47], a[76:79], v[76:79]
    s_nop 0
    v_mfma_f32_16x16x32_bf16 v[80:83], v[48:51], a[64:67], v[80:83]
    ds_read_b128 v[32:35], v3 offset:10240
    ds_read_b128 v[36:39], v3 offset:11264
    v_mfma_f32_16x16x32_bf16 v[80:83], v[52:55], a[72:75], v[80:83]
    s_nop 0
    v_mfma_f32_16x16x32_bf16 v[84:87], v[48:51], a[68:71], v[84:87]
    buffer_load_dwordx4 v5, s[8:11], s31 offen offset:3072 lds
    v_mfma_f32_16x16x32_bf16 v[84:87], v[52:55], a[76:79], v[84:87]
    s_add_u32 m0, s28, 131072
    s_waitcnt lgkmcnt(4)
    v_mfma_f32_16x16x32_bf16 v[88:91], v[56:59], a[64:67], v[88:91]
    ds_read_b128 v[40:43], v3 offset:12288
    ds_read_b128 v[44:47], v3 offset:13312
    v_mfma_f32_16x16x32_bf16 v[88:91], v[60:63], a[72:75], v[88:91]
    buffer_store_dwordx4 a[152:155], v248, s[8:11], s23 offen sc1
    v_mfma_f32_16x16x32_bf16 v[92:95], v[56:59], a[68:71], v[92:95]
    s_mov_b32 s31, 131072
    v_mfma_f32_16x16x32_bf16 v[92:95], v[60:63], a[76:79], v[92:95]
    buffer_load_dwordx4 v5, s[8:11], s31 offen offset:0 lds
    v_mfma_f32_16x16x32_bf16 v[96:99], v[64:67], a[64:67], v[96:99]
    ds_read_b128 v[48:51], v3 offset:14336
    ds_read_b128 v[52:55], v3 offset:15360
    v_mfma_f32_16x16x32_bf16 v[96:99], v[68:71], a[72:75], v[96:99]
    v_mfma_f32_16x16x32_bf16 v[100:103], v[64:67], a[68:71], v[100:103]
    v_mfma_f32_16x16x32_bf16 v[100:103], v[68:71], a[76:79], v[100:103]
    s_waitcnt lgkmcnt(4)
    v_mfma_f32_16x16x32_bf16 v[104:107], v[24:27], a[64:67], v[104:107]
    s_barrier
    ds_read_b128 v[56:59], v3 offset:16384
    ds_read_b128 v[60:63], v3 offset:17408
    v_mfma_f32_16x16x32_bf16 v[104:107], v[28:31], a[72:75], v[104:107]
    buffer_load_dwordx4 v5, s[8:11], s31 offen offset:1024 lds
    v_mfma_f32_16x16x32_bf16 v[108:111], v[24:27], a[68:71], v[108:111]
    v_readlane_b32 s23, v249, 3
    v_mfma_f32_16x16x32_bf16 v[108:111], v[28:31], a[76:79], v[108:111]
    s_nop 0
    v_mfma_f32_16x16x32_bf16 v[112:115], v[32:35], a[64:67], v[112:115]
    ds_read_b128 v[64:67], v3 offset:18432
    ds_read_b128 v[68:71], v3 offset:19456
    v_mfma_f32_16x16x32_bf16 v[112:115], v[36:39], a[72:75], v[112:115]
    s_nop 0
    v_mfma_f32_16x16x32_bf16 v[116:119], v[32:35], a[68:71], v[116:119]
    buffer_load_dwordx4 v5, s[8:11], s31 offen offset:2048 lds
    v_mfma_f32_16x16x32_bf16 v[116:119], v[36:39], a[76:79], v[116:119]
    s_waitcnt lgkmcnt(4)
    v_mfma_f32_16x16x32_bf16 v[120:123], v[40:43], a[64:67], v[120:123]
    ds_read_b128 v[24:27], v3 offset:20480
    ds_read_b128 v[28:31], v3 offset:21504
    v_mfma_f32_16x16x32_bf16 v[120:123], v[44:47], a[72:75], v[120:123]
    buffer_store_dwordx4 a[156:159], v248, s[8:11], s23 offen sc1
    v_mfma_f32_16x16x32_bf16 v[124:127], v[40:43], a[68:71], v[124:127]
    v_mfma_f32_16x16x32_bf16 v[124:127], v[44:47], a[76:79], v[124:127]
    buffer_load_dwordx4 v5, s[8:11], s31 offen offset:3072 lds
    v_mfma_f32_16x16x32_bf16 v[128:131], v[48:51], a[64:67], v[128:131]
    ds_read_b128 v[32:35], v3 offset:22528
    ds_read_b128 v[36:39], v3 offset:23552
    v_mfma_f32_16x16x32_bf16 v[128:131], v[52:55], a[72:75], v[128:131]
    v_mfma_f32_16x16x32_bf16 v[132:135], v[48:51], a[68:71], v[132:135]
    s_add_u32 m0, s28, 147456
    s_mov_b32 s31, 147456
    v_mfma_f32_16x16x32_bf16 v[132:135], v[52:55], a[76:79], v[132:135]
    s_waitcnt vmcnt(25)
    s_waitcnt lgkmcnt(4)
    v_mfma_f32_16x16x32_bf16 v[72:75], v[56:59], a[80:83], v[72:75]
    ds_read_b128 v[40:43], v3 offset:24576
    ds_read_b128 v[44:47], v3 offset:25600
    v_mfma_f32_16x16x32_bf16 v[72:75], v[60:63], a[88:91], v[72:75]
    buffer_load_dwordx4 v5, s[8:11], s31 offen offset:0 lds
    v_mfma_f32_16x16x32_bf16 v[76:79], v[56:59], a[84:87], v[76:79]
    v_readlane_b32 s23, v249, 4
    v_mfma_f32_16x16x32_bf16 v[76:79], v[60:63], a[92:95], v[76:79]
    s_nop 0
    v_mfma_f32_16x16x32_bf16 v[80:83], v[64:67], a[80:83], v[80:83]
    ds_read_b128 v[48:51], v3 offset:26624
    ds_read_b128 v[52:55], v3 offset:27648
    v_mfma_f32_16x16x32_bf16 v[80:83], v[68:71], a[88:91], v[80:83]
    s_nop 0
    v_mfma_f32_16x16x32_bf16 v[84:87], v[64:67], a[84:87], v[84:87]
    buffer_load_dwordx4 v5, s[8:11], s31 offen offset:1024 lds
    v_mfma_f32_16x16x32_bf16 v[84:87], v[68:71], a[92:95], v[84:87]
    s_waitcnt lgkmcnt(4)
    v_mfma_f32_16x16x32_bf16 v[88:91], v[24:27], a[80:83], v[88:91]
    ds_read_b128 v[56:59], v3 offset:28672
    ds_read_b128 v[60:63], v3 offset:29696
    v_mfma_f32_16x16x32_bf16 v[88:91], v[28:31], a[88:91], v[88:91]
    buffer_store_dwordx4 a[160:163], v248, s[8:11], s23 offen sc1
    v_mfma_f32_16x16x32_bf16 v[92:95], v[24:27], a[84:87], v[92:95]
    v_mfma_f32_16x16x32_bf16 v[92:95], v[28:31], a[92:95], v[92:95]
    buffer_load_dwordx4 v5, s[8:11], s31 offen offset:2048 lds
    v_mfma_f32_16x16x32_bf16 v[96:99], v[32:35], a[80:83], v[96:99]
    ds_read_b128 v[64:67], v3 offset:30720
    ds_read_b128 v[68:71], v3 offset:31744
    v_mfma_f32_16x16x32_bf16 v[96:99], v[36:39], a[88:91], v[96:99]
    v_mfma_f32_16x16x32_bf16 v[100:103], v[32:35], a[84:87], v[100:103]
    v_mfma_f32_16x16x32_bf16 v[100:103], v[36:39], a[92:95], v[100:103]
    s_waitcnt lgkmcnt(4)
    v_mfma_f32_16x16x32_bf16 v[104:107], v[40:43], a[80:83], v[104:107]
    s_barrier
    ds_read_b128 v[24:27], v3 offset:32768
    ds_read_b128 v[28:31], v3 offset:33792
    v_mfma_f32_16x16x32_bf16 v[104:107], v[44:47], a[88:91], v[104:107]
    buffer_load_dwordx4 v5, s[8:11], s31 offen offset:3072 lds
    v_mfma_f32_16x16x32_bf16 v[108:111], v[40:43], a[84:87], v[108:111]
    s_add_u32 m0, s28, 0
    s_mov_b32 s31, 163840
    v_mfma_f32_16x16x32_bf16 v[108:111], v[44:47], a[92:95], v[108:111]
    v_readlane_b32 s23, v249, 5
    v_mfma_f32_16x16x32_bf16 v[112:115], v[48:51], a[80:83], v[112:115]
    ds_read_b128 v[32:35], v3 offset:34816
    ds_read_b128 v[36:39], v3 offset:35840
    v_mfma_f32_16x16x32_bf16 v[112:115], v[52:55], a[88:91], v[112:115]
    s_nop 0
    v_mfma_f32_16x16x32_bf16 v[116:119], v[48:51], a[84:87], v[116:119]
    buffer_load_dwordx4 v5, s[8:11], s31 offen offset:0 lds
    v_mfma_f32_16x16x32_bf16 v[116:119], v[52:55], a[92:95], v[116:119]
    s_nop 0
    s_waitcnt lgkmcnt(4)
    v_mfma_f32_16x16x32_bf16 v[120:123], v[56:59], a[80:83], v[120:123]
    ds_read_b128 v[40:43], v3 offset:36864
    ds_read_b128 v[44:47], v3 offset:37888
    v_mfma_f32_16x16x32_bf16 v[120:123], v[60:63], a[88:91], v[120:123]
    buffer_store_dwordx4 a[164:167], v248, s[8:11], s23 offen sc1
    v_mfma_f32_16x16x32_bf16 v[124:127], v[56:59], a[84:87], v[124:127]
    v_mfma_f32_16x16x32_bf16 v[124:127], v[60:63], a[92:95], v[124:127]
    buffer_load_dwordx4 v5, s[8:11], s31 offen offset:1024 lds
    v_mfma_f32_16x16x32_bf16 v[128:131], v[64:67], a[80:83], v[128:131]
    ds_read_b128 v[48:51], v3 offset:38912
    ds_read_b128 v[52:55], v3 offset:39936
    v_mfma_f32_16x16x32_bf16 v[128:131], v[68:71], a[88:91], v[128:131]
    v_mfma_f32_16x16x32_bf16 v[132:135], v[64:67], a[84:87], v[132:135]
    v_mfma_f32_16x16x32_bf16 v[132:135], v[68:71], a[92:95], v[132:135]
    s_waitcnt vmcnt(29)
    s_waitcnt lgkmcnt(4)
    v_mfma_f32_16x16x32_bf16 v[72:75], v[24:27], a[96:99], v[72:75]
    ds_read_b128 v[56:59], v3 offset:40960
    ds_read_b128 v[60:63], v3 offset:41984
    v_mfma_f32_16x16x32_bf16 v[72:75], v[28:31], a[104:107], v[72:75]
    buffer_load_dwordx4 v5, s[8:11], s31 offen offset:2048 lds
    v_mfma_f32_16x16x32_bf16 v[76:79], v[24:27], a[100:103], v[76:79]
    v_readlane_b32 s23, v249, 6
    v_mfma_f32_16x16x32_bf16 v[76:79], v[28:31], a[108:111], v[76:79]
    s_nop 0
    v_mfma_f32_16x16x32_bf16 v[80:83], v[32:35], a[96:99], v[80:83]
    ds_read_b128 v[64:67], v3 offset:43008
    ds_read_b128 v[68:71], v3 offset:44032
    v_mfma_f32_16x16x32_bf16 v[80:83], v[36:39], a[104:107], v[80:83]
    s_nop 0
    v_mfma_f32_16x16x32_bf16 v[84:87], v[32:35], a[100:103], v[84:87]
    buffer_load_dwordx4 v5, s[8:11], s31 offen offset:3072 lds
    v_mfma_f32_16x16x32_bf16 v[84:87], v[36:39], a[108:111], v[84:87]
    s_add_u32 m0, s28, 16384
    s_waitcnt lgkmcnt(4)
    v_mfma_f32_16x16x32_bf16 v[88:91], v[40:43], a[96:99], v[88:91]
    ds_read_b128 v[24:27], v3 offset:45056
    ds_read_b128 v[28:31], v3 offset:46080
    v_mfma_f32_16x16x32_bf16 v[88:91], v[44:47], a[104:107], v[88:91]
    buffer_store_dwordx4 a[168:171], v248, s[8:11], s23 offen sc1
    v_mfma_f32_16x16x32_bf16 v[92:95], v[40:43], a[100:103], v[92:95]
    buffer_store_dwordx4 v[204:207], v254, s[8:11], s16 offen sc1
    v_mfma_f32_16x16x32_bf16 v[92:95], v[44:47], a[108:111], v[92:95]
    s_mov_b32 s31, 180224
    buffer_load_dwordx4 v5, s[8:11], s31 offen offset:0 lds
    v_mfma_f32_16x16x32_bf16 v[96:99], v[48:51], a[96:99], v[96:99]
    ds_read_b128 v[32:35], v3 offset:47104
    ds_read_b128 v[36:39], v3 offset:48128
    v_mfma_f32_16x16x32_bf16 v[96:99], v[52:55], a[104:107], v[96:99]
    v_mfma_f32_16x16x32_bf16 v[100:103], v[48:51], a[100:103], v[100:103]
    v_mfma_f32_16x16x32_bf16 v[100:103], v[52:55], a[108:111], v[100:103]
    s_waitcnt lgkmcnt(4)
    v_mfma_f32_16x16x32_bf16 v[104:107], v[56:59], a[96:99], v[104:107]
    s_waitcnt vmcnt(19)
    s_barrier
    ds_read_b128 v[40:43], v3 offset:49152
    ds_read_b128 v[44:47], v3 offset:50176
    v_mfma_f32_16x16x32_bf16 v[104:107], v[60:63], a[104:107], v[104:107]
    buffer_load_dwordx4 v5, s[8:11], s31 offen offset:1024 lds
    v_mfma_f32_16x16x32_bf16 v[108:111], v[56:59], a[100:103], v[108:111]
    v_readlane_b32 s23, v249, 7
    v_mfma_f32_16x16x32_bf16 v[108:111], v[60:63], a[108:111], v[108:111]
    s_nop 0
    v_mfma_f32_16x16x32_bf16 v[112:115], v[64:67], a[96:99], v[112:115]
    ds_read_b128 v[48:51], v3 offset:51200
    ds_read_b128 v[52:55], v3 offset:52224
    v_mfma_f32_16x16x32_bf16 v[112:115], v[68:71], a[104:107], v[112:115]
    s_nop 0
    v_mfma_f32_16x16x32_bf16 v[116:119], v[64:67], a[100:103], v[116:119]
    buffer_load_dwordx4 v5, s[8:11], s31 offen offset:2048 lds
    v_mfma_f32_16x16x32_bf16 v[116:119], v[68:71], a[108:111], v[116:119]
    s_waitcnt lgkmcnt(4)
    v_mfma_f32_16x16x32_bf16 v[120:123], v[24:27], a[96:99], v[120:123]
    ds_read_b128 v[56:59], v3 offset:53248
    ds_read_b128 v[60:63], v3 offset:54272
    v_mfma_f32_16x16x32_bf16 v[120:123], v[28:31], a[104:107], v[120:123]
    buffer_store_dwordx4 a[172:175], v248, s[8:11], s23 offen sc1
    v_mfma_f32_16x16x32_bf16 v[124:127], v[24:27], a[100:103], v[124:127]
    buffer_store_dwordx4 v[208:211], v254, s[8:11], s17 offen sc1
    v_mfma_f32_16x16x32_bf16 v[124:127], v[28:31], a[108:111], v[124:127]
    buffer_load_dwordx4 v5, s[8:11], s31 offen offset:3072 lds
    v_mfma_f32_16x16x32_bf16 v[128:131], v[32:35], a[96:99], v[128:131]
    ds_read_b128 v[64:67], v3 offset:55296
    ds_read_b128 v[68:71], v3 offset:56320
    v_mfma_f32_16x16x32_bf16 v[128:131], v[36:39], a[104:107], v[128:131]
    v_mfma_f32_16x16x32_bf16 v[132:135], v[32:35], a[100:103], v[132:135]
    s_add_u32 m0, s28, 32768
    s_mov_b32 s31, 196608
    v_mfma_f32_16x16x32_bf16 v[132:135], v[36:39], a[108:111], v[132:135]
    s_waitcnt lgkmcnt(4)
    v_mfma_f32_16x16x32_bf16 v[72:75], v[40:43], a[112:115], v[72:75]
    ds_read_b128 v[24:27], v3 offset:57344
    ds_read_b128 v[28:31], v3 offset:58368
    v_mfma_f32_16x16x32_bf16 v[72:75], v[44:47], a[120:123], v[72:75]
    buffer_load_dwordx4 v5, s[8:11], s31 offen offset:0 lds
    v_mfma_f32_16x16x32_bf16 v[76:79], v[40:43], a[116:119], v[76:79]
    v_readlane_b32 s23, v249, 8
    v_mfma_f32_16x16x32_bf16 v[76:79], v[44:47], a[124:127], v[76:79]
    s_nop 0
    v_mfma_f32_16x16x32_bf16 v[80:83], v[48:51], a[112:115], v[80:83]
    ds_read_b128 v[32:35], v3 offset:59392
    ds_read_b128 v[36:39], v3 offset:60416
    v_mfma_f32_16x16x32_bf16 v[80:83], v[52:55], a[120:123], v[80:83]
    s_nop 0
    v_mfma_f32_16x16x32_bf16 v[84:87], v[48:51], a[116:119], v[84:87]
    buffer_load_dwordx4 v5, s[8:11], s31 offen offset:1024 lds
    v_mfma_f32_16x16x32_bf16 v[84:87], v[52:55], a[124:127], v[84:87]
    s_waitcnt lgkmcnt(4)
    v_mfma_f32_16x16x32_bf16 v[88:91], v[56:59], a[112:115], v[88:91]
    ds_read_b128 v[40:43], v3 offset:61440
    ds_read_b128 v[44:47], v3 offset:62464
    v_mfma_f32_16x16x32_bf16 v[88:91], v[60:63], a[120:123], v[88:91]
    buffer_store_dwordx4 a[176:179], v248, s[8:11], s23 offen sc1
    v_mfma_f32_16x16x32_bf16 v[92:95], v[56:59], a[116:119], v[92:95]
    buffer_store_dwordx4 v[212:215], v254, s[8:11], s18 offen sc1
    v_mfma_f32_16x16x32_bf16 v[92:95], v[60:63], a[124:127], v[92:95]
    buffer_load_dwordx4 v5, s[8:11], s31 offen offset:2048 lds
    v_mfma_f32_16x16x32_bf16 v[96:99], v[64:67], a[112:115], v[96:99]
    ds_read_b128 v[48:51], v3 offset:63488
    ds_read_b128 v[52:55], v3 offset:64512
    v_mfma_f32_16x16x32_bf16 v[96:99], v[68:71], a[120:123], v[96:99]
    v_mfma_f32_16x16x32_bf16 v[100:103], v[64:67], a[116:119], v[100:103]
    v_mfma_f32_16x16x32_bf16 v[100:103], v[68:71], a[124:127], v[100:103]
    s_waitcnt lgkmcnt(4)
    v_mfma_f32_16x16x32_bf16 v[104:107], v[24:27], a[112:115], v[104:107]
    s_waitcnt vmcnt(23)
    s_barrier
    ds_read_b128 v[56:59], v4 offset:0
    ds_read_b128 v[60:63], v4 offset:1024
    v_mfma_f32_16x16x32_bf16 v[104:107], v[28:31], a[120:123], v[104:107]
    buffer_load_dwordx4 v5, s[8:11], s31 offen offset:3072 lds
    v_mfma_f32_16x16x32_bf16 v[108:111], v[24:27], a[116:119], v[108:111]
    s_add_u32 m0, s28, 49152
    s_mov_b32 s31, 212992
    v_mfma_f32_16x16x32_bf16 v[108:111], v[28:31], a[124:127], v[108:111]
    v_mfma_f32_16x16x32_bf16 v[112:115], v[32:35], a[112:115], v[112:115]
    ds_read_b128 v[64:67], v4 offset:2048
    ds_read_b128 v[68:71], v4 offset:3072
    v_mfma_f32_16x16x32_bf16 v[112:115], v[36:39], a[120:123], v[112:115]
    v_mfma_f32_16x16x32_bf16 v[116:119], v[32:35], a[116:119], v[116:119]
    buffer_load_dwordx4 v5, s[8:11], s31 offen offset:0 lds
    v_mfma_f32_16x16x32_bf16 v[116:119], v[36:39], a[124:127], v[116:119]
    s_waitcnt lgkmcnt(4)
    v_mfma_f32_16x16x32_bf16 v[120:123], v[40:43], a[112:115], v[120:123]
    ds_read_b128 v[24:27], v4 offset:4096
    ds_read_b128 v[28:31], v4 offset:5120
    v_mfma_f32_16x16x32_bf16 v[120:123], v[44:47], a[120:123], v[120:123]
    v_mfma_f32_16x16x32_bf16 v[124:127], v[40:43], a[116:119], v[124:127]
    v_mfma_f32_16x16x32_bf16 v[124:127], v[44:47], a[124:127], v[124:127]
    buffer_load_dwordx4 v5, s[8:11], s31 offen offset:1024 lds
    v_mfma_f32_16x16x32_bf16 v[128:131], v[48:51], a[112:115], v[128:131]
    ds_read_b128 v[32:35], v4 offset:6144
    ds_read_b128 v[36:39], v4 offset:7168
    v_mfma_f32_16x16x32_bf16 v[128:131], v[52:55], a[120:123], v[128:131]
    v_mfma_f32_16x16x32_bf16 v[132:135], v[48:51], a[116:119], v[132:135]
    v_mfma_f32_16x16x32_bf16 v[132:135], v[52:55], a[124:127], v[132:135]
    s_waitcnt lgkmcnt(4)
    v_mfma_f32_16x16x32_bf16 v[72:75], v[56:59], a[128:131], v[72:75]
    ds_read_b128 v[40:43], v4 offset:8192
    ds_read_b128 v[44:47], v4 offset:9216
    v_mfma_f32_16x16x32_bf16 v[72:75], v[60:63], a[136:139], v[72:75]
    buffer_load_dwordx4 v5, s[8:11], s31 offen offset:2048 lds
    v_mfma_f32_16x16x32_bf16 v[76:79], v[56:59], a[132:135], v[76:79]
    v_mfma_f32_16x16x32_bf16 v[76:79], v[60:63], a[140:143], v[76:79]
    v_mfma_f32_16x16x32_bf16 v[80:83], v[64:67], a[128:131], v[80:83]
    ds_read_b128 v[48:51], v4 offset:10240
    ds_read_b128 v[52:55], v4 offset:11264
    v_mfma_f32_16x16x32_bf16 v[80:83], v[68:71], a[136:139], v[80:83]
    v_mfma_f32_16x16x32_bf16 v[84:87], v[64:67], a[132:135], v[84:87]
    buffer_load_dwordx4 v5, s[8:11], s31 offen offset:3072 lds
    v_mfma_f32_16x16x32_bf16 v[84:87], v[68:71], a[140:143], v[84:87]
    s_add_u32 m0, s28, 65536
    s_waitcnt lgkmcnt(4)
    v_mfma_f32_16x16x32_bf16 v[88:91], v[24:27], a[128:131], v[88:91]
    ds_read_b128 v[56:59], v4 offset:12288
    ds_read_b128 v[60:63], v4 offset:13312
    v_mfma_f32_16x16x32_bf16 v[88:91], v[28:31], a[136:139], v[88:91]
    s_mov_b32 s31, 229376
    v_mfma_f32_16x16x32_bf16 v[92:95], v[24:27], a[132:135], v[92:95]
    v_mfma_f32_16x16x32_bf16 v[92:95], v[28:31], a[140:143], v[92:95]
    buffer_load_dwordx4 v5, s[8:11], s31 offen offset:0 lds
    v_mfma_f32_16x16x32_bf16 v[96:99], v[32:35], a[128:131], v[96:99]
    ds_read_b128 v[64:67], v4 offset:14336
    ds_read_b128 v[68:71], v4 offset:15360
    v_mfma_f32_16x16x32_bf16 v[96:99], v[36:39], a[136:139], v[96:99]
    v_mfma_f32_16x16x32_bf16 v[100:103], v[32:35], a[132:135], v[100:103]
    v_mfma_f32_16x16x32_bf16 v[100:103], v[36:39], a[140:143], v[100:103]
    s_waitcnt lgkmcnt(4)
    v_mfma_f32_16x16x32_bf16 v[104:107], v[40:43], a[128:131], v[104:107]
    s_waitcnt vmcnt(11)
    s_barrier
    ds_read_b128 v[24:27], v4 offset:16384
    ds_read_b128 v[28:31], v4 offset:17408
    v_mfma_f32_16x16x32_bf16 v[104:107], v[44:47], a[136:139], v[104:107]
    buffer_load_dwordx4 v5, s[8:11], s31 offen offset:1024 lds
    v_mfma_f32_16x16x32_bf16 v[108:111], v[40:43], a[132:135], v[108:111]
    v_mfma_f32_16x16x32_bf16 v[108:111], v[44:47], a[140:143], v[108:111]
    v_mfma_f32_16x16x32_bf16 v[112:115], v[48:51], a[128:131], v[112:115]
    ds_read_b128 v[32:35], v4 offset:18432
    ds_read_b128 v[36:39], v4 offset:19456
    v_mfma_f32_16x16x32_bf16 v[112:115], v[52:55], a[136:139], v[112:115]
    v_mfma_f32_16x16x32_bf16 v[116:119], v[48:51], a[132:135], v[116:119]
    buffer_load_dwordx4 v5, s[8:11], s31 offen offset:2048 lds
    v_mfma_f32_16x16x32_bf16 v[116:119], v[52:55], a[140:143], v[116:119]
    s_waitcnt lgkmcnt(4)
    v_mfma_f32_16x16x32_bf16 v[120:123], v[56:59], a[128:131], v[120:123]
    ds_read_b128 v[40:43], v4 offset:20480
    ds_read_b128 v[44:47], v4 offset:21504
    v_mfma_f32_16x16x32_bf16 v[120:123], v[60:63], a[136:139], v[120:123]
    v_mfma_f32_16x16x32_bf16 v[124:127], v[56:59], a[132:135], v[124:127]
    v_mfma_f32_16x16x32_bf16 v[124:127], v[60:63], a[140:143], v[124:127]
    buffer_load_dwordx4 v5, s[8:11], s31 offen offset:3072 lds
    v_mfma_f32_16x16x32_bf16 v[128:131], v[64:67], a[128:131], v[128:131]
    ds_read_b128 v[48:51], v4 offset:22528
    ds_read_b128 v[52:55], v4 offset:23552
    v_mfma_f32_16x16x32_bf16 v[128:131], v[68:71], a[136:139], v[128:131]
    v_exp_f32 v72, v72
    v_mfma_f32_16x16x32_bf16 v[132:135], v[64:67], a[132:135], v[132:135]
    v_exp_f32 v73, v73
    v_mfma_f32_16x16x32_bf16 v[132:135], v[68:71], a[140:143], v[132:135]
    v_exp_f32 v74, v74
    s_waitcnt lgkmcnt(4)
    v_mfma_f32_16x16x32_bf16 v[216:219], v[24:27], a[0:3], 0
    ds_read_b128 v[56:59], v4 offset:24576
    v_exp_f32 v75, v75
    v_mfma_f32_16x16x32_bf16 v[216:219], v[28:31], a[8:11], v[216:219]
    v_exp_f32 v80, v80
    v_mfma_f32_16x16x32_bf16 v[220:223], v[24:27], a[4:7], 0
    ds_read_b128 v[60:63], v4 offset:25600
    v_exp_f32 v81, v81
    v_mfma_f32_16x16x32_bf16 v[220:223], v[28:31], a[12:15], v[220:223]
    s_add_u32 m0, s28, 81920
    s_mov_b32 s31, 245760
    buffer_load_dwordx4 v5, s[8:11], s31 offen offset:0 lds
    v_mfma_f32_16x16x32_bf16 v[224:227], v[32:35], a[0:3], 0
    ds_read_b128 v[64:67], v4 offset:26624
    v_exp_f32 v82, v82
    v_mfma_f32_16x16x32_bf16 v[224:227], v[36:39], a[8:11], v[224:227]
    v_exp_f32 v83, v83
    v_mfma_f32_16x16x32_bf16 v[228:231], v[32:35], a[4:7], 0
    ds_read_b128 v[68:71], v4 offset:27648
    v_fma_f32 v72, v72, s30, s30
    v_mfma_f32_16x16x32_bf16 v[228:231], v[36:39], a[12:15], v[228:231]
    v_fma_f32 v73, v73, s30, s30
    s_waitcnt lgkmcnt(4)
    v_mfma_f32_16x16x32_bf16 v[232:235], v[40:43], a[0:3], 0
    ds_read_b128 v[24:27], v4 offset:28672
    v_fma_f32 v74, v74, s30, s30
    v_mfma_f32_16x16x32_bf16 v[232:235], v[44:47], a[8:11], v[232:235]
    v_rcp_f32 v72, v72
    v_mfma_f32_16x16x32_bf16 v[236:239], v[40:43], a[4:7], 0
    ds_read_b128 v[28:31], v4 offset:29696
    v_fma_f32 v75, v75, s30, s30
    v_mfma_f32_16x16x32_bf16 v[236:239], v[44:47], a[12:15], v[236:239]
    buffer_load_dwordx4 v5, s[8:11], s31 offen offset:1024 lds
    v_mfma_f32_16x16x32_bf16 v[240:243], v[48:51], a[0:3], 0
    ds_read_b128 v[32:35], v4 offset:30720
    v_mul_f32 v72, v72, v88
    v_mfma_f32_16x16x32_bf16 v[240:243], v[52:55], a[8:11], v[240:243]
    v_rcp_f32 v73, v73
    v_mfma_f32_16x16x32_bf16 v[244:247], v[48:51], a[4:7], 0
    ds_read_b128 v[36:39], v4 offset:31744
    v_fma_f32 v80, v80, s30, s30
    v_mfma_f32_16x16x32_bf16 v[244:247], v[52:55], a[12:15], v[244:247]
    v_mul_f32 v73, v73, v89
    s_waitcnt lgkmcnt(4)
    v_mfma_f32_16x16x32_bf16 v[216:219], v[56:59], a[16:19], v[216:219]
    ds_read_b128 v[40:43], v2 offset:0
    v_cvt_pk_bf16_f32 v144, v72, v73
    v_mfma_f32_16x16x32_bf16 v[216:219], v[60:63], a[24:27], v[216:219]
    v_rcp_f32 v74, v74
    v_mfma_f32_16x16x32_bf16 v[220:223], v[56:59], a[20:23], v[220:223]
    ds_read_b128 v[44:47], v2 offset:1024
    v_fma_f32 v81, v81, s30, s30
    v_mfma_f32_16x16x32_bf16 v[220:223], v[60:63], a[28:31], v[220:223]
    buffer_load_dwordx4 v5, s[8:11], s31 offen offset:2048 lds
    v_mfma_f32_16x16x32_bf16 v[224:227], v[64:67], a[16:19], v[224:227]
    ds_read_b128 v[48:51], v2 offset:2048
    v_mul_f32 v74, v74, v90
    v_mfma_f32_16x16x32_bf16 v[224:227], v[68:71], a[24:27], v[224:227]
    v_rcp_f32 v75, v75
    v_mfma_f32_16x16x32_bf16 v[228:231], v[64:67], a[20:23], v[228:231]
    ds_read_b128 v[52:55], v2 offset:3072
    v_fma_f32 v82, v82, s30, s30
    v_mfma_f32_16x16x32_bf16 v[228:231], v[68:71], a[28:31], v[228:231]
    v_mul_f32 v75, v75, v91
    s_waitcnt lgkmcnt(4)
    v_mfma_f32_16x16x32_bf16 v[232:235], v[24:27], a[16:19], v[232:235]
    ds_read_b128 v[56:59], v2 offset:4096
    v_cvt_pk_bf16_f32 v145, v74, v75
    v_mfma_f32_16x16x32_bf16 v[232:235], v[28:31], a[24:27], v[232:235]
    v_rcp_f32 v80, v80
    v_mfma_f32_16x16x32_bf16 v[236:239], v[24:27], a[20:23], v[236:239]
    ds_read_b128 v[60:63], v2 offset:5120
    v_fma_f32 v83, v83, s30, s30
    v_mfma_f32_16x16x32_bf16 v[236:239], v[28:31], a[28:31], v[236:239]
    buffer_load_dwordx4 v5, s[8:11], s31 offen offset:3072 lds
    v_mfma_f32_16x16x32_bf16 v[240:243], v[32:35], a[16:19], v[240:243]
    ds_read_b128 v[64:67], v2 offset:6144
    v_mul_f32 v80, v80, v96
    v_mfma_f32_16x16x32_bf16 v[240:243], v[36:39], a[24:27], v[240:243]
    v_rcp_f32 v81, v81
    v_mfma_f32_16x16x32_bf16 v[244:247], v[32:35], a[20:23], v[244:247]
    ds_read_b128 v[68:71], v2 offset:7168
    v_rcp_f32 v82, v82
    v_mfma_f32_16x16x32_bf16 v[244:247], v[36:39], a[28:31], v[244:247]
    s_add_u32 m0, s28, 98304
    s_waitcnt lgkmcnt(4)
    v_mfma_f32_16x16x32_bf16 v[216:219], v[40:43], a[32:35], v[216:219]
    ds_read_b128 v[24:27], v2 offset:8192
    s_mov_b32 s31, 262144
    v_mfma_f32_16x16x32_bf16 v[216:219], v[44:47], a[40:43], v[216:219]
    v_rcp_f32 v83, v83
    v_mfma_f32_16x16x32_bf16 v[220:223], v[40:43], a[36:39], v[220:223]
    ds_read_b128 v[28:31], v2 offset:9216
    v_mul_f32 v81, v81, v97
    v_mfma_f32_16x16x32_bf16 v[220:223], v[44:47], a[44:47], v[220:223]
    buffer_load_dwordx4 v5, s[8:11], s31 offen offset:0 lds
    v_mfma_f32_16x16x32_bf16 v[224:227], v[48:51], a[32:35], v[224:227]
    ds_read_b128 v[32:35], v2 offset:10240
    v_mul_f32 v82, v82, v98
    v_mfma_f32_16x16x32_bf16 v[224:227], v[52:55], a[40:43], v[224:227]
    v_exp_f32 v76, v76
    v_mfma_f32_16x16x32_bf16 v[228:231], v[48:51], a[36:39], v[228:231]
    ds_read_b128 v[36:39], v2 offset:11264
    v_mul_f32 v83, v83, v99
    v_mfma_f32_16x16x32_bf16 v[228:231], v[52:55], a[44:47], v[228:231]
    v_cvt_pk_bf16_f32 v146, v80, v81
    s_waitcnt lgkmcnt(4)
    v_mfma_f32_16x16x32_bf16 v[232:235], v[56:59], a[32:35], v[232:235]
    ds_read_b128 v[40:43], v2 offset:12288
    v_cvt_pk_bf16_f32 v147, v82, v83
    v_mfma_f32_16x16x32_bf16 v[232:235], v[60:63], a[40:43], v[232:235]
    v_exp_f32 v77, v77
    v_mfma_f32_16x16x32_bf16 v[236:239], v[56:59], a[36:39], v[236:239]
    ds_read_b128 v[44:47], v2 offset:13312
    s_mov_b32 s29, 0
    v_mfma_f32_16x16x32_bf16 v[236:239], v[60:63], a[44:47], v[236:239]
    buffer_load_dwordx4 v5, s[8:11], s31 offen offset:1024 lds
    v_mfma_f32_16x16x32_bf16 v[240:243], v[64:67], a[32:35], v[240:243]
    ds_read_b128 v[48:51], v2 offset:14336
    v_fma_f32 v76, v76, s30, s30
    v_mfma_f32_16x16x32_bf16 v[240:243], v[68:71], a[40:43], v[240:243]
    buffer_store_dwordx4 v[144:147], v8, s[8:11], s29 offen offset:0 sc1
    v_mfma_f32_16x16x32_bf16 v[244:247], v[64:67], a[36:39], v[244:247]
    ds_read_b128 v[52:55], v2 offset:15360
    v_fma_f32 v77, v77, s30, s30
    v_mfma_f32_16x16x32_bf16 v[244:247], v[68:71], a[44:47], v[244:247]
    v_rcp_f32 v76, v76
    s_waitcnt lgkmcnt(4)
    v_mfma_f32_16x16x32_bf16 v[216:219], v[24:27], a[48:51], v[216:219]
    ds_read_b128 v[56:59], v2 offset:16384
    v_mfma_f32_16x16x32_bf16 v[216:219], v[28:31], a[56:59], v[216:219]
    v_rcp_f32 v77, v77
    v_mfma_f32_16x16x32_bf16 v[220:223], v[24:27], a[52:55], v[220:223]
    ds_read_b128 v[60:63], v2 offset:17408
    v_mul_f32 v76, v76, v92
    v_mfma_f32_16x16x32_bf16 v[220:223], v[28:31], a[60:63], v[220:223]
    buffer_load_dwordx4 v5, s[8:11], s31 offen offset:2048 lds
    v_mfma_f32_16x16x32_bf16 v[224:227], v[32:35], a[48:51], v[224:227]
    ds_read_b128 v[64:67], v2 offset:18432
    v_mul_f32 v77, v77, v93
    v_mfma_f32_16x16x32_bf16 v[224:227], v[36:39], a[56:59], v[224:227]
    v_exp_f32 v78, v78
    v_mfma_f32_16x16x32_bf16 v[228:231], v[32:35], a[52:55], v[228:231]
    ds_read_b128 v[68:71], v2 offset:19456
    v_cvt_pk_bf16_f32 v148, v76, v77
    v_mfma_f32_16x16x32_bf16 v[228:231], v[36:39], a[60:63], v[228:231]
    v_fma_f32 v78, v78, s30, s30
    s_waitcnt lgkmcnt(4)
    v_mfma_f32_16x16x32_bf16 v[232:235], v[40:43], a[48:51], v[232:235]
    ds_read_b128 v[24:27], v2 offset:20480
    v_mfma_f32_16x16x32_bf16 v[232:235], v[44:47], a[56:59], v[232:235]
    v_rcp_f32 v78, v78
    v_mfma_f32_16x16x32_bf16 v[236:239], v[40:43], a[52:55], v[236:239]
    ds_read_b128 v[28:31], v2 offset:21504
    v_mfma_f32_16x16x32_bf16 v[236:239], v[44:47], a[60:63], v[236:239]
    buffer_load_dwordx4 v5, s[8:11], s31 offen offset:3072 lds
    v_mfma_f32_16x16x32_bf16 v[240:243], v[48:51], a[48:51], v[240:243]
    ds_read_b128 v[32:35], v2 offset:22528
    v_mul_f32 v78, v78, v94
    v_mfma_f32_16x16x32_bf16 v[240:243], v[52:55], a[56:59], v[240:243]
    v_exp_f32 v79, v79
    v_mfma_f32_16x16x32_bf16 v[244:247], v[48:51], a[52:55], v[244:247]
    ds_read_b128 v[36:39], v2 offset:23552
    s_add_u32 m0, s28, 114688
    v_mfma_f32_16x16x32_bf16 v[244:247], v[52:55], a[60:63], v[244:247]
    s_mov_b32 s31, 278528
    s_waitcnt lgkmcnt(4)
    v_mfma_f32_16x16x32_bf16 v[216:219], v[56:59], a[64:67], v[216:219]
    ds_read_b128 v[40:43], v2 offset:24576
    v_fma_f32 v79, v79, s30, s30
    v_mfma_f32_16x16x32_bf16 v[216:219], v[60:63], a[72:75], v[216:219]
    v_rcp_f32 v79, v79
    v_mfma_f32_16x16x32_bf16 v[220:223], v[56:59], a[68:71], v[220:223]
    ds_read_b128 v[44:47], v2 offset:25600
    v_mfma_f32_16x16x32_bf16 v[220:223], v[60:63], a[76:79], v[220:223]
    buffer_load_dwordx4 v5, s[8:11], s31 offen offset:0 lds
    v_mfma_f32_16x16x32_bf16 v[224:227], v[64:67], a[64:67], v[224:227]
    ds_read_b128 v[48:51], v2 offset:26624
    v_mul_f32 v79, v79, v95
    v_mfma_f32_16x16x32_bf16 v[224:227], v[68:71], a[72:75], v[224:227]
    v_exp_f32 v84, v84
    v_mfma_f32_16x16x32_bf16 v[228:231], v[64:67], a[68:71], v[228:231]
    ds_read_b128 v[52:55], v2 offset:27648
    v_cvt_pk_bf16_f32 v149, v78, v79
    v_mfma_f32_16x16x32_bf16 v[228:231], v[68:71], a[76:79], v[228:231]
    v_fma_f32 v84, v84, s30, s30
    s_waitcnt lgkmcnt(4)
    v_mfma_f32_16x16x32_bf16 v[232:235], v[24:27], a[64:67], v[232:235]
    ds_read_b128 v[56:59], v2 offset:28672
    v_mfma_f32_16x16x32_bf16 v[232:235], v[28:31], a[72:75], v[232:235]
    v_rcp_f32 v84, v84
    v_mfma_f32_16x16x32_bf16 v[236:239], v[24:27], a[68:71], v[236:239]
    ds_read_b128 v[60:63], v2 offset:29696
    v_mfma_f32_16x16x32_bf16 v[236:239], v[28:31], a[76:79], v[236:239]
    buffer_load_dwordx4 v5, s[8:11], s31 offen offset:1024 lds
    v_mfma_f32_16x16x32_bf16 v[240:243], v[32:35], a[64:67], v[240:243]
    ds_read_b128 v[64:67], v2 offset:30720
    v_mul_f32 v84, v84, v100
    v_mfma_f32_16x16x32_bf16 v[240:243], v[36:39], a[72:75], v[240:243]
    v_exp_f32 v85, v85
    v_mfma_f32_16x16x32_bf16 v[244:247], v[32:35], a[68:71], v[244:247]
    ds_read_b128 v[68:71], v2 offset:31744
    v_mfma_f32_16x16x32_bf16 v[244:247], v[36:39], a[76:79], v[244:247]
    v_fma_f32 v85, v85, s30, s30
    s_waitcnt lgkmcnt(4)
    v_mfma_f32_16x16x32_bf16 v[216:219], v[40:43], a[80:83], v[216:219]
    s_waitcnt vmcnt(11)
    s_barrier
    buffer_store_dword v253, off, s[8:11], s33 sc1
    buffer_store_dword v13, off, s[8:11], s35 sc1
    ds_read_b128 v[24:27], v2 offset:32768
    v_mfma_f32_16x16x32_bf16 v[216:219], v[44:47], a[88:91], v[216:219]
    v_rcp_f32 v85, v85
    v_mfma_f32_16x16x32_bf16 v[220:223], v[40:43], a[84:87], v[220:223]
    ds_read_b128 v[28:31], v2 offset:33792
    v_mfma_f32_16x16x32_bf16 v[220:223], v[44:47], a[92:95], v[220:223]
    buffer_load_dwordx4 v5, s[8:11], s31 offen offset:2048 lds
    v_mfma_f32_16x16x32_bf16 v[224:227], v[48:51], a[80:83], v[224:227]
    ds_read_b128 v[32:35], v2 offset:34816
    v_mul_f32 v85, v85, v101
    v_mfma_f32_16x16x32_bf16 v[224:227], v[52:55], a[88:91], v[224:227]
    v_exp_f32 v86, v86
    v_mfma_f32_16x16x32_bf16 v[228:231], v[48:51], a[84:87], v[228:231]
    ds_read_b128 v[36:39], v2 offset:35840
    v_cvt_pk_bf16_f32 v150, v84, v85
    v_mfma_f32_16x16x32_bf16 v[228:231], v[52:55], a[92:95], v[228:231]
    v_fma_f32 v86, v86, s30, s30
    s_waitcnt lgkmcnt(4)
    v_mfma_f32_16x16x32_bf16 v[232:235], v[56:59], a[80:83], v[232:235]
    ds_read_b128 v[40:43], v2 offset:36864
    v_mfma_f32_16x16x32_bf16 v[232:235], v[60:63], a[88:91], v[232:235]
    v_rcp_f32 v86, v86
    v_mfma_f32_16x16x32_bf16 v[236:239], v[56:59], a[84:87], v[236:239]
    ds_read_b128 v[44:47], v2 offset:37888
    v_mfma_f32_16x16x32_bf16 v[236:239], v[60:63], a[92:95], v[236:239]
    buffer_load_dwordx4 v5, s[8:11], s31 offen offset:3072 lds
    v_mfma_f32_16x16x32_bf16 v[240:243], v[64:67], a[80:83], v[240:243]
    ds_read_b128 v[48:51], v2 offset:38912
    v_mul_f32 v86, v86, v102
    v_mfma_f32_16x16x32_bf16 v[240:243], v[68:71], a[88:91], v[240:243]
    v_exp_f32 v87, v87
    v_mfma_f32_16x16x32_bf16 v[244:247], v[64:67], a[84:87], v[244:247]
    ds_read_b128 v[52:55], v2 offset:39936
    s_add_u32 m0, s28, 131072
    v_mfma_f32_16x16x32_bf16 v[244:247], v[68:71], a[92:95], v[244:247]
    s_mov_b32 s31, 294912
    s_waitcnt lgkmcnt(4)
    v_mfma_f32_16x16x32_bf16 v[216:219], v[24:27], a[96:99], v[216:219]
    ds_read_b128 v[56:59], v2 offset:40960
    v_fma_f32 v87, v87, s30, s30
    v_mfma_f32_16x16x32_bf16 v[216:219], v[28:31], a[104:107], v[216:219]
    v_rcp_f32 v87, v87
    v_mfma_f32_16x16x32_bf16 v[220:223], v[24:27], a[100:103], v[220:223]
    ds_read_b128 v[60:63], v2 offset:41984
    v_mfma_f32_16x16x32_bf16 v[220:223], v[28:31], a[108:111], v[220:223]
    buffer_load_dwordx4 v5, s[8:11], s31 offen offset:0 lds
    v_mfma_f32_16x16x32_bf16 v[224:227], v[32:35], a[96:99], v[224:227]
    ds_read_b128 v[64:67], v2 offset:43008
    v_mul_f32 v87, v87, v103
    v_mfma_f32_16x16x32_bf16 v[224:227], v[36:39], a[104:107], v[224:227]
    v_exp_f32 v104, v104
    v_mfma_f32_16x16x32_bf16 v[228:231], v[32:35], a[100:103], v[228:231]
    ds_read_b128 v[68:71], v2 offset:44032
    v_cvt_pk_bf16_f32 v151, v86, v87
    v_mfma_f32_16x16x32_bf16 v[228:231], v[36:39], a[108:111], v[228:231]
    s_mov_b32 s29, 0
    s_waitcnt lgkmcnt(4)
    v_mfma_f32_16x16x32_bf16 v[232:235], v[40:43], a[96:99], v[232:235]
    ds_read_b128 v[24:27], v2 offset:45056
    v_fma_f32 v104, v104, s30, s30
    v_mfma_f32_16x16x32_bf16 v[232:235], v[44:47], a[104:107], v[232:235]
    buffer_store_dwordx4 v[148:151], v8, s[8:11], s29 offen offset:1024 sc1
    v_mfma_f32_16x16x32_bf16 v[236:239], v[40:43], a[100:103], v[236:239]
    ds_read_b128 v[28:31], v2 offset:46080
    v_rcp_f32 v104, v104
    v_mfma_f32_16x16x32_bf16 v[236:239], v[44:47], a[108:111], v[236:239]
    buffer_load_dwordx4 v5, s[8:11], s31 offen offset:1024 lds
    v_mfma_f32_16x16x32_bf16 v[240:243], v[48:51], a[96:99], v[240:243]
    ds_read_b128 v[32:35], v2 offset:47104
    v_exp_f32 v105, v105
    v_mfma_f32_16x16x32_bf16 v[240:243], v[52:55], a[104:107], v[240:243]
    v_exp_f32 v106, v106
    v_mfma_f32_16x16x32_bf16 v[244:247], v[48:51], a[100:103], v[244:247]
    ds_read_b128 v[36:39], v2 offset:48128
    v_mul_f32 v104, v104, v120
    v_mfma_f32_16x16x32_bf16 v[244:247], v[52:55], a[108:111], v[244:247]
    v_fma_f32 v105, v105, s30, s30
    s_waitcnt lgkmcnt(4)
    v_mfma_f32_16x16x32_bf16 v[216:219], v[56:59], a[112:115], v[216:219]
    ds_read_b128 v[40:43], v2 offset:49152
    v_fma_f32 v106, v106, s30, s30
    v_mfma_f32_16x16x32_bf16 v[216:219], v[60:63], a[120:123], v[216:219]
    v_rcp_f32 v105, v105
    v_mfma_f32_16x16x32_bf16 v[220:223], v[56:59], a[116:119], v[220:223]
    ds_read_b128 v[44:47], v2 offset:50176
    v_rcp_f32 v106, v106
    v_mfma_f32_16x16x32_bf16 v[220:223], v[60:63], a[124:127], v[220:223]
    buffer_load_dwordx4 v5, s[8:11], s31 offen offset:2048 lds
    v_mfma_f32_16x16x32_bf16 v[224:227], v[64:67], a[112:115], v[224:227]
    ds_read_b128 v[48:51], v2 offset:51200
    v_mul_f32 v105, v105, v121
k4_kernel_j105:
    v_mfma_f32_16x16x32_bf16 v[224:227], v[68:71], a[120:123], v[224:227]
    v_exp_f32 v107, v107
    v_mfma_f32_16x16x32_bf16 v[228:231], v[64:67], a[116:119], v[228:231]
    ds_read_b128 v[52:55], v2 offset:52224
    v_mul_f32 v106, v106, v122
    v_mfma_f32_16x16x32_bf16 v[228:231], v[68:71], a[124:127], v[228:231]
    v_fma_f32 v107, v107, s30, s30
    s_waitcnt lgkmcnt(4)
    v_mfma_f32_16x16x32_bf16 v[232:235], v[24:27], a[112:115], v[232:235]
    ds_read_b128 v[56:59], v2 offset:53248
    v_cvt_pk_bf16_f32 v152, v104, v105
    v_mfma_f32_16x16x32_bf16 v[232:235], v[28:31], a[120:123], v[232:235]
    v_rcp_f32 v107, v107
    v_mfma_f32_16x16x32_bf16 v[236:239], v[24:27], a[116:119], v[236:239]
    ds_read_b128 v[60:63], v2 offset:54272
    v_exp_f32 v112, v112
    v_mfma_f32_16x16x32_bf16 v[236:239], v[28:31], a[124:127], v[236:239]
    buffer_load_dwordx4 v5, s[8:11], s31 offen offset:3072 lds
    v_mfma_f32_16x16x32_bf16 v[240:243], v[32:35], a[112:115], v[240:243]
    ds_read_b128 v[64:67], v2 offset:55296
    v_mul_f32 v107, v107, v123
    v_mfma_f32_16x16x32_bf16 v[240:243], v[36:39], a[120:123], v[240:243]
    v_exp_f32 v113, v113
    v_mfma_f32_16x16x32_bf16 v[244:247], v[32:35], a[116:119], v[244:247]
    ds_read_b128 v[68:71], v2 offset:56320
    s_add_u32 m0, s28, 147456
    v_mfma_f32_16x16x32_bf16 v[244:247], v[36:39], a[124:127], v[244:247]
    s_mov_b32 s31, 311296
    s_waitcnt lgkmcnt(4)
    v_mfma_f32_16x16x32_bf16 v[216:219], v[40:43], a[128:131], v[216:219]
    ds_read_b128 v[24:27], v2 offset:57344
    v_cvt_pk_bf16_f32 v153, v106, v107
    v_mfma_f32_16x16x32_bf16 v[216:219], v[44:47], a[136:139], v[216:219]
    v_exp_f32 v114, v114
    v_mfma_f32_16x16x32_bf16 v[220:223], v[40:43], a[132:135], v[220:223]
    ds_read_b128 v[28:31], v2 offset:58368
    v_fma_f32 v112, v112, s30, s30
    v_mfma_f32_16x16x32_bf16 v[220:223], v[44:47], a[140:143], v[220:223]
    buffer_load_dwordx4 v5, s[8:11], s31 offen offset:0 lds
    v_mfma_f32_16x16x32_bf16 v[224:227], v[48:51], a[128:131], v[224:227]
    ds_read_b128 v[32:35], v2 offset:59392
    v_fma_f32 v113, v113, s30, s30
    v_mfma_f32_16x16x32_bf16 v[224:227], v[52:55], a[136:139], v[224:227]
    v_rcp_f32 v112, v112
    v_mfma_f32_16x16x32_bf16 v[228:231], v[48:51], a[132:135], v[228:231]
    ds_read_b128 v[36:39], v2 offset:60416
    v_fma_f32 v114, v114, s30, s30
    v_mfma_f32_16x16x32_bf16 v[228:231], v[52:55], a[140:143], v[228:231]
    v_mul_f32 v112, v112, v128
    s_waitcnt lgkmcnt(4)
    v_mfma_f32_16x16x32_bf16 v[232:235], v[56:59], a[128:131], v[232:235]
    ds_read_b128 v[40:43], v2 offset:61440
    v_mfma_f32_16x16x32_bf16 v[232:235], v[60:63], a[136:139], v[232:235]
    v_rcp_f32 v113, v113
    v_mfma_f32_16x16x32_bf16 v[236:239], v[56:59], a[132:135], v[236:239]
    ds_read_b128 v[44:47], v2 offset:62464
    v_mfma_f32_16x16x32_bf16 v[236:239], v[60:63], a[140:143], v[236:239]
    buffer_load_dwordx4 v5, s[8:11], s31 offen offset:1024 lds
    v_mfma_f32_16x16x32_bf16 v[240:243], v[64:67], a[128:131], v[240:243]
    ds_read_b128 v[48:51], v2 offset:63488
    v_mul_f32 v113, v113, v129
    v_mfma_f32_16x16x32_bf16 v[240:243], v[68:71], a[136:139], v[240:243]
    v_rcp_f32 v114, v114
    v_mfma_f32_16x16x32_bf16 v[244:247], v[64:67], a[132:135], v[244:247]
    ds_read_b128 v[52:55], v2 offset:64512
    v_cvt_pk_bf16_f32 v154, v112, v113
    v_mfma_f32_16x16x32_bf16 v[244:247], v[68:71], a[140:143], v[244:247]
    v_mul_f32 v114, v114, v130
    s_waitcnt lgkmcnt(4)
    v_mfma_f32_16x16x32_bf16 v[72:75], v[24:27], a[0:3], 0
    ds_read_b128 v[56:59], v3 offset:0
    v_mfma_f32_16x16x32_bf16 v[72:75], v[28:31], a[8:11], v[72:75]
    v_exp_f32 v115, v115
    v_mfma_f32_16x16x32_bf16 v[76:79], v[24:27], a[4:7], 0
    ds_read_b128 v[60:63], v3 offset:1024
    v_mfma_f32_16x16x32_bf16 v[76:79], v[28:31], a[12:15], v[76:79]
    buffer_load_dwordx4 v5, s[8:11], s31 offen offset:2048 lds
    v_mfma_f32_16x16x32_bf16 v[80:83], v[32:35], a[0:3], 0
    ds_read_b128 v[64:67], v3 offset:2048
    v_fma_f32 v115, v115, s30, s30
    v_mfma_f32_16x16x32_bf16 v[80:83], v[36:39], a[8:11], v[80:83]
    v_rcp_f32 v115, v115
    v_mfma_f32_16x16x32_bf16 v[84:87], v[32:35], a[4:7], 0
    ds_read_b128 v[68:71], v3 offset:3072
    v_mfma_f32_16x16x32_bf16 v[84:87], v[36:39], a[12:15], v[84:87]
    v_mul_f32 v115, v115, v131
    s_waitcnt lgkmcnt(4)
    v_mfma_f32_16x16x32_bf16 v[88:91], v[40:43], a[0:3], 0
    ds_read_b128 v[24:27], v3 offset:4096
    v_cvt_pk_bf16_f32 v155, v114, v115
    v_mfma_f32_16x16x32_bf16 v[88:91], v[44:47], a[8:11], v[88:91]
    v_exp_f32 v108, v108
    v_mfma_f32_16x16x32_bf16 v[92:95], v[40:43], a[4:7], 0
    ds_read_b128 v[28:31], v3 offset:5120
    s_mov_b32 s29, 2048
    v_mfma_f32_16x16x32_bf16 v[92:95], v[44:47], a[12:15], v[92:95]
    buffer_load_dwordx4 v5, s[8:11], s31 offen offset:3072 lds
    v_mfma_f32_16x16x32_bf16 v[96:99], v[48:51], a[0:3], 0
    ds_read_b128 v[32:35], v3 offset:6144
    v_fma_f32 v108, v108, s30, s30
    v_mfma_f32_16x16x32_bf16 v[96:99], v[52:55], a[8:11], v[96:99]
    buffer_store_dwordx4 v[152:155], v8, s[8:11], s29 offen offset:0 sc1
    v_mfma_f32_16x16x32_bf16 v[100:103], v[48:51], a[4:7], 0
    ds_read_b128 v[36:39], v3 offset:7168
    s_add_u32 m0, s28, 0
    v_mfma_f32_16x16x32_bf16 v[100:103], v[52:55], a[12:15], v[100:103]
    s_mov_b32 s31, 327680
    s_waitcnt lgkmcnt(4)
    v_mfma_f32_16x16x32_bf16 v[72:75], v[56:59], a[16:19], v[72:75]
    ds_read_b128 v[40:43], v3 offset:8192
    v_mfma_f32_16x16x32_bf16 v[72:75], v[60:63], a[24:27], v[72:75]
    v_rcp_f32 v108, v108
    v_mfma_f32_16x16x32_bf16 v[76:79], v[56:59], a[20:23], v[76:79]
    ds_read_b128 v[44:47], v3 offset:9216
    v_mfma_f32_16x16x32_bf16 v[76:79], v[60:63], a[28:31], v[76:79]
    buffer_load_dwordx4 v5, s[8:11], s31 offen offset:0 lds
    v_mfma_f32_16x16x32_bf16 v[80:83], v[64:67], a[16:19], v[80:83]
    ds_read_b128 v[48:51], v3 offset:10240
    v_mul_f32 v108, v108, v124
    v_mfma_f32_16x16x32_bf16 v[80:83], v[68:71], a[24:27], v[80:83]
    v_exp_f32 v109, v109
    v_mfma_f32_16x16x32_bf16 v[84:87], v[64:67], a[20:23], v[84:87]
    ds_read_b128 v[52:55], v3 offset:11264
    v_mfma_f32_16x16x32_bf16 v[84:87], v[68:71], a[28:31], v[84:87]
    v_fma_f32 v109, v109, s30, s30
    s_waitcnt lgkmcnt(4)
    v_mfma_f32_16x16x32_bf16 v[88:91], v[24:27], a[16:19], v[88:91]
    ds_read_b128 v[56:59], v3 offset:12288
    v_mfma_f32_16x16x32_bf16 v[88:91], v[28:31], a[24:27], v[88:91]
    v_rcp_f32 v109, v109
    v_mfma_f32_16x16x32_bf16 v[92:95], v[24:27], a[20:23], v[92:95]
    ds_read_b128 v[60:63], v3 offset:13312
    v_mfma_f32_16x16x32_bf16 v[92:95], v[28:31], a[28:31], v[92:95]
    buffer_load_dwordx4 v5, s[8:11], s31 offen offset:1024 lds
    v_mfma_f32_16x16x32_bf16 v[96:99], v[32:35], a[16:19], v[96:99]
    ds_read_b128 v[64:67], v3 offset:14336
    v_mul_f32 v109, v109, v125
    v_mfma_f32_16x16x32_bf16 v[96:99], v[36:39], a[24:27], v[96:99]
    v_exp_f32 v110, v110
    v_mfma_f32_16x16x32_bf16 v[100:103], v[32:35], a[20:23], v[100:103]
    ds_read_b128 v[68:71], v3 offset:15360
    v_cvt_pk_bf16_f32 v156, v108, v109
    v_mfma_f32_16x16x32_bf16 v[100:103], v[36:39], a[28:31], v[100:103]
    v_fma_f32 v110, v110, s30, s30
    s_waitcnt lgkmcnt(4)
    v_mfma_f32_16x16x32_bf16 v[72:75], v[40:43], a[32:35], v[72:75]
    s_waitcnt vmcnt(12)
    s_barrier
    ds_read_b128 v[24:27], v3 offset:16384
    v_mfma_f32_16x16x32_bf16 v[72:75], v[44:47], a[40:43], v[72:75]
    v_rcp_f32 v110, v110
    v_mfma_f32_16x16x32_bf16 v[76:79], v[40:43], a[36:39], v[76:79]
    ds_read_b128 v[28:31], v3 offset:17408
    v_mfma_f32_16x16x32_bf16 v[76:79], v[44:47], a[44:47], v[76:79]
    buffer_load_dwordx4 v5, s[8:11], s31 offen offset:2048 lds
    v_mfma_f32_16x16x32_bf16 v[80:83], v[48:51], a[32:35], v[80:83]
    ds_read_b128 v[32:35], v3 offset:18432
    v_mul_f32 v110, v110, v126
    v_mfma_f32_16x16x32_bf16 v[80:83], v[52:55], a[40:43], v[80:83]
    v_exp_f32 v111, v111
    v_mfma_f32_16x16x32_bf16 v[84:87], v[48:51], a[36:39], v[84:87]
    ds_read_b128 v[36:39], v3 offset:19456
    v_mfma_f32_16x16x32_bf16 v[84:87], v[52:55], a[44:47], v[84:87]
    v_fma_f32 v111, v111, s30, s30
    s_waitcnt lgkmcnt(4)
    v_mfma_f32_16x16x32_bf16 v[88:91], v[56:59], a[32:35], v[88:91]
    ds_read_b128 v[40:43], v3 offset:20480
    v_mfma_f32_16x16x32_bf16 v[88:91], v[60:63], a[40:43], v[88:91]
    v_rcp_f32 v111, v111
    v_mfma_f32_16x16x32_bf16 v[92:95], v[56:59], a[36:39], v[92:95]
    ds_read_b128 v[44:47], v3 offset:21504
    v_mfma_f32_16x16x32_bf16 v[92:95], v[60:63], a[44:47], v[92:95]
    buffer_load_dwordx4 v5, s[8:11], s31 offen offset:3072 lds
    v_mfma_f32_16x16x32_bf16 v[96:99], v[64:67], a[32:35], v[96:99]
    ds_read_b128 v[48:51], v3 offset:22528
    v_mul_f32 v111, v111, v127
    v_mfma_f32_16x16x32_bf16 v[96:99], v[68:71], a[40:43], v[96:99]
    v_exp_f32 v116, v116
    v_mfma_f32_16x16x32_bf16 v[100:103], v[64:67], a[36:39], v[100:103]
    ds_read_b128 v[52:55], v3 offset:23552
    s_add_u32 m0, s28, 16384
    v_mfma_f32_16x16x32_bf16 v[100:103], v[68:71], a[44:47], v[100:103]
    s_mov_b32 s31, 344064
    s_waitcnt lgkmcnt(4)
    v_mfma_f32_16x16x32_bf16 v[72:75], v[24:27], a[48:51], v[72:75]
    ds_read_b128 v[56:59], v3 offset:24576
    v_cvt_pk_bf16_f32 v157, v110, v111
    v_mfma_f32_16x16x32_bf16 v[72:75], v[28:31], a[56:59], v[72:75]
    v_exp_f32 v117, v117
    v_mfma_f32_16x16x32_bf16 v[76:79], v[24:27], a[52:55], v[76:79]
    ds_read_b128 v[60:63], v3 offset:25600
    v_fma_f32 v116, v116, s30, s30
    v_mfma_f32_16x16x32_bf16 v[76:79], v[28:31], a[60:63], v[76:79]
    buffer_load_dwordx4 v5, s[8:11], s31 offen offset:0 lds
    v_mfma_f32_16x16x32_bf16 v[80:83], v[32:35], a[48:51], v[80:83]
    ds_read_b128 v[64:67], v3 offset:26624
    v_fma_f32 v117, v117, s30, s30
    v_mfma_f32_16x16x32_bf16 v[80:83], v[36:39], a[56:59], v[80:83]
    v_rcp_f32 v116, v116
    v_mfma_f32_16x16x32_bf16 v[84:87], v[32:35], a[52:55], v[84:87]
    ds_read_b128 v[68:71], v3 offset:27648
    v_mfma_f32_16x16x32_bf16 v[84:87], v[36:39], a[60:63], v[84:87]
    v_mul_f32 v116, v116, v132
    s_waitcnt lgkmcnt(4)
    v_mfma_f32_16x16x32_bf16 v[88:91], v[40:43], a[48:51], v[88:91]
    ds_read_b128 v[24:27], v3 offset:28672
    v_mfma_f32_16x16x32_bf16 v[88:91], v[44:47], a[56:59], v[88:91]
    v_rcp_f32 v117, v117
    v_mfma_f32_16x16x32_bf16 v[92:95], v[40:43], a[52:55], v[92:95]
    ds_read_b128 v[28:31], v3 offset:29696
    v_mfma_f32_16x16x32_bf16 v[92:95], v[44:47], a[60:63], v[92:95]
    buffer_load_dwordx4 v5, s[8:11], s31 offen offset:1024 lds
    v_mfma_f32_16x16x32_bf16 v[96:99], v[48:51], a[48:51], v[96:99]
    ds_read_b128 v[32:35], v3 offset:30720
    v_mul_f32 v117, v117, v133
    v_mfma_f32_16x16x32_bf16 v[96:99], v[52:55], a[56:59], v[96:99]
    v_exp_f32 v118, v118
    v_mfma_f32_16x16x32_bf16 v[100:103], v[48:51], a[52:55], v[100:103]
    ds_read_b128 v[36:39], v3 offset:31744
    v_cvt_pk_bf16_f32 v158, v116, v117
    v_mfma_f32_16x16x32_bf16 v[100:103], v[52:55], a[60:63], v[100:103]
    v_fma_f32 v118, v118, s30, s30
    s_waitcnt lgkmcnt(4)
    v_mfma_f32_16x16x32_bf16 v[72:75], v[56:59], a[64:67], v[72:75]
    ds_read_b128 v[40:43], v3 offset:32768
    v_mfma_f32_16x16x32_bf16 v[72:75], v[60:63], a[72:75], v[72:75]
    v_rcp_f32 v118, v118
    v_mfma_f32_16x16x32_bf16 v[76:79], v[56:59], a[68:71], v[76:79]
    ds_read_b128 v[44:47], v3 offset:33792
    v_mfma_f32_16x16x32_bf16 v[76:79], v[60:63], a[76:79], v[76:79]
    buffer_load_dwordx4 v5, s[8:11], s31 offen offset:2048 lds
    v_mfma_f32_16x16x32_bf16 v[80:83], v[64:67], a[64:67], v[80:83]
    ds_read_b128 v[48:51], v3 offset:34816
    v_mul_f32 v118, v118, v134
    v_mfma_f32_16x16x32_bf16 v[80:83], v[68:71], a[72:75], v[80:83]
    v_exp_f32 v119, v119
    v_mfma_f32_16x16x32_bf16 v[84:87], v[64:67], a[68:71], v[84:87]
    ds_read_b128 v[52:55], v3 offset:35840
    v_mfma_f32_16x16x32_bf16 v[84:87], v[68:71], a[76:79], v[84:87]
    v_fma_f32 v119, v119, s30, s30
    s_waitcnt lgkmcnt(4)
    v_mfma_f32_16x16x32_bf16 v[88:91], v[24:27], a[64:67], v[88:91]
    ds_read_b128 v[56:59], v3 offset:36864
    v_mfma_f32_16x16x32_bf16 v[88:91], v[28:31], a[72:75], v[88:91]
    v_add_u32 v251, k4_kernel_j505-k4_kernel_pc, v250
    v_min_u32 v251, k4_kernel_end-k4_kernel_pc, v251
    global_load_dword v252, v251, s[40:41]
    v_mfma_f32_16x16x32_bf16 v[92:95], v[24:27], a[68:71], v[92:95]
    ds_read_b128 v[60:63], v3 offset:37888
    v_mfma_f32_16x16x32_bf16 v[92:95], v[28:31], a[76:79], v[92:95]
    buffer_load_dwordx4 v5, s[8:11], s31 offen offset:3072 lds
    v_mfma_f32_16x16x32_bf16 v[96:99], v[32:35], a[64:67], v[96:99]
    ds_read_b128 v[64:67], v3 offset:38912
    v_mfma_f32_16x16x32_bf16 v[96:99], v[36:39], a[72:75], v[96:99]
    v_rcp_f32 v119, v119
    v_mfma_f32_16x16x32_bf16 v[100:103], v[32:35], a[68:71], v[100:103]
    ds_read_b128 v[68:71], v3 offset:39936
    s_add_u32 m0, s28, 32768
    v_mfma_f32_16x16x32_bf16 v[100:103], v[36:39], a[76:79], v[100:103]
    s_mov_b32 s31, 360448
    s_waitcnt lgkmcnt(4)
    v_mfma_f32_16x16x32_bf16 v[72:75], v[40:43], a[80:83], v[72:75]
    ds_read_b128 v[24:27], v3 offset:40960
    v_mul_f32 v119, v119, v135
    v_mfma_f32_16x16x32_bf16 v[72:75], v[44:47], a[88:91], v[72:75]
    v_exp_f32 v216, v216
    v_mfma_f32_16x16x32_bf16 v[76:79], v[40:43], a[84:87], v[76:79]
    ds_read_b128 v[28:31], v3 offset:41984
    v_cvt_pk_bf16_f32 v159, v118, v119
    v_mfma_f32_16x16x32_bf16 v[76:79], v[44:47], a[92:95], v[76:79]
    buffer_load_dwordx4 v5, s[8:11], s31 offen offset:0 lds
    v_mfma_f32_16x16x32_bf16 v[80:83], v[48:51], a[80:83], v[80:83]
    ds_read_b128 v[32:35], v3 offset:43008
    s_mov_b32 s29, 2048
    v_mfma_f32_16x16x32_bf16 v[80:83], v[52:55], a[88:91], v[80:83]
    buffer_store_dwordx4 v[156:159], v8, s[8:11], s29 offen offset:1024 sc1
    v_mfma_f32_16x16x32_bf16 v[84:87], v[48:51], a[84:87], v[84:87]
    ds_read_b128 v[36:39], v3 offset:44032
    v_exp_f32 v217, v217
    v_mfma_f32_16x16x32_bf16 v[84:87], v[52:55], a[92:95], v[84:87]
    v_fma_f32 v216, v216, s30, s30
    s_waitcnt lgkmcnt(4)
    v_mfma_f32_16x16x32_bf16 v[88:91], v[56:59], a[80:83], v[88:91]
    ds_read_b128 v[40:43], v3 offset:45056
    v_fma_f32 v217, v217, s30, s30
    v_mfma_f32_16x16x32_bf16 v[88:91], v[60:63], a[88:91], v[88:91]
    v_rcp_f32 v216, v216
    v_mfma_f32_16x16x32_bf16 v[92:95], v[56:59], a[84:87], v[92:95]
    ds_read_b128 v[44:47], v3 offset:46080
    v_rcp_f32 v217, v217
    v_mfma_f32_16x16x32_bf16 v[92:95], v[60:63], a[92:95], v[92:95]
    buffer_load_dwordx4 v5, s[8:11], s31 offen offset:1024 lds
    v_mfma_f32_16x16x32_bf16 v[96:99], v[64:67], a[80:83], v[96:99]
    ds_read_b128 v[48:51], v3 offset:47104
    v_mul_f32 v216, v216, v232
    v_mfma_f32_16x16x32_bf16 v[96:99], v[68:71], a[88:91], v[96:99]
    v_exp_f32 v218, v218
    v_mfma_f32_16x16x32_bf16 v[100:103], v[64:67], a[84:87], v[100:103]
    ds_read_b128 v[52:55], v3 offset:48128
    v_mul_f32 v217, v217, v233
    v_mfma_f32_16x16x32_bf16 v[100:103], v[68:71], a[92:95], v[100:103]
    v_fma_f32 v218, v218, s30, s30
    s_waitcnt lgkmcnt(4)
    v_mfma_f32_16x16x32_bf16 v[72:75], v[24:27], a[96:99], v[72:75]
    ds_read_b128 v[56:59], v3 offset:49152
    v_cvt_pk_bf16_f32 v160, v216, v217
    v_mfma_f32_16x16x32_bf16 v[72:75], v[28:31], a[104:107], v[72:75]
    v_rcp_f32 v218, v218
    v_mfma_f32_16x16x32_bf16 v[76:79], v[24:27], a[100:103], v[76:79]
    ds_read_b128 v[60:63], v3 offset:50176
    v_exp_f32 v219, v219
    v_mfma_f32_16x16x32_bf16 v[76:79], v[28:31], a[108:111], v[76:79]
    buffer_load_dwordx4 v5, s[8:11], s31 offen offset:2048 lds
    v_mfma_f32_16x16x32_bf16 v[80:83], v[32:35], a[96:99], v[80:83]
    ds_read_b128 v[64:67], v3 offset:51200
    v_mul_f32 v218, v218, v234
    v_mfma_f32_16x16x32_bf16 v[80:83], v[36:39], a[104:107], v[80:83]
    v_exp_f32 v224, v224
    v_mfma_f32_16x16x32_bf16 v[84:87], v[32:35], a[100:103], v[84:87]
    ds_read_b128 v[68:71], v3 offset:52224
    v_fma_f32 v219, v219, s30, s30
    v_mfma_f32_16x16x32_bf16 v[84:87], v[36:39], a[108:111], v[84:87]
    v_fma_f32 v224, v224, s30, s30
    s_waitcnt lgkmcnt(4)
    v_mfma_f32_16x16x32_bf16 v[88:91], v[40:43], a[96:99], v[88:91]
    ds_read_b128 v[24:27], v3 offset:53248
    v_rcp_f32 v219, v219
    v_mfma_f32_16x16x32_bf16 v[88:91], v[44:47], a[104:107], v[88:91]
    v_rcp_f32 v224, v224
    v_mfma_f32_16x16x32_bf16 v[92:95], v[40:43], a[100:103], v[92:95]
    ds_read_b128 v[28:31], v3 offset:54272
    v_mul_f32 v219, v219, v235
    v_mfma_f32_16x16x32_bf16 v[92:95], v[44:47], a[108:111], v[92:95]
    buffer_load_dwordx4 v5, s[8:11], s31 offen offset:3072 lds
    v_mfma_f32_16x16x32_bf16 v[96:99], v[48:51], a[96:99], v[96:99]
    ds_read_b128 v[32:35], v3 offset:55296
    v_cvt_pk_bf16_f32 v161, v218, v219
    v_mfma_f32_16x16x32_bf16 v[96:99], v[52:55], a[104:107], v[96:99]
    v_exp_f32 v225, v225
    v_mfma_f32_16x16x32_bf16 v[100:103], v[48:51], a[100:103], v[100:103]
    ds_read_b128 v[36:39], v3 offset:56320
    s_add_u32 m0, s28, 49152
    v_mfma_f32_16x16x32_bf16 v[100:103], v[52:55], a[108:111], v[100:103]
    s_mov_b32 s31, 376832
    s_waitcnt lgkmcnt(4)
    v_mfma_f32_16x16x32_bf16 v[72:75], v[56:59], a[112:115], v[72:75]
    ds_read_b128 v[40:43], v3 offset:57344
    v_mul_f32 v224, v224, v240
    v_mfma_f32_16x16x32_bf16 v[72:75], v[60:63], a[120:123], v[72:75]
    v_exp_f32 v226, v226
    v_mfma_f32_16x16x32_bf16 v[76:79], v[56:59], a[116:119], v[76:79]
    ds_read_b128 v[44:47], v3 offset:58368
    v_fma_f32 v225, v225, s30, s30
    v_mfma_f32_16x16x32_bf16 v[76:79], v[60:63], a[124:127], v[76:79]
    buffer_load_dwordx4 v5, s[8:11], s31 offen offset:0 lds
    v_mfma_f32_16x16x32_bf16 v[80:83], v[64:67], a[112:115], v[80:83]
    ds_read_b128 v[48:51], v3 offset:59392
    v_fma_f32 v226, v226, s30, s30
    v_mfma_f32_16x16x32_bf16 v[80:83], v[68:71], a[120:123], v[80:83]
    v_rcp_f32 v225, v225
    v_mfma_f32_16x16x32_bf16 v[84:87], v[64:67], a[116:119], v[84:87]
    ds_read_b128 v[52:55], v3 offset:60416
    v_mfma_f32_16x16x32_bf16 v[84:87], v[68:71], a[124:127], v[84:87]
    v_mul_f32 v225, v225, v241
    s_waitcnt lgkmcnt(4)
    v_mfma_f32_16x16x32_bf16 v[88:91], v[24:27], a[112:115], v[88:91]
    ds_read_b128 v[56:59], v3 offset:61440
    v_cvt_pk_bf16_f32 v162, v224, v225
    v_mfma_f32_16x16x32_bf16 v[88:91], v[28:31], a[120:123], v[88:91]
    v_rcp_f32 v226, v226
    v_mfma_f32_16x16x32_bf16 v[92:95], v[24:27], a[116:119], v[92:95]
    ds_read_b128 v[60:63], v3 offset:62464
    v_mfma_f32_16x16x32_bf16 v[92:95], v[28:31], a[124:127], v[92:95]
    buffer_load_dwordx4 v5, s[8:11], s31 offen offset:1024 lds
    v_mfma_f32_16x16x32_bf16 v[96:99], v[32:35], a[112:115], v[96:99]
    ds_read_b128 v[64:67], v3 offset:63488
    v_mul_f32 v226, v226, v242
    v_mfma_f32_16x16x32_bf16 v[96:99], v[36:39], a[120:123], v[96:99]
    v_exp_f32 v227, v227
    v_mfma_f32_16x16x32_bf16 v[100:103], v[32:35], a[116:119], v[100:103]
    ds_read_b128 v[68:71], v3 offset:64512
    v_mfma_f32_16x16x32_bf16 v[100:103], v[36:39], a[124:127], v[100:103]
    v_fma_f32 v227, v227, s30, s30
    s_waitcnt lgkmcnt(4)
    v_mfma_f32_16x16x32_bf16 v[72:75], v[40:43], a[128:131], v[72:75]
    s_waitcnt vmcnt(12)
    s_barrier
    ds_read_b128 v[24:27], v4 offset:0
    v_mfma_f32_16x16x32_bf16 v[72:75], v[44:47], a[136:139], v[72:75]
    v_rcp_f32 v227, v227
    v_mfma_f32_16x16x32_bf16 v[76:79], v[40:43], a[132:135], v[76:79]
    ds_read_b128 v[28:31], v4 offset:1024
    v_mfma_f32_16x16x32_bf16 v[76:79], v[44:47], a[140:143], v[76:79]
    buffer_load_dwordx4 v5, s[8:11], s31 offen offset:2048 lds
    v_mfma_f32_16x16x32_bf16 v[80:83], v[48:51], a[128:131], v[80:83]
    ds_read_b128 v[32:35], v4 offset:2048
    v_mul_f32 v227, v227, v243
    v_mfma_f32_16x16x32_bf16 v[80:83], v[52:55], a[136:139], v[80:83]
    v_exp_f32 v220, v220
    v_mfma_f32_16x16x32_bf16 v[84:87], v[48:51], a[132:135], v[84:87]
    ds_read_b128 v[36:39], v4 offset:3072
    v_cvt_pk_bf16_f32 v163, v226, v227
    v_mfma_f32_16x16x32_bf16 v[84:87], v[52:55], a[140:143], v[84:87]
    s_mov_b32 s29, 4096
    s_waitcnt lgkmcnt(4)
    v_mfma_f32_16x16x32_bf16 v[88:91], v[56:59], a[128:131], v[88:91]
    ds_read_b128 v[40:43], v4 offset:4096
    v_fma_f32 v220, v220, s30, s30
    v_mfma_f32_16x16x32_bf16 v[88:91], v[60:63], a[136:139], v[88:91]
    buffer_store_dwordx4 v[160:163], v8, s[8:11], s29 offen offset:0 sc1
    v_mfma_f32_16x16x32_bf16 v[92:95], v[56:59], a[132:135], v[92:95]
    ds_read_b128 v[44:47], v4 offset:5120
    v_mfma_f32_16x16x32_bf16 v[92:95], v[60:63], a[140:143], v[92:95]
    buffer_load_dwordx4 v5, s[8:11], s31 offen offset:3072 lds
    v_mfma_f32_16x16x32_bf16 v[96:99], v[64:67], a[128:131], v[96:99]
    ds_read_b128 v[48:51], v4 offset:6144
    v_mfma_f32_16x16x32_bf16 v[96:99], v[68:71], a[136:139], v[96:99]
    v_rcp_f32 v220, v220
    v_mfma_f32_16x16x32_bf16 v[100:103], v[64:67], a[132:135], v[100:103]
    ds_read_b128 v[52:55], v4 offset:7168
    s_add_u32 m0, s28, 65536
    v_mfma_f32_16x16x32_bf16 v[100:103], v[68:71], a[140:143], v[100:103]
    s_mov_b32 s31, 393216
    s_waitcnt lgkmcnt(4)
    v_mfma_f32_16x16x32_bf16 v[104:107], v[24:27], a[0:3], 0
    ds_read_b128 v[56:59], v4 offset:8192
    v_mul_f32 v220, v220, v236
    v_mfma_f32_16x16x32_bf16 v[104:107], v[28:31], a[8:11], v[104:107]
    v_exp_f32 v221, v221
    v_mfma_f32_16x16x32_bf16 v[108:111], v[24:27], a[4:7], 0
    ds_read_b128 v[60:63], v4 offset:9216
    v_mfma_f32_16x16x32_bf16 v[108:111], v[28:31], a[12:15], v[108:111]
    buffer_load_dwordx4 v5, s[8:11], s31 offen offset:0 lds
    v_mfma_f32_16x16x32_bf16 v[112:115], v[32:35], a[0:3], 0
    ds_read_b128 v[64:67], v4 offset:10240
    v_fma_f32 v221, v221, s30, s30
    v_mfma_f32_16x16x32_bf16 v[112:115], v[36:39], a[8:11], v[112:115]
    v_rcp_f32 v221, v221
    v_mfma_f32_16x16x32_bf16 v[116:119], v[32:35], a[4:7], 0
    ds_read_b128 v[68:71], v4 offset:11264
    v_mfma_f32_16x16x32_bf16 v[116:119], v[36:39], a[12:15], v[116:119]
    v_mul_f32 v221, v221, v237
    s_waitcnt lgkmcnt(4)
    v_mfma_f32_16x16x32_bf16 v[120:123], v[40:43], a[0:3], 0
    ds_read_b128 v[24:27], v4 offset:12288
    v_cvt_pk_bf16_f32 v164, v220, v221
    v_mfma_f32_16x16x32_bf16 v[120:123], v[44:47], a[8:11], v[120:123]
    v_exp_f32 v222, v222
    v_mfma_f32_16x16x32_bf16 v[124:127], v[40:43], a[4:7], 0
    ds_read_b128 v[28:31], v4 offset:13312
    v_mfma_f32_16x16x32_bf16 v[124:127], v[44:47], a[12:15], v[124:127]
    buffer_load_dwordx4 v5, s[8:11], s31 offen offset:1024 lds
    v_mfma_f32_16x16x32_bf16 v[128:131], v[48:51], a[0:3], 0
    ds_read_b128 v[32:35], v4 offset:14336
    v_fma_f32 v222, v222, s30, s30
    v_mfma_f32_16x16x32_bf16 v[128:131], v[52:55], a[8:11], v[128:131]
    v_rcp_f32 v222, v222
    v_mfma_f32_16x16x32_bf16 v[132:135], v[48:51], a[4:7], 0
    ds_read_b128 v[36:39], v4 offset:15360
    v_mfma_f32_16x16x32_bf16 v[132:135], v[52:55], a[12:15], v[132:135]
    v_mul_f32 v222, v222, v238
    s_waitcnt lgkmcnt(4)
    v_mfma_f32_16x16x32_bf16 v[104:107], v[56:59], a[16:19], v[104:107]
    ds_read_b128 v[40:43], v4 offset:16384
    v_mfma_f32_16x16x32_bf16 v[104:107], v[60:63], a[24:27], v[104:107]
    v_exp_f32 v223, v223
    v_mfma_f32_16x16x32_bf16 v[108:111], v[56:59], a[20:23], v[108:111]
    ds_read_b128 v[44:47], v4 offset:17408
    v_mfma_f32_16x16x32_bf16 v[108:111], v[60:63], a[28:31], v[108:111]
    buffer_load_dwordx4 v5, s[8:11], s31 offen offset:2048 lds
    v_mfma_f32_16x16x32_bf16 v[112:115], v[64:67], a[16:19], v[112:115]
    ds_read_b128 v[48:51], v4 offset:18432
    v_fma_f32 v223, v223, s30, s30
    v_mfma_f32_16x16x32_bf16 v[112:115], v[68:71], a[24:27], v[112:115]
    v_rcp_f32 v223, v223
    v_mfma_f32_16x16x32_bf16 v[116:119], v[64:67], a[20:23], v[116:119]
    ds_read_b128 v[52:55], v4 offset:19456
    v_mfma_f32_16x16x32_bf16 v[116:119], v[68:71], a[28:31], v[116:119]
    v_mul_f32 v223, v223, v239
    s_waitcnt lgkmcnt(4)
    v_mfma_f32_16x16x32_bf16 v[120:123], v[24:27], a[16:19], v[120:123]
    ds_read_b128 v[56:59], v4 offset:20480
    v_cvt_pk_bf16_f32 v165, v222, v223
    v_mfma_f32_16x16x32_bf16 v[120:123], v[28:31], a[24:27], v[120:123]
    v_exp_f32 v228, v228
    v_mfma_f32_16x16x32_bf16 v[124:127], v[24:27], a[20:23], v[124:127]
    ds_read_b128 v[60:63], v4 offset:21504
    v_mfma_f32_16x16x32_bf16 v[124:127], v[28:31], a[28:31], v[124:127]
    buffer_load_dwordx4 v5, s[8:11], s31 offen offset:3072 lds
    v_mfma_f32_16x16x32_bf16 v[128:131], v[32:35], a[16:19], v[128:131]
    ds_read_b128 v[64:67], v4 offset:22528
    v_fma_f32 v228, v228, s30, s30
    v_mfma_f32_16x16x32_bf16 v[128:131], v[36:39], a[24:27], v[128:131]
    v_rcp_f32 v228, v228
    v_mfma_f32_16x16x32_bf16 v[132:135], v[32:35], a[20:23], v[132:135]
    ds_read_b128 v[68:71], v4 offset:23552
    s_add_u32 m0, s28, 81920
    v_mfma_f32_16x16x32_bf16 v[132:135], v[36:39], a[28:31], v[132:135]
    s_mov_b32 s31, 409600
    s_waitcnt lgkmcnt(4)
    v_mfma_f32_16x16x32_bf16 v[104:107], v[40:43], a[32:35], v[104:107]
    ds_read_b128 v[24:27], v4 offset:24576
    v_mul_f32 v228, v228, v244
    v_mfma_f32_16x16x32_bf16 v[104:107], v[44:47], a[40:43], v[104:107]
    v_exp_f32 v229, v229
    v_mfma_f32_16x16x32_bf16 v[108:111], v[40:43], a[36:39], v[108:111]
    ds_read_b128 v[28:31], v4 offset:25600
    v_mfma_f32_16x16x32_bf16 v[108:111], v[44:47], a[44:47], v[108:111]
    buffer_load_dwordx4 v5, s[8:11], s31 offen offset:0 lds
    v_mfma_f32_16x16x32_bf16 v[112:115], v[48:51], a[32:35], v[112:115]
    ds_read_b128 v[32:35], v4 offset:26624
    v_fma_f32 v229, v229, s30, s30
    v_mfma_f32_16x16x32_bf16 v[112:115], v[52:55], a[40:43], v[112:115]
    v_rcp_f32 v229, v229
    v_mfma_f32_16x16x32_bf16 v[116:119], v[48:51], a[36:39], v[116:119]
    ds_read_b128 v[36:39], v4 offset:27648
    v_mfma_f32_16x16x32_bf16 v[116:119], v[52:55], a[44:47], v[116:119]
    v_mul_f32 v229, v229, v245
    s_waitcnt lgkmcnt(4)
    v_mfma_f32_16x16x32_bf16 v[120:123], v[56:59], a[32:35], v[120:123]
    ds_read_b128 v[40:43], v4 offset:28672
    v_cvt_pk_bf16_f32 v166, v228, v229
    v_mfma_f32_16x16x32_bf16 v[120:123], v[60:63], a[40:43], v[120:123]
    v_exp_f32 v230, v230
    v_mfma_f32_16x16x32_bf16 v[124:127], v[56:59], a[36:39], v[124:127]
    ds_read_b128 v[44:47], v4 offset:29696
    v_mfma_f32_16x16x32_bf16 v[124:127], v[60:63], a[44:47], v[124:127]
    buffer_load_dwordx4 v5, s[8:11], s31 offen offset:1024 lds
    v_mfma_f32_16x16x32_bf16 v[128:131], v[64:67], a[32:35], v[128:131]
    ds_read_b128 v[48:51], v4 offset:30720
    v_fma_f32 v230, v230, s30, s30
    v_mfma_f32_16x16x32_bf16 v[128:131], v[68:71], a[40:43], v[128:131]
    v_rcp_f32 v230, v230
    v_mfma_f32_16x16x32_bf16 v[132:135], v[64:67], a[36:39], v[132:135]
    ds_read_b128 v[52:55], v4 offset:31744
    v_mfma_f32_16x16x32_bf16 v[132:135], v[68:71], a[44:47], v[132:135]
    v_mul_f32 v230, v230, v246
    s_waitcnt lgkmcnt(4)
    v_mfma_f32_16x16x32_bf16 v[104:107], v[24:27], a[48:51], v[104:107]
    ds_read_b128 v[56:59], v2 offset:0
    v_mfma_f32_16x16x32_bf16 v[104:107], v[28:31], a[56:59], v[104:107]
    v_exp_f32 v231, v231
    v_mfma_f32_16x16x32_bf16 v[108:111], v[24:27], a[52:55], v[108:111]
    ds_read_b128 v[60:63], v2 offset:1024
    v_mfma_f32_16x16x32_bf16 v[108:111], v[28:31], a[60:63], v[108:111]
    buffer_load_dwordx4 v5, s[8:11], s31 offen offset:2048 lds
    v_mfma_f32_16x16x32_bf16 v[112:115], v[32:35], a[48:51], v[112:115]
    ds_read_b128 v[64:67], v2 offset:2048
    v_fma_f32 v231, v231, s30, s30
    v_mfma_f32_16x16x32_bf16 v[112:115], v[36:39], a[56:59], v[112:115]
    v_rcp_f32 v231, v231
    v_mfma_f32_16x16x32_bf16 v[116:119], v[32:35], a[52:55], v[116:119]
    ds_read_b128 v[68:71], v2 offset:3072
    v_mfma_f32_16x16x32_bf16 v[116:119], v[36:39], a[60:63], v[116:119]
    v_mul_f32 v231, v231, v247
    s_waitcnt lgkmcnt(4)
    v_mfma_f32_16x16x32_bf16 v[120:123], v[40:43], a[48:51], v[120:123]
    ds_read_b128 v[24:27], v2 offset:4096
    v_cvt_pk_bf16_f32 v167, v230, v231
    v_mfma_f32_16x16x32_bf16 v[120:123], v[44:47], a[56:59], v[120:123]
    v_exp_f32 v72, v72
    v_mfma_f32_16x16x32_bf16 v[124:127], v[40:43], a[52:55], v[124:127]
    ds_read_b128 v[28:31], v2 offset:5120
    s_mov_b32 s29, 4096
    v_mfma_f32_16x16x32_bf16 v[124:127], v[44:47], a[60:63], v[124:127]
    buffer_load_dwordx4 v5, s[8:11], s31 offen offset:3072 lds
    v_mfma_f32_16x16x32_bf16 v[128:131], v[48:51], a[48:51], v[128:131]
    ds_read_b128 v[32:35], v2 offset:6144
    v_fma_f32 v72, v72, s30, s30
    v_mfma_f32_16x16x32_bf16 v[128:131], v[52:55], a[56:59], v[128:131]
    buffer_store_dwordx4 v[164:167], v8, s[8:11], s29 offen offset:1024 sc1
    v_mfma_f32_16x16x32_bf16 v[132:135], v[48:51], a[52:55], v[132:135]
    ds_read_b128 v[36:39], v2 offset:7168
    v_rcp_f32 v72, v72
    v_mfma_f32_16x16x32_bf16 v[132:135], v[52:55], a[60:63], v[132:135]
    v_exp_f32 v73, v73
    s_waitcnt lgkmcnt(4)
    v_mfma_f32_16x16x32_bf16 v[104:107], v[56:59], a[64:67], v[104:107]
    ds_read_b128 v[40:43], v2 offset:8192
    s_add_u32 m0, s28, 98304
    v_mfma_f32_16x16x32_bf16 v[104:107], v[60:63], a[72:75], v[104:107]
    v_exp_f32 v74, v74
    v_mfma_f32_16x16x32_bf16 v[108:111], v[56:59], a[68:71], v[108:111]
    ds_read_b128 v[44:47], v2 offset:9216
    s_mov_b32 s31, 425984
    v_mfma_f32_16x16x32_bf16 v[108:111], v[60:63], a[76:79], v[108:111]
    buffer_load_dwordx4 v5, s[8:11], s31 offen offset:0 lds
    v_mfma_f32_16x16x32_bf16 v[112:115], v[64:67], a[64:67], v[112:115]
    ds_read_b128 v[48:51], v2 offset:10240
    v_mul_f32 v72, v72, v88
    v_mfma_f32_16x16x32_bf16 v[112:115], v[68:71], a[72:75], v[112:115]
    v_exp_f32 v75, v75
    v_mfma_f32_16x16x32_bf16 v[116:119], v[64:67], a[68:71], v[116:119]
    ds_read_b128 v[52:55], v2 offset:11264
    v_fma_f32 v73, v73, s30, s30
    v_mfma_f32_16x16x32_bf16 v[116:119], v[68:71], a[76:79], v[116:119]
    v_fma_f32 v74, v74, s30, s30
    s_waitcnt lgkmcnt(4)
    v_mfma_f32_16x16x32_bf16 v[120:123], v[24:27], a[64:67], v[120:123]
    ds_read_b128 v[56:59], v2 offset:12288
    v_fma_f32 v75, v75, s30, s30
    v_mfma_f32_16x16x32_bf16 v[120:123], v[28:31], a[72:75], v[120:123]
    v_rcp_f32 v73, v73
    v_mfma_f32_16x16x32_bf16 v[124:127], v[24:27], a[68:71], v[124:127]
    ds_read_b128 v[60:63], v2 offset:13312
    v_rcp_f32 v74, v74
    v_mfma_f32_16x16x32_bf16 v[124:127], v[28:31], a[76:79], v[124:127]
    buffer_load_dwordx4 v5, s[8:11], s31 offen offset:1024 lds
    v_mfma_f32_16x16x32_bf16 v[128:131], v[32:35], a[64:67], v[128:131]
    ds_read_b128 v[64:67], v2 offset:14336
    v_mul_f32 v73, v73, v89
    v_mfma_f32_16x16x32_bf16 v[128:131], v[36:39], a[72:75], v[128:131]
    v_rcp_f32 v75, v75
    v_mfma_f32_16x16x32_bf16 v[132:135], v[32:35], a[68:71], v[132:135]
    ds_read_b128 v[68:71], v2 offset:15360
    v_mul_f32 v74, v74, v90
    v_mfma_f32_16x16x32_bf16 v[132:135], v[36:39], a[76:79], v[132:135]
    v_mul_f32 v75, v75, v91
    s_waitcnt lgkmcnt(4)
    v_mfma_f32_16x16x32_bf16 v[104:107], v[40:43], a[80:83], v[104:107]
    s_waitcnt vmcnt(11)
    s_barrier
    ds_read_b128 v[24:27], v2 offset:16384
    v_mfma_f32_16x16x32_bf16 v[104:107], v[44:47], a[88:91], v[104:107]
    v_exp_f32 v80, v80
    v_mfma_f32_16x16x32_bf16 v[108:111], v[40:43], a[84:87], v[108:111]
    ds_read_b128 v[28:31], v2 offset:17408
    v_cvt_pk_bf16_f32 v168, v72, v73
    v_mfma_f32_16x16x32_bf16 v[108:111], v[44:47], a[92:95], v[108:111]
    buffer_load_dwordx4 v5, s[8:11], s31 offen offset:2048 lds
    v_mfma_f32_16x16x32_bf16 v[112:115], v[48:51], a[80:83], v[112:115]
    ds_read_b128 v[32:35], v2 offset:18432
    v_cvt_pk_bf16_f32 v169, v74, v75
    v_mfma_f32_16x16x32_bf16 v[112:115], v[52:55], a[88:91], v[112:115]
    v_exp_f32 v81, v81
    v_mfma_f32_16x16x32_bf16 v[116:119], v[48:51], a[84:87], v[116:119]
    ds_read_b128 v[36:39], v2 offset:19456
    v_fma_f32 v80, v80, s30, s30
    v_mfma_f32_16x16x32_bf16 v[116:119], v[52:55], a[92:95], v[116:119]
    v_fma_f32 v81, v81, s30, s30
    s_waitcnt lgkmcnt(4)
    v_mfma_f32_16x16x32_bf16 v[120:123], v[56:59], a[80:83], v[120:123]
    ds_read_b128 v[40:43], v2 offset:20480
    v_mfma_f32_16x16x32_bf16 v[120:123], v[60:63], a[88:91], v[120:123]
    v_rcp_f32 v80, v80
    v_mfma_f32_16x16x32_bf16 v[124:127], v[56:59], a[84:87], v[124:127]
    ds_read_b128 v[44:47], v2 offset:21504
    v_mfma_f32_16x16x32_bf16 v[124:127], v[60:63], a[92:95], v[124:127]
    buffer_load_dwordx4 v5, s[8:11], s31 offen offset:3072 lds
    v_mfma_f32_16x16x32_bf16 v[128:131], v[64:67], a[80:83], v[128:131]
    ds_read_b128 v[48:51], v2 offset:22528
    v_mul_f32 v80, v80, v96
    v_mfma_f32_16x16x32_bf16 v[128:131], v[68:71], a[88:91], v[128:131]
    v_rcp_f32 v81, v81
    v_mfma_f32_16x16x32_bf16 v[132:135], v[64:67], a[84:87], v[132:135]
    ds_read_b128 v[52:55], v2 offset:23552
    s_add_u32 m0, s28, 114688
    v_mfma_f32_16x16x32_bf16 v[132:135], v[68:71], a[92:95], v[132:135]
    s_mov_b32 s31, 442368
    s_waitcnt lgkmcnt(4)
    v_mfma_f32_16x16x32_bf16 v[104:107], v[24:27], a[96:99], v[104:107]
    ds_read_b128 v[56:59], v2 offset:24576
    v_mul_f32 v81, v81, v97
    v_mfma_f32_16x16x32_bf16 v[104:107], v[28:31], a[104:107], v[104:107]
    v_exp_f32 v82, v82
    v_mfma_f32_16x16x32_bf16 v[108:111], v[24:27], a[100:103], v[108:111]
    ds_read_b128 v[60:63], v2 offset:25600
    v_cvt_pk_bf16_f32 v170, v80, v81
    v_mfma_f32_16x16x32_bf16 v[108:111], v[28:31], a[108:111], v[108:111]
    buffer_load_dwordx4 v5, s[8:11], s31 offen offset:0 lds
    v_mfma_f32_16x16x32_bf16 v[112:115], v[32:35], a[96:99], v[112:115]
    ds_read_b128 v[64:67], v2 offset:26624
    v_fma_f32 v82, v82, s30, s30
    v_mfma_f32_16x16x32_bf16 v[112:115], v[36:39], a[104:107], v[112:115]
    v_rcp_f32 v82, v82
    v_mfma_f32_16x16x32_bf16 v[116:119], v[32:35], a[100:103], v[116:119]
    ds_read_b128 v[68:71], v2 offset:27648
    v_mfma_f32_16x16x32_bf16 v[116:119], v[36:39], a[108:111], v[116:119]
    v_mul_f32 v82, v82, v98
    s_waitcnt lgkmcnt(4)
    v_mfma_f32_16x16x32_bf16 v[120:123], v[40:43], a[96:99], v[120:123]
    ds_read_b128 v[24:27], v2 offset:28672
    v_mfma_f32_16x16x32_bf16 v[120:123], v[44:47], a[104:107], v[120:123]
    v_exp_f32 v83, v83
    v_mfma_f32_16x16x32_bf16 v[124:127], v[40:43], a[100:103], v[124:127]
    ds_read_b128 v[28:31], v2 offset:29696
    v_mfma_f32_16x16x32_bf16 v[124:127], v[44:47], a[108:111], v[124:127]
    buffer_load_dwordx4 v5, s[8:11], s31 offen offset:1024 lds
    v_mfma_f32_16x16x32_bf16 v[128:131], v[48:51], a[96:99], v[128:131]
    ds_read_b128 v[32:35], v2 offset:30720
    v_fma_f32 v83, v83, s30, s30
    v_mfma_f32_16x16x32_bf16 v[128:131], v[52:55], a[104:107], v[128:131]
    v_rcp_f32 v83, v83
    v_mfma_f32_16x16x32_bf16 v[132:135], v[48:51], a[100:103], v[132:135]
    ds_read_b128 v[36:39], v2 offset:31744
    v_mfma_f32_16x16x32_bf16 v[132:135], v[52:55], a[108:111], v[132:135]
    v_mul_f32 v83, v83, v99
    s_waitcnt lgkmcnt(4)
    v_mfma_f32_16x16x32_bf16 v[104:107], v[56:59], a[112:115], v[104:107]
    ds_read_b128 v[40:43], v2 offset:32768
    v_cvt_pk_bf16_f32 v171, v82, v83
    v_mfma_f32_16x16x32_bf16 v[104:107], v[60:63], a[120:123], v[104:107]
    v_exp_f32 v76, v76
    v_mfma_f32_16x16x32_bf16 v[108:111], v[56:59], a[116:119], v[108:111]
    ds_read_b128 v[44:47], v2 offset:33792
    s_mov_b32 s29, 6144
    v_mfma_f32_16x16x32_bf16 v[108:111], v[60:63], a[124:127], v[108:111]
    buffer_load_dwordx4 v5, s[8:11], s31 offen offset:2048 lds
    v_mfma_f32_16x16x32_bf16 v[112:115], v[64:67], a[112:115], v[112:115]
    ds_read_b128 v[48:51], v2 offset:34816
    v_fma_f32 v76, v76, s30, s30
    v_mfma_f32_16x16x32_bf16 v[112:115], v[68:71], a[120:123], v[112:115]
    buffer_store_dwordx4 v[168:171], v8, s[8:11], s29 offen offset:0 sc1
    v_mfma_f32_16x16x32_bf16 v[116:119], v[64:67], a[116:119], v[116:119]
    ds_read_b128 v[52:55], v2 offset:35840
    v_mfma_f32_16x16x32_bf16 v[116:119], v[68:71], a[124:127], v[116:119]
    s_waitcnt lgkmcnt(4)
    v_mfma_f32_16x16x32_bf16 v[120:123], v[24:27], a[112:115], v[120:123]
    ds_read_b128 v[56:59], v2 offset:36864
    v_mfma_f32_16x16x32_bf16 v[120:123], v[28:31], a[120:123], v[120:123]
    v_rcp_f32 v76, v76
    v_mfma_f32_16x16x32_bf16 v[124:127], v[24:27], a[116:119], v[124:127]
    ds_read_b128 v[60:63], v2 offset:37888
    v_mfma_f32_16x16x32_bf16 v[124:127], v[28:31], a[124:127], v[124:127]
    buffer_load_dwordx4 v5, s[8:11], s31 offen offset:3072 lds
    v_mfma_f32_16x16x32_bf16 v[128:131], v[32:35], a[112:115], v[128:131]
    ds_read_b128 v[64:67], v2 offset:38912
    v_mul_f32 v76, v76, v92
    v_mfma_f32_16x16x32_bf16 v[128:131], v[36:39], a[120:123], v[128:131]
    v_exp_f32 v77, v77
    v_mfma_f32_16x16x32_bf16 v[132:135], v[32:35], a[116:119], v[132:135]
    ds_read_b128 v[68:71], v2 offset:39936
    s_add_u32 m0, s28, 131072
    v_mfma_f32_16x16x32_bf16 v[132:135], v[36:39], a[124:127], v[132:135]
    s_mov_b32 s31, 458752
    s_waitcnt lgkmcnt(4)
    v_mfma_f32_16x16x32_bf16 v[104:107], v[40:43], a[128:131], v[104:107]
    ds_read_b128 v[24:27], v2 offset:40960
    v_fma_f32 v77, v77, s30, s30
    v_mfma_f32_16x16x32_bf16 v[104:107], v[44:47], a[136:139], v[104:107]
    v_rcp_f32 v77, v77
    v_mfma_f32_16x16x32_bf16 v[108:111], v[40:43], a[132:135], v[108:111]
    ds_read_b128 v[28:31], v2 offset:41984
    v_mfma_f32_16x16x32_bf16 v[108:111], v[44:47], a[140:143], v[108:111]
    buffer_load_dwordx4 v5, s[8:11], s31 offen offset:0 lds
    v_mfma_f32_16x16x32_bf16 v[112:115], v[48:51], a[128:131], v[112:115]
    ds_read_b128 v[32:35], v2 offset:43008
    v_mul_f32 v77, v77, v93
    v_mfma_f32_16x16x32_bf16 v[112:115], v[52:55], a[136:139], v[112:115]
    v_exp_f32 v78, v78
    v_mfma_f32_16x16x32_bf16 v[116:119], v[48:51], a[132:135], v[116:119]
    ds_read_b128 v[36:39], v2 offset:44032
    v_cvt_pk_bf16_f32 v172, v76, v77
    v_mfma_f32_16x16x32_bf16 v[116:119], v[52:55], a[140:143], v[116:119]
    v_fma_f32 v78, v78, s30, s30
    s_waitcnt lgkmcnt(4)
    v_mfma_f32_16x16x32_bf16 v[120:123], v[56:59], a[128:131], v[120:123]
    ds_read_b128 v[40:43], v2 offset:45056
    v_mfma_f32_16x16x32_bf16 v[120:123], v[60:63], a[136:139], v[120:123]
    v_rcp_f32 v78, v78
    v_mfma_f32_16x16x32_bf16 v[124:127], v[56:59], a[132:135], v[124:127]
    ds_read_b128 v[44:47], v2 offset:46080
    v_mfma_f32_16x16x32_bf16 v[124:127], v[60:63], a[140:143], v[124:127]
    buffer_load_dwordx4 v5, s[8:11], s31 offen offset:1024 lds
    v_mfma_f32_16x16x32_bf16 v[128:131], v[64:67], a[128:131], v[128:131]
    ds_read_b128 v[48:51], v2 offset:47104
    v_mul_f32 v78, v78, v94
    v_mfma_f32_16x16x32_bf16 v[128:131], v[68:71], a[136:139], v[128:131]
    v_exp_f32 v79, v79
    v_mfma_f32_16x16x32_bf16 v[132:135], v[64:67], a[132:135], v[132:135]
    ds_read_b128 v[52:55], v2 offset:48128
    v_mfma_f32_16x16x32_bf16 v[132:135], v[68:71], a[140:143], v[132:135]
    v_fma_f32 v79, v79, s30, s30
    s_waitcnt lgkmcnt(4)
    v_mfma_f32_16x16x32_bf16 v[216:219], v[24:27], a[0:3], 0
    ds_read_b128 v[56:59], v2 offset:49152
    v_mfma_f32_16x16x32_bf16 v[216:219], v[28:31], a[8:11], v[216:219]
    v_rcp_f32 v79, v79
    v_mfma_f32_16x16x32_bf16 v[220:223], v[24:27], a[4:7], 0
    ds_read_b128 v[60:63], v2 offset:50176
    v_mfma_f32_16x16x32_bf16 v[220:223], v[28:31], a[12:15], v[220:223]
    buffer_load_dwordx4 v5, s[8:11], s31 offen offset:2048 lds
    v_mfma_f32_16x16x32_bf16 v[224:227], v[32:35], a[0:3], 0
    ds_read_b128 v[64:67], v2 offset:51200
    v_mul_f32 v79, v79, v95
    v_mfma_f32_16x16x32_bf16 v[224:227], v[36:39], a[8:11], v[224:227]
    v_exp_f32 v84, v84
    v_mfma_f32_16x16x32_bf16 v[228:231], v[32:35], a[4:7], 0
    ds_read_b128 v[68:71], v2 offset:52224
    v_cvt_pk_bf16_f32 v173, v78, v79
    v_mfma_f32_16x16x32_bf16 v[228:231], v[36:39], a[12:15], v[228:231]
    v_fma_f32 v84, v84, s30, s30
    s_waitcnt lgkmcnt(4)
    v_mfma_f32_16x16x32_bf16 v[232:235], v[40:43], a[0:3], 0
    ds_read_b128 v[24:27], v2 offset:53248
    v_mfma_f32_16x16x32_bf16 v[232:235], v[44:47], a[8:11], v[232:235]
    v_rcp_f32 v84, v84
    v_mfma_f32_16x16x32_bf16 v[236:239], v[40:43], a[4:7], 0
    ds_read_b128 v[28:31], v2 offset:54272
    v_mfma_f32_16x16x32_bf16 v[236:239], v[44:47], a[12:15], v[236:239]
    buffer_load_dwordx4 v5, s[8:11], s31 offen offset:3072 lds
    v_mfma_f32_16x16x32_bf16 v[240:243], v[48:51], a[0:3], 0
    ds_read_b128 v[32:35], v2 offset:55296
    v_mul_f32 v84, v84, v100
    v_mfma_f32_16x16x32_bf16 v[240:243], v[52:55], a[8:11], v[240:243]
    v_exp_f32 v85, v85
    v_mfma_f32_16x16x32_bf16 v[244:247], v[48:51], a[4:7], 0
    ds_read_b128 v[36:39], v2 offset:56320
    s_add_u32 m0, s28, 147456
    v_mfma_f32_16x16x32_bf16 v[244:247], v[52:55], a[12:15], v[244:247]
    s_mov_b32 s31, 475136
    s_waitcnt lgkmcnt(4)
    v_mfma_f32_16x16x32_bf16 v[216:219], v[56:59], a[16:19], v[216:219]
    ds_read_b128 v[40:43], v2 offset:57344
    v_fma_f32 v85, v85, s30, s30
    v_mfma_f32_16x16x32_bf16 v[216:219], v[60:63], a[24:27], v[216:219]
    v_rcp_f32 v85, v85
    v_mfma_f32_16x16x32_bf16 v[220:223], v[56:59], a[20:23], v[220:223]
    ds_read_b128 v[44:47], v2 offset:58368
    v_mfma_f32_16x16x32_bf16 v[220:223], v[60:63], a[28:31], v[220:223]
    buffer_load_dwordx4 v5, s[8:11], s31 offen offset:0 lds
    v_mfma_f32_16x16x32_bf16 v[224:227], v[64:67], a[16:19], v[224:227]
    ds_read_b128 v[48:51], v2 offset:59392
    v_mul_f32 v85, v85, v101
    v_mfma_f32_16x16x32_bf16 v[224:227], v[68:71], a[24:27], v[224:227]
    v_exp_f32 v86, v86
    v_mfma_f32_16x16x32_bf16 v[228:231], v[64:67], a[20:23], v[228:231]
    ds_read_b128 v[52:55], v2 offset:60416
    v_cvt_pk_bf16_f32 v174, v84, v85
    v_mfma_f32_16x16x32_bf16 v[228:231], v[68:71], a[28:31], v[228:231]
    v_fma_f32 v86, v86, s30, s30
    s_waitcnt lgkmcnt(4)
    v_mfma_f32_16x16x32_bf16 v[232:235], v[24:27], a[16:19], v[232:235]
    ds_read_b128 v[56:59], v2 offset:61440
    v_mfma_f32_16x16x32_bf16 v[232:235], v[28:31], a[24:27], v[232:235]
    v_rcp_f32 v86, v86
    v_mfma_f32_16x16x32_bf16 v[236:239], v[24:27], a[20:23], v[236:239]
    ds_read_b128 v[60:63], v2 offset:62464
    v_mfma_f32_16x16x32_bf16 v[236:239], v[28:31], a[28:31], v[236:239]
    buffer_load_dwordx4 v5, s[8:11], s31 offen offset:1024 lds
    v_mfma_f32_16x16x32_bf16 v[240:243], v[32:35], a[16:19], v[240:243]
    ds_read_b128 v[64:67], v2 offset:63488
    v_mul_f32 v86, v86, v102
    v_mfma_f32_16x16x32_bf16 v[240:243], v[36:39], a[24:27], v[240:243]
    v_exp_f32 v87, v87
    v_mfma_f32_16x16x32_bf16 v[244:247], v[32:35], a[20:23], v[244:247]
    ds_read_b128 v[68:71], v2 offset:64512
    v_mfma_f32_16x16x32_bf16 v[244:247], v[36:39], a[28:31], v[244:247]
    v_fma_f32 v87, v87, s30, s30
    s_waitcnt lgkmcnt(4)
    v_mfma_f32_16x16x32_bf16 v[216:219], v[40:43], a[32:35], v[216:219]
    s_waitcnt vmcnt(11)
    s_barrier
    ds_read_b128 v[24:27], v3 offset:0
    v_mfma_f32_16x16x32_bf16 v[216:219], v[44:47], a[40:43], v[216:219]
    v_rcp_f32 v87, v87
    v_mfma_f32_16x16x32_bf16 v[220:223], v[40:43], a[36:39], v[220:223]
    ds_read_b128 v[28:31], v3 offset:1024
    v_mfma_f32_16x16x32_bf16 v[220:223], v[44:47], a[44:47], v[220:223]
    buffer_load_dwordx4 v5, s[8:11], s31 offen offset:2048 lds
    v_mfma_f32_16x16x32_bf16 v[224:227], v[48:51], a[32:35], v[224:227]
    ds_read_b128 v[32:35], v3 offset:2048
    v_mul_f32 v87, v87, v103
    v_mfma_f32_16x16x32_bf16 v[224:227], v[52:55], a[40:43], v[224:227]
    v_exp_f32 v104, v104
    v_mfma_f32_16x16x32_bf16 v[228:231], v[48:51], a[36:39], v[228:231]
    ds_read_b128 v[36:39], v3 offset:3072
    v_cvt_pk_bf16_f32 v175, v86, v87
    v_mfma_f32_16x16x32_bf16 v[228:231], v[52:55], a[44:47], v[228:231]
    s_mov_b32 s29, 6144
    s_waitcnt lgkmcnt(4)
    v_mfma_f32_16x16x32_bf16 v[232:235], v[56:59], a[32:35], v[232:235]
    ds_read_b128 v[40:43], v3 offset:4096
    v_fma_f32 v104, v104, s30, s30
    v_mfma_f32_16x16x32_bf16 v[232:235], v[60:63], a[40:43], v[232:235]
    buffer_store_dwordx4 v[172:175], v8, s[8:11], s29 offen offset:1024 sc1
    v_mfma_f32_16x16x32_bf16 v[236:239], v[56:59], a[36:39], v[236:239]
    ds_read_b128 v[44:47], v3 offset:5120
    v_rcp_f32 v104, v104
    v_mfma_f32_16x16x32_bf16 v[236:239], v[60:63], a[44:47], v[236:239]
    buffer_load_dwordx4 v5, s[8:11], s31 offen offset:3072 lds
    v_mfma_f32_16x16x32_bf16 v[240:243], v[64:67], a[32:35], v[240:243]
    ds_read_b128 v[48:51], v3 offset:6144
    v_mul_f32 v104, v104, v120
    v_mfma_f32_16x16x32_bf16 v[240:243], v[68:71], a[40:43], v[240:243]
    v_exp_f32 v105, v105
    v_mfma_f32_16x16x32_bf16 v[244:247], v[64:67], a[36:39], v[244:247]
    ds_read_b128 v[52:55], v3 offset:7168
    v_exp_f32 v106, v106
    v_mfma_f32_16x16x32_bf16 v[244:247], v[68:71], a[44:47], v[244:247]
    s_add_u32 m0, s28, 0
    s_waitcnt lgkmcnt(4)
    v_mfma_f32_16x16x32_bf16 v[216:219], v[24:27], a[48:51], v[216:219]
    ds_read_b128 v[56:59], v3 offset:8192
    s_mov_b32 s31, 491520
    v_mfma_f32_16x16x32_bf16 v[216:219], v[28:31], a[56:59], v[216:219]
    v_exp_f32 v107, v107
    v_mfma_f32_16x16x32_bf16 v[220:223], v[24:27], a[52:55], v[220:223]
    ds_read_b128 v[60:63], v3 offset:9216
    v_fma_f32 v105, v105, s30, s30
    v_mfma_f32_16x16x32_bf16 v[220:223], v[28:31], a[60:63], v[220:223]
    buffer_load_dwordx4 v5, s[8:11], s31 offen offset:0 lds
    v_mfma_f32_16x16x32_bf16 v[224:227], v[32:35], a[48:51], v[224:227]
    ds_read_b128 v[64:67], v3 offset:10240
    v_fma_f32 v106, v106, s30, s30
    v_mfma_f32_16x16x32_bf16 v[224:227], v[36:39], a[56:59], v[224:227]
    v_rcp_f32 v105, v105
    v_mfma_f32_16x16x32_bf16 v[228:231], v[32:35], a[52:55], v[228:231]
    ds_read_b128 v[68:71], v3 offset:11264
    v_fma_f32 v107, v107, s30, s30
    v_mfma_f32_16x16x32_bf16 v[228:231], v[36:39], a[60:63], v[228:231]
    v_mul_f32 v105, v105, v121
    s_waitcnt lgkmcnt(4)
    v_mfma_f32_16x16x32_bf16 v[232:235], v[40:43], a[48:51], v[232:235]
    ds_read_b128 v[24:27], v3 offset:12288
    v_cvt_pk_bf16_f32 v176, v104, v105
    v_mfma_f32_16x16x32_bf16 v[232:235], v[44:47], a[56:59], v[232:235]
    v_rcp_f32 v106, v106
    v_mfma_f32_16x16x32_bf16 v[236:239], v[40:43], a[52:55], v[236:239]
    ds_read_b128 v[28:31], v3 offset:13312
    v_rcp_f32 v107, v107
    v_mfma_f32_16x16x32_bf16 v[236:239], v[44:47], a[60:63], v[236:239]
    buffer_load_dwordx4 v5, s[8:11], s31 offen offset:1024 lds
    v_mfma_f32_16x16x32_bf16 v[240:243], v[48:51], a[48:51], v[240:243]
    ds_read_b128 v[32:35], v3 offset:14336
    v_mul_f32 v106, v106, v122
    v_mfma_f32_16x16x32_bf16 v[240:243], v[52:55], a[56:59], v[240:243]
    v_exp_f32 v112, v112
    v_mfma_f32_16x16x32_bf16 v[244:247], v[48:51], a[52:55], v[244:247]
    ds_read_b128 v[36:39], v3 offset:15360
    v_mul_f32 v107, v107, v123
    v_mfma_f32_16x16x32_bf16 v[244:247], v[52:55], a[60:63], v[244:247]
    v_cvt_pk_bf16_f32 v177, v106, v107
    s_waitcnt lgkmcnt(4)
    v_mfma_f32_16x16x32_bf16 v[216:219], v[56:59], a[64:67], v[216:219]
    ds_read_b128 v[40:43], v3 offset:16384
    v_fma_f32 v112, v112, s30, s30
    v_mfma_f32_16x16x32_bf16 v[216:219], v[60:63], a[72:75], v[216:219]
    v_rcp_f32 v112, v112
    v_mfma_f32_16x16x32_bf16 v[220:223], v[56:59], a[68:71], v[220:223]
    ds_read_b128 v[44:47], v3 offset:17408
    v_mfma_f32_16x16x32_bf16 v[220:223], v[60:63], a[76:79], v[220:223]
    buffer_load_dwordx4 v5, s[8:11], s31 offen offset:2048 lds
    v_mfma_f32_16x16x32_bf16 v[224:227], v[64:67], a[64:67], v[224:227]
    ds_read_b128 v[48:51], v3 offset:18432
    v_mul_f32 v112, v112, v128
    v_mfma_f32_16x16x32_bf16 v[224:227], v[68:71], a[72:75], v[224:227]
    v_exp_f32 v113, v113
    v_mfma_f32_16x16x32_bf16 v[228:231], v[64:67], a[68:71], v[228:231]
    ds_read_b128 v[52:55], v3 offset:19456
    v_mfma_f32_16x16x32_bf16 v[228:231], v[68:71], a[76:79], v[228:231]
    v_fma_f32 v113, v113, s30, s30
    s_waitcnt lgkmcnt(4)
    v_mfma_f32_16x16x32_bf16 v[232:235], v[24:27], a[64:67], v[232:235]
    ds_read_b128 v[56:59], v3 offset:20480
    v_mfma_f32_16x16x32_bf16 v[232:235], v[28:31], a[72:75], v[232:235]
    v_rcp_f32 v113, v113
    v_mfma_f32_16x16x32_bf16 v[236:239], v[24:27], a[68:71], v[236:239]
    ds_read_b128 v[60:63], v3 offset:21504
    v_mfma_f32_16x16x32_bf16 v[236:239], v[28:31], a[76:79], v[236:239]
    buffer_load_dwordx4 v5, s[8:11], s31 offen offset:3072 lds
    v_mfma_f32_16x16x32_bf16 v[240:243], v[32:35], a[64:67], v[240:243]
    ds_read_b128 v[64:67], v3 offset:22528
    v_mul_f32 v113, v113, v129
    v_mfma_f32_16x16x32_bf16 v[240:243], v[36:39], a[72:75], v[240:243]
    v_exp_f32 v114, v114
    v_mfma_f32_16x16x32_bf16 v[244:247], v[32:35], a[68:71], v[244:247]
    ds_read_b128 v[68:71], v3 offset:23552
    s_add_u32 m0, s28, 16384
    v_mfma_f32_16x16x32_bf16 v[244:247], v[36:39], a[76:79], v[244:247]
    s_mov_b32 s31, 507904
    s_waitcnt lgkmcnt(4)
    v_mfma_f32_16x16x32_bf16 v[216:219], v[40:43], a[80:83], v[216:219]
    ds_read_b128 v[24:27], v3 offset:24576
    v_fma_f32 v114, v114, s30, s30
    v_mfma_f32_16x16x32_bf16 v[216:219], v[44:47], a[88:91], v[216:219]
    v_rcp_f32 v114, v114
    v_mfma_f32_16x16x32_bf16 v[220:223], v[40:43], a[84:87], v[220:223]
    ds_read_b128 v[28:31], v3 offset:25600
    v_cvt_pk_bf16_f32 v178, v112, v113
    v_mfma_f32_16x16x32_bf16 v[220:223], v[44:47], a[92:95], v[220:223]
    buffer_load_dwordx4 v5, s[8:11], s31 offen offset:0 lds
    v_mfma_f32_16x16x32_bf16 v[224:227], v[48:51], a[80:83], v[224:227]
    ds_read_b128 v[32:35], v3 offset:26624
    v_mul_f32 v114, v114, v130
k4_kernel_j505:
    v_mfma_f32_16x16x32_bf16 v[224:227], v[52:55], a[88:91], v[224:227]
    v_exp_f32 v115, v115
    v_mfma_f32_16x16x32_bf16 v[228:231], v[48:51], a[84:87], v[228:231]
    ds_read_b128 v[36:39], v3 offset:27648
    v_mfma_f32_16x16x32_bf16 v[228:231], v[52:55], a[92:95], v[228:231]
    v_fma_f32 v115, v115, s30, s30
    s_waitcnt lgkmcnt(4)
    v_mfma_f32_16x16x32_bf16 v[232:235], v[56:59], a[80:83], v[232:235]
    ds_read_b128 v[40:43], v3 offset:28672
    v_mfma_f32_16x16x32_bf16 v[232:235], v[60:63], a[88:91], v[232:235]
    v_rcp_f32 v115, v115
    v_mfma_f32_16x16x32_bf16 v[236:239], v[56:59], a[84:87], v[236:239]
    ds_read_b128 v[44:47], v3 offset:29696
    v_mfma_f32_16x16x32_bf16 v[236:239], v[60:63], a[92:95], v[236:239]
    buffer_load_dwordx4 v5, s[8:11], s31 offen offset:1024 lds
    v_mfma_f32_16x16x32_bf16 v[240:243], v[64:67], a[80:83], v[240:243]
    ds_read_b128 v[48:51], v3 offset:30720
    v_mul_f32 v115, v115, v131
    v_mfma_f32_16x16x32_bf16 v[240:243], v[68:71], a[88:91], v[240:243]
    v_exp_f32 v108, v108
    v_mfma_f32_16x16x32_bf16 v[244:247], v[64:67], a[84:87], v[244:247]
    ds_read_b128 v[52:55], v3 offset:31744
    v_cvt_pk_bf16_f32 v179, v114, v115
    v_mfma_f32_16x16x32_bf16 v[244:247], v[68:71], a[92:95], v[244:247]
    s_mov_b32 s29, 8192
    s_waitcnt lgkmcnt(4)
    v_mfma_f32_16x16x32_bf16 v[216:219], v[24:27], a[96:99], v[216:219]
    ds_read_b128 v[56:59], v3 offset:32768
    v_fma_f32 v108, v108, s30, s30
    v_mfma_f32_16x16x32_bf16 v[216:219], v[28:31], a[104:107], v[216:219]
    buffer_store_dwordx4 v[176:179], v8, s[8:11], s29 offen offset:0 sc1
    v_mfma_f32_16x16x32_bf16 v[220:223], v[24:27], a[100:103], v[220:223]
    ds_read_b128 v[60:63], v3 offset:33792
    v_mfma_f32_16x16x32_bf16 v[220:223], v[28:31], a[108:111], v[220:223]
    buffer_load_dwordx4 v5, s[8:11], s31 offen offset:2048 lds
    v_mfma_f32_16x16x32_bf16 v[224:227], v[32:35], a[96:99], v[224:227]
    ds_read_b128 v[64:67], v3 offset:34816
    v_mfma_f32_16x16x32_bf16 v[224:227], v[36:39], a[104:107], v[224:227]
    v_rcp_f32 v108, v108
    v_mfma_f32_16x16x32_bf16 v[228:231], v[32:35], a[100:103], v[228:231]
    ds_read_b128 v[68:71], v3 offset:35840
    v_mfma_f32_16x16x32_bf16 v[228:231], v[36:39], a[108:111], v[228:231]
    v_mul_f32 v108, v108, v124
    s_waitcnt lgkmcnt(4)
    v_mfma_f32_16x16x32_bf16 v[232:235], v[40:43], a[96:99], v[232:235]
    ds_read_b128 v[24:27], v3 offset:36864
    v_mfma_f32_16x16x32_bf16 v[232:235], v[44:47], a[104:107], v[232:235]
    v_exp_f32 v109, v109
    v_mfma_f32_16x16x32_bf16 v[236:239], v[40:43], a[100:103], v[236:239]
    ds_read_b128 v[28:31], v3 offset:37888
    v_mfma_f32_16x16x32_bf16 v[236:239], v[44:47], a[108:111], v[236:239]
    buffer_load_dwordx4 v5, s[8:11], s31 offen offset:3072 lds
    v_mfma_f32_16x16x32_bf16 v[240:243], v[48:51], a[96:99], v[240:243]
    ds_read_b128 v[32:35], v3 offset:38912
    v_fma_f32 v109, v109, s30, s30
    v_mfma_f32_16x16x32_bf16 v[240:243], v[52:55], a[104:107], v[240:243]
    v_rcp_f32 v109, v109
    v_mfma_f32_16x16x32_bf16 v[244:247], v[48:51], a[100:103], v[244:247]
    ds_read_b128 v[36:39], v3 offset:39936
    s_add_u32 m0, s28, 32768
    v_mfma_f32_16x16x32_bf16 v[244:247], v[52:55], a[108:111], v[244:247]
    s_mov_b32 s31, 524288
    s_waitcnt lgkmcnt(4)
    v_mfma_f32_16x16x32_bf16 v[216:219], v[56:59], a[112:115], v[216:219]
    ds_read_b128 v[40:43], v3 offset:40960
    v_mul_f32 v109, v109, v125
    v_mfma_f32_16x16x32_bf16 v[216:219], v[60:63], a[120:123], v[216:219]
    v_exp_f32 v110, v110
    v_mfma_f32_16x16x32_bf16 v[220:223], v[56:59], a[116:119], v[220:223]
    ds_read_b128 v[44:47], v3 offset:41984
    v_cvt_pk_bf16_f32 v180, v108, v109
    v_mfma_f32_16x16x32_bf16 v[220:223], v[60:63], a[124:127], v[220:223]
    buffer_load_dwordx4 v5, s[8:11], s31 offen offset:0 lds
    v_mfma_f32_16x16x32_bf16 v[224:227], v[64:67], a[112:115], v[224:227]
    ds_read_b128 v[48:51], v3 offset:43008
    v_fma_f32 v110, v110, s30, s30
    v_mfma_f32_16x16x32_bf16 v[224:227], v[68:71], a[120:123], v[224:227]
    s_waitcnt vmcnt(11)
    buffer_store_dword v13, v9, s[8:11], s47 offen sc1
    v_mfma_f32_16x16x32_bf16 v[228:231], v[64:67], a[116:119], v[228:231]
    ds_read_b128 v[52:55], v3 offset:44032
    v_mfma_f32_16x16x32_bf16 v[228:231], v[68:71], a[124:127], v[228:231]
    s_waitcnt lgkmcnt(4)
    v_mfma_f32_16x16x32_bf16 v[232:235], v[24:27], a[112:115], v[232:235]
    ds_read_b128 v[56:59], v3 offset:45056
    v_mfma_f32_16x16x32_bf16 v[232:235], v[28:31], a[120:123], v[232:235]
    v_rcp_f32 v110, v110
    v_mfma_f32_16x16x32_bf16 v[236:239], v[24:27], a[116:119], v[236:239]
    ds_read_b128 v[60:63], v3 offset:46080
    v_mfma_f32_16x16x32_bf16 v[236:239], v[28:31], a[124:127], v[236:239]
    buffer_load_dwordx4 v5, s[8:11], s31 offen offset:1024 lds
    v_mfma_f32_16x16x32_bf16 v[240:243], v[32:35], a[112:115], v[240:243]
    ds_read_b128 v[64:67], v3 offset:47104
    v_mul_f32 v110, v110, v126
    v_mfma_f32_16x16x32_bf16 v[240:243], v[36:39], a[120:123], v[240:243]
    v_exp_f32 v111, v111
    v_mfma_f32_16x16x32_bf16 v[244:247], v[32:35], a[116:119], v[244:247]
    ds_read_b128 v[68:71], v3 offset:48128
    v_mfma_f32_16x16x32_bf16 v[244:247], v[36:39], a[124:127], v[244:247]
    v_fma_f32 v111, v111, s30, s30
    s_waitcnt lgkmcnt(4)
    v_mfma_f32_16x16x32_bf16 v[216:219], v[40:43], a[128:131], v[216:219]
    s_waitcnt vmcnt(12)
    s_barrier
    ds_read_b128 v[24:27], v3 offset:49152
    v_mfma_f32_16x16x32_bf16 v[216:219], v[44:47], a[136:139], v[216:219]
    v_rcp_f32 v111, v111
    v_mfma_f32_16x16x32_bf16 v[220:223], v[40:43], a[132:135], v[220:223]
    ds_read_b128 v[28:31], v3 offset:50176
    v_mfma_f32_16x16x32_bf16 v[220:223], v[44:47], a[140:143], v[220:223]
    buffer_load_dwordx4 v5, s[8:11], s31 offen offset:2048 lds
    v_mfma_f32_16x16x32_bf16 v[224:227], v[48:51], a[128:131], v[224:227]
    ds_read_b128 v[32:35], v3 offset:51200
    v_mul_f32 v111, v111, v127
    v_mfma_f32_16x16x32_bf16 v[224:227], v[52:55], a[136:139], v[224:227]
    v_exp_f32 v116, v116
    v_mfma_f32_16x16x32_bf16 v[228:231], v[48:51], a[132:135], v[228:231]
    ds_read_b128 v[36:39], v3 offset:52224
    v_cvt_pk_bf16_f32 v181, v110, v111
    v_mfma_f32_16x16x32_bf16 v[228:231], v[52:55], a[140:143], v[228:231]
    v_fma_f32 v116, v116, s30, s30
    s_waitcnt lgkmcnt(4)
    v_mfma_f32_16x16x32_bf16 v[232:235], v[56:59], a[128:131], v[232:235]
    ds_read_b128 v[40:43], v3 offset:53248
    v_mfma_f32_16x16x32_bf16 v[232:235], v[60:63], a[136:139], v[232:235]
    v_rcp_f32 v116, v116
    v_mfma_f32_16x16x32_bf16 v[236:239], v[56:59], a[132:135], v[236:239]
    ds_read_b128 v[44:47], v3 offset:54272
    v_mfma_f32_16x16x32_bf16 v[236:239], v[60:63], a[140:143], v[236:239]
    buffer_load_dwordx4 v5, s[8:11], s31 offen offset:3072 lds
    v_mfma_f32_16x16x32_bf16 v[240:243], v[64:67], a[128:131], v[240:243]
    ds_read_b128 v[48:51], v3 offset:55296
    v_mul_f32 v116, v116, v132
    v_mfma_f32_16x16x32_bf16 v[240:243], v[68:71], a[136:139], v[240:243]
    v_exp_f32 v117, v117
    v_mfma_f32_16x16x32_bf16 v[244:247], v[64:67], a[132:135], v[244:247]
    ds_read_b128 v[52:55], v3 offset:56320
    s_add_u32 m0, s28, 49152
    v_mfma_f32_16x16x32_bf16 v[244:247], v[68:71], a[140:143], v[244:247]
    s_mov_b32 s31, 540672
    s_waitcnt lgkmcnt(4)
    v_mfma_f32_16x16x32_bf16 v[72:75], v[24:27], a[0:3], 0
    ds_read_b128 v[56:59], v3 offset:57344
    v_fma_f32 v117, v117, s30, s30
    v_mfma_f32_16x16x32_bf16 v[72:75], v[28:31], a[8:11], v[72:75]
    v_rcp_f32 v117, v117
    v_mfma_f32_16x16x32_bf16 v[76:79], v[24:27], a[4:7], 0
    ds_read_b128 v[60:63], v3 offset:58368
    v_mfma_f32_16x16x32_bf16 v[76:79], v[28:31], a[12:15], v[76:79]
    buffer_load_dwordx4 v5, s[8:11], s31 offen offset:0 lds
    v_mfma_f32_16x16x32_bf16 v[80:83], v[32:35], a[0:3], 0
    ds_read_b128 v[64:67], v3 offset:59392
    v_mul_f32 v117, v117, v133
    v_mfma_f32_16x16x32_bf16 v[80:83], v[36:39], a[8:11], v[80:83]
    v_exp_f32 v118, v118
    v_mfma_f32_16x16x32_bf16 v[84:87], v[32:35], a[4:7], 0
    ds_read_b128 v[68:71], v3 offset:60416
    v_cvt_pk_bf16_f32 v182, v116, v117
    v_mfma_f32_16x16x32_bf16 v[84:87], v[36:39], a[12:15], v[84:87]
    v_fma_f32 v118, v118, s30, s30
    s_waitcnt lgkmcnt(4)
    v_mfma_f32_16x16x32_bf16 v[88:91], v[40:43], a[0:3], 0
    ds_read_b128 v[24:27], v3 offset:61440
    v_mfma_f32_16x16x32_bf16 v[88:91], v[44:47], a[8:11], v[88:91]
    buffer_load_dword v16, v255, s[8:11], 0 offen sc1
    v_mfma_f32_16x16x32_bf16 v[92:95], v[40:43], a[4:7], 0
    ds_read_b128 v[28:31], v3 offset:62464
    v_mfma_f32_16x16x32_bf16 v[92:95], v[44:47], a[12:15], v[92:95]
    buffer_load_dwordx4 v5, s[8:11], s31 offen offset:1024 lds
    v_mfma_f32_16x16x32_bf16 v[96:99], v[48:51], a[0:3], 0
    ds_read_b128 v[32:35], v3 offset:63488
    v_mfma_f32_16x16x32_bf16 v[96:99], v[52:55], a[8:11], v[96:99]
    v_rcp_f32 v118, v118
    v_mfma_f32_16x16x32_bf16 v[100:103], v[48:51], a[4:7], 0
    ds_read_b128 v[36:39], v3 offset:64512
    v_mfma_f32_16x16x32_bf16 v[100:103], v[52:55], a[12:15], v[100:103]
    v_mul_f32 v118, v118, v134
    s_waitcnt lgkmcnt(4)
    v_mfma_f32_16x16x32_bf16 v[72:75], v[56:59], a[16:19], v[72:75]
    ds_read_b128 v[40:43], v4 offset:0
    v_mfma_f32_16x16x32_bf16 v[72:75], v[60:63], a[24:27], v[72:75]
    v_exp_f32 v119, v119
    v_mfma_f32_16x16x32_bf16 v[76:79], v[56:59], a[20:23], v[76:79]
    ds_read_b128 v[44:47], v4 offset:1024
    v_mfma_f32_16x16x32_bf16 v[76:79], v[60:63], a[28:31], v[76:79]
    buffer_load_dwordx4 v5, s[8:11], s31 offen offset:2048 lds
    v_mfma_f32_16x16x32_bf16 v[80:83], v[64:67], a[16:19], v[80:83]
    ds_read_b128 v[48:51], v4 offset:2048
    v_fma_f32 v119, v119, s30, s30
    v_mfma_f32_16x16x32_bf16 v[80:83], v[68:71], a[24:27], v[80:83]
    v_rcp_f32 v119, v119
    v_mfma_f32_16x16x32_bf16 v[84:87], v[64:67], a[20:23], v[84:87]
    ds_read_b128 v[52:55], v4 offset:3072
    v_mfma_f32_16x16x32_bf16 v[84:87], v[68:71], a[28:31], v[84:87]
    v_mul_f32 v119, v119, v135
    s_waitcnt lgkmcnt(4)
    v_mfma_f32_16x16x32_bf16 v[88:91], v[24:27], a[16:19], v[88:91]
    ds_read_b128 v[56:59], v4 offset:4096
    v_cvt_pk_bf16_f32 v183, v118, v119
    v_mfma_f32_16x16x32_bf16 v[88:91], v[28:31], a[24:27], v[88:91]
    v_exp_f32 v216, v216
    v_mfma_f32_16x16x32_bf16 v[92:95], v[24:27], a[20:23], v[92:95]
    ds_read_b128 v[60:63], v4 offset:5120
    s_mov_b32 s29, 8192
    v_mfma_f32_16x16x32_bf16 v[92:95], v[28:31], a[28:31], v[92:95]
    buffer_load_dwordx4 v5, s[8:11], s31 offen offset:3072 lds
    v_mfma_f32_16x16x32_bf16 v[96:99], v[32:35], a[16:19], v[96:99]
    ds_read_b128 v[64:67], v4 offset:6144
    v_fma_f32 v216, v216, s30, s30
    v_mfma_f32_16x16x32_bf16 v[96:99], v[36:39], a[24:27], v[96:99]
    buffer_store_dwordx4 v[180:183], v8, s[8:11], s29 offen offset:1024 sc1
    v_mfma_f32_16x16x32_bf16 v[100:103], v[32:35], a[20:23], v[100:103]
    ds_read_b128 v[68:71], v4 offset:7168
    v_rcp_f32 v216, v216
    v_mfma_f32_16x16x32_bf16 v[100:103], v[36:39], a[28:31], v[100:103]
    v_exp_f32 v217, v217
    s_waitcnt lgkmcnt(4)
    v_mfma_f32_16x16x32_bf16 v[72:75], v[40:43], a[32:35], v[72:75]
    ds_read_b128 v[24:27], v4 offset:8192
    s_add_u32 m0, s28, 65536
    v_mfma_f32_16x16x32_bf16 v[72:75], v[44:47], a[40:43], v[72:75]
    v_exp_f32 v218, v218
    v_mfma_f32_16x16x32_bf16 v[76:79], v[40:43], a[36:39], v[76:79]
    ds_read_b128 v[28:31], v4 offset:9216
    s_mov_b32 s31, 557056
    v_mfma_f32_16x16x32_bf16 v[76:79], v[44:47], a[44:47], v[76:79]
    buffer_load_dwordx4 v5, s[8:11], s31 offen offset:0 lds
    v_mfma_f32_16x16x32_bf16 v[80:83], v[48:51], a[32:35], v[80:83]
    ds_read_b128 v[32:35], v4 offset:10240
    v_mul_f32 v216, v216, v232
    v_mfma_f32_16x16x32_bf16 v[80:83], v[52:55], a[40:43], v[80:83]
    v_exp_f32 v219, v219
    v_mfma_f32_16x16x32_bf16 v[84:87], v[48:51], a[36:39], v[84:87]
    ds_read_b128 v[36:39], v4 offset:11264
    v_fma_f32 v217, v217, s30, s30
    v_mfma_f32_16x16x32_bf16 v[84:87], v[52:55], a[44:47], v[84:87]
    v_fma_f32 v218, v218, s30, s30
    s_waitcnt lgkmcnt(4)
    v_mfma_f32_16x16x32_bf16 v[88:91], v[56:59], a[32:35], v[88:91]
    ds_read_b128 v[40:43], v4 offset:12288
    v_fma_f32 v219, v219, s30, s30
    v_mfma_f32_16x16x32_bf16 v[88:91], v[60:63], a[40:43], v[88:91]
    v_add_u32 v251, k4_kernel_j905-k4_kernel_pc, v250
    v_min_u32 v251, k4_kernel_end-k4_kernel_pc, v251
    global_load_dword v252, v251, s[40:41]
    v_mfma_f32_16x16x32_bf16 v[92:95], v[56:59], a[36:39], v[92:95]
    ds_read_b128 v[44:47], v4 offset:13312
    v_rcp_f32 v217, v217
    v_mfma_f32_16x16x32_bf16 v[92:95], v[60:63], a[44:47], v[92:95]
    buffer_load_dwordx4 v5, s[8:11], s31 offen offset:1024 lds
    v_mfma_f32_16x16x32_bf16 v[96:99], v[64:67], a[32:35], v[96:99]
    ds_read_b128 v[48:51], v4 offset:14336
    v_mul_f32 v217, v217, v233
    v_mfma_f32_16x16x32_bf16 v[96:99], v[68:71], a[40:43], v[96:99]
    v_rcp_f32 v218, v218
    v_mfma_f32_16x16x32_bf16 v[100:103], v[64:67], a[36:39], v[100:103]
    ds_read_b128 v[52:55], v4 offset:15360
    v_cvt_pk_bf16_f32 v184, v216, v217
    v_mfma_f32_16x16x32_bf16 v[100:103], v[68:71], a[44:47], v[100:103]
    v_mul_f32 v218, v218, v234
    s_waitcnt lgkmcnt(4)
    v_mfma_f32_16x16x32_bf16 v[72:75], v[24:27], a[48:51], v[72:75]
    ds_read_b128 v[56:59], v4 offset:16384
    v_rcp_f32 v219, v219
    v_mfma_f32_16x16x32_bf16 v[72:75], v[28:31], a[56:59], v[72:75]
    v_exp_f32 v224, v224
    v_mfma_f32_16x16x32_bf16 v[76:79], v[24:27], a[52:55], v[76:79]
    ds_read_b128 v[60:63], v4 offset:17408
    v_mul_f32 v219, v219, v235
    v_mfma_f32_16x16x32_bf16 v[76:79], v[28:31], a[60:63], v[76:79]
    buffer_load_dwordx4 v5, s[8:11], s31 offen offset:2048 lds
    v_mfma_f32_16x16x32_bf16 v[80:83], v[32:35], a[48:51], v[80:83]
    ds_read_b128 v[64:67], v4 offset:18432
    v_cvt_pk_bf16_f32 v185, v218, v219
    v_mfma_f32_16x16x32_bf16 v[80:83], v[36:39], a[56:59], v[80:83]
    v_exp_f32 v225, v225
    v_mfma_f32_16x16x32_bf16 v[84:87], v[32:35], a[52:55], v[84:87]
    ds_read_b128 v[68:71], v4 offset:19456
    v_fma_f32 v224, v224, s30, s30
    v_mfma_f32_16x16x32_bf16 v[84:87], v[36:39], a[60:63], v[84:87]
    v_fma_f32 v225, v225, s30, s30
    s_waitcnt lgkmcnt(4)
    v_mfma_f32_16x16x32_bf16 v[88:91], v[40:43], a[48:51], v[88:91]
    ds_read_b128 v[24:27], v4 offset:20480
    v_rcp_f32 v224, v224
    v_mfma_f32_16x16x32_bf16 v[88:91], v[44:47], a[56:59], v[88:91]
    v_rcp_f32 v225, v225
    v_mfma_f32_16x16x32_bf16 v[92:95], v[40:43], a[52:55], v[92:95]
    ds_read_b128 v[28:31], v4 offset:21504
    v_mul_f32 v224, v224, v240
    v_mfma_f32_16x16x32_bf16 v[92:95], v[44:47], a[60:63], v[92:95]
    buffer_load_dwordx4 v5, s[8:11], s31 offen offset:3072 lds
    v_mfma_f32_16x16x32_bf16 v[96:99], v[48:51], a[48:51], v[96:99]
    ds_read_b128 v[32:35], v4 offset:22528
    v_mul_f32 v225, v225, v241
    v_mfma_f32_16x16x32_bf16 v[96:99], v[52:55], a[56:59], v[96:99]
    v_exp_f32 v226, v226
    v_mfma_f32_16x16x32_bf16 v[100:103], v[48:51], a[52:55], v[100:103]
    ds_read_b128 v[36:39], v4 offset:23552
    s_add_u32 m0, s28, 81920
    v_mfma_f32_16x16x32_bf16 v[100:103], v[52:55], a[60:63], v[100:103]
    s_mov_b32 s31, 573440
    s_waitcnt lgkmcnt(4)
    v_mfma_f32_16x16x32_bf16 v[72:75], v[56:59], a[64:67], v[72:75]
    ds_read_b128 v[40:43], v4 offset:24576
    v_fma_f32 v226, v226, s30, s30
    v_mfma_f32_16x16x32_bf16 v[72:75], v[60:63], a[72:75], v[72:75]
    s_waitcnt vmcnt(9)
k4_kernel_f5a:
    v_cmp_eq_u32 vcc, 0, v16
    s_cbranch_vccz k4_kernel_f5b
    s_sub_u32 s34, s34, 1
    s_cmp_lt_i32 s34, 0
    s_cbranch_scc1 k4_kernel_f5b
    buffer_load_dword v16, v255, s[8:11], 0 offen sc1
    s_waitcnt vmcnt(0)
    s_branch k4_kernel_f5a
k4_kernel_f5b:
    v_mfma_f32_16x16x32_bf16 v[76:79], v[56:59], a[68:71], v[76:79]
    ds_read_b128 v[44:47], v4 offset:25600
    v_cvt_pk_bf16_f32 v186, v224, v225
    v_mfma_f32_16x16x32_bf16 v[76:79], v[60:63], a[76:79], v[76:79]
    buffer_load_dwordx4 v5, s[8:11], s31 offen offset:0 lds
    v_mfma_f32_16x16x32_bf16 v[80:83], v[64:67], a[64:67], v[80:83]
    ds_read_b128 v[48:51], v4 offset:26624
    v_mfma_f32_16x16x32_bf16 v[80:83], v[68:71], a[72:75], v[80:83]
    v_rcp_f32 v226, v226
    v_mfma_f32_16x16x32_bf16 v[84:87], v[64:67], a[68:71], v[84:87]
    ds_read_b128 v[52:55], v4 offset:27648
    v_mfma_f32_16x16x32_bf16 v[84:87], v[68:71], a[76:79], v[84:87]
    v_mul_f32 v226, v226, v242
    s_waitcnt lgkmcnt(4)
    v_mfma_f32_16x16x32_bf16 v[88:91], v[24:27], a[64:67], v[88:91]
    ds_read_b128 v[56:59], v4 offset:28672
    v_mfma_f32_16x16x32_bf16 v[88:91], v[28:31], a[72:75], v[88:91]
    v_exp_f32 v227, v227
    v_mfma_f32_16x16x32_bf16 v[92:95], v[24:27], a[68:71], v[92:95]
    ds_read_b128 v[60:63], v4 offset:29696
    v_mfma_f32_16x16x32_bf16 v[92:95], v[28:31], a[76:79], v[92:95]
    buffer_load_dwordx4 v5, s[8:11], s31 offen offset:1024 lds
    v_mfma_f32_16x16x32_bf16 v[96:99], v[32:35], a[64:67], v[96:99]
    ds_read_b128 v[64:67], v4 offset:30720
    v_fma_f32 v227, v227, s30, s30
    v_mfma_f32_16x16x32_bf16 v[96:99], v[36:39], a[72:75], v[96:99]
    v_rcp_f32 v227, v227
    v_mfma_f32_16x16x32_bf16 v[100:103], v[32:35], a[68:71], v[100:103]
    ds_read_b128 v[68:71], v4 offset:31744
    v_mfma_f32_16x16x32_bf16 v[100:103], v[36:39], a[76:79], v[100:103]
    v_mul_f32 v227, v227, v243
    s_waitcnt lgkmcnt(4)
    v_mfma_f32_16x16x32_bf16 v[72:75], v[40:43], a[80:83], v[72:75]
    s_barrier
    ds_read_b128 v[24:27], v2 offset:0
    v_mfma_f32_16x16x32_bf16 v[72:75], v[44:47], a[88:91], v[72:75]
    v_exp_f32 v220, v220
    v_mfma_f32_16x16x32_bf16 v[76:79], v[40:43], a[84:87], v[76:79]
    ds_read_b128 v[28:31], v2 offset:1024
    v_cvt_pk_bf16_f32 v187, v226, v227
    v_mfma_f32_16x16x32_bf16 v[76:79], v[44:47], a[92:95], v[76:79]
    buffer_load_dwordx4 v5, s[8:11], s31 offen offset:2048 lds
    v_mfma_f32_16x16x32_bf16 v[80:83], v[48:51], a[80:83], v[80:83]
    ds_read_b128 v[32:35], v2 offset:2048
    s_mov_b32 s29, 10240
    v_mfma_f32_16x16x32_bf16 v[80:83], v[52:55], a[88:91], v[80:83]
    buffer_store_dwordx4 v[184:187], v8, s[8:11], s29 offen offset:0 sc1
    v_mfma_f32_16x16x32_bf16 v[84:87], v[48:51], a[84:87], v[84:87]
    ds_read_b128 v[36:39], v2 offset:3072
    v_fma_f32 v220, v220, s30, s30
    v_mfma_f32_16x16x32_bf16 v[84:87], v[52:55], a[92:95], v[84:87]
    s_waitcnt lgkmcnt(4)
    v_mfma_f32_16x16x32_bf16 v[88:91], v[56:59], a[80:83], v[88:91]
    ds_read_b128 v[40:43], v2 offset:4096
    v_mfma_f32_16x16x32_bf16 v[88:91], v[60:63], a[88:91], v[88:91]
    v_rcp_f32 v220, v220
    v_mfma_f32_16x16x32_bf16 v[92:95], v[56:59], a[84:87], v[92:95]
    ds_read_b128 v[44:47], v2 offset:5120
    v_mfma_f32_16x16x32_bf16 v[92:95], v[60:63], a[92:95], v[92:95]
    buffer_load_dwordx4 v5, s[8:11], s31 offen offset:3072 lds
    v_mfma_f32_16x16x32_bf16 v[96:99], v[64:67], a[80:83], v[96:99]
    ds_read_b128 v[48:51], v2 offset:6144
    v_mul_f32 v220, v220, v236
    v_mfma_f32_16x16x32_bf16 v[96:99], v[68:71], a[88:91], v[96:99]
    v_exp_f32 v221, v221
    v_mfma_f32_16x16x32_bf16 v[100:103], v[64:67], a[84:87], v[100:103]
    ds_read_b128 v[52:55], v2 offset:7168
    s_add_u32 m0, s28, 98304
    v_mfma_f32_16x16x32_bf16 v[100:103], v[68:71], a[92:95], v[100:103]
    s_mov_b32 s31, 589824
    s_waitcnt lgkmcnt(4)
    v_mfma_f32_16x16x32_bf16 v[72:75], v[24:27], a[96:99], v[72:75]
    ds_read_b128 v[56:59], v2 offset:8192
    v_fma_f32 v221, v221, s30, s30
    v_mfma_f32_16x16x32_bf16 v[72:75], v[28:31], a[104:107], v[72:75]
    buffer_load_dwordx4 v[16:19], v9, s[8:11], 0 offen sc1
    v_mfma_f32_16x16x32_bf16 v[76:79], v[24:27], a[100:103], v[76:79]
    ds_read_b128 v[60:63], v2 offset:9216
    v_mfma_f32_16x16x32_bf16 v[76:79], v[28:31], a[108:111], v[76:79]
    buffer_load_dwordx4 v5, s[8:11], s31 offen offset:0 lds
    v_mfma_f32_16x16x32_bf16 v[80:83], v[32:35], a[96:99], v[80:83]
    ds_read_b128 v[64:67], v2 offset:10240
    v_mfma_f32_16x16x32_bf16 v[80:83], v[36:39], a[104:107], v[80:83]
    v_rcp_f32 v221, v221
    v_mfma_f32_16x16x32_bf16 v[84:87], v[32:35], a[100:103], v[84:87]
    ds_read_b128 v[68:71], v2 offset:11264
    v_mfma_f32_16x16x32_bf16 v[84:87], v[36:39], a[108:111], v[84:87]
    v_mul_f32 v221, v221, v237
    s_waitcnt lgkmcnt(4)
    v_mfma_f32_16x16x32_bf16 v[88:91], v[40:43], a[96:99], v[88:91]
    ds_read_b128 v[24:27], v2 offset:12288
    v_cvt_pk_bf16_f32 v188, v220, v221
    v_mfma_f32_16x16x32_bf16 v[88:91], v[44:47], a[104:107], v[88:91]
    v_exp_f32 v222, v222
    v_mfma_f32_16x16x32_bf16 v[92:95], v[40:43], a[100:103], v[92:95]
    ds_read_b128 v[28:31], v2 offset:13312
    v_mfma_f32_16x16x32_bf16 v[92:95], v[44:47], a[108:111], v[92:95]
    buffer_load_dwordx4 v5, s[8:11], s31 offen offset:1024 lds
    v_mfma_f32_16x16x32_bf16 v[96:99], v[48:51], a[96:99], v[96:99]
    ds_read_b128 v[32:35], v2 offset:14336
    v_fma_f32 v222, v222, s30, s30
    v_mfma_f32_16x16x32_bf16 v[96:99], v[52:55], a[104:107], v[96:99]
    v_rcp_f32 v222, v222
    v_mfma_f32_16x16x32_bf16 v[100:103], v[48:51], a[100:103], v[100:103]
    ds_read_b128 v[36:39], v2 offset:15360
    v_mfma_f32_16x16x32_bf16 v[100:103], v[52:55], a[108:111], v[100:103]
    v_mul_f32 v222, v222, v238
    s_waitcnt lgkmcnt(4)
    v_mfma_f32_16x16x32_bf16 v[72:75], v[56:59], a[112:115], v[72:75]
    ds_read_b128 v[40:43], v2 offset:16384
    v_mfma_f32_16x16x32_bf16 v[72:75], v[60:63], a[120:123], v[72:75]
    v_exp_f32 v223, v223
    v_mfma_f32_16x16x32_bf16 v[76:79], v[56:59], a[116:119], v[76:79]
    ds_read_b128 v[44:47], v2 offset:17408
    v_mfma_f32_16x16x32_bf16 v[76:79], v[60:63], a[124:127], v[76:79]
    buffer_load_dwordx4 v5, s[8:11], s31 offen offset:2048 lds
    v_mfma_f32_16x16x32_bf16 v[80:83], v[64:67], a[112:115], v[80:83]
    ds_read_b128 v[48:51], v2 offset:18432
    v_fma_f32 v223, v223, s30, s30
    v_mfma_f32_16x16x32_bf16 v[80:83], v[68:71], a[120:123], v[80:83]
    v_rcp_f32 v223, v223
    v_mfma_f32_16x16x32_bf16 v[84:87], v[64:67], a[116:119], v[84:87]
    ds_read_b128 v[52:55], v2 offset:19456
    v_mfma_f32_16x16x32_bf16 v[84:87], v[68:71], a[124:127], v[84:87]
    v_mul_f32 v223, v223, v239
    s_waitcnt lgkmcnt(4)
    v_mfma_f32_16x16x32_bf16 v[88:91], v[24:27], a[112:115], v[88:91]
    ds_read_b128 v[56:59], v2 offset:20480
    v_cvt_pk_bf16_f32 v189, v222, v223
    v_mfma_f32_16x16x32_bf16 v[88:91], v[28:31], a[120:123], v[88:91]
    v_exp_f32 v228, v228
    v_mfma_f32_16x16x32_bf16 v[92:95], v[24:27], a[116:119], v[92:95]
    ds_read_b128 v[60:63], v2 offset:21504
    v_mfma_f32_16x16x32_bf16 v[92:95], v[28:31], a[124:127], v[92:95]
    buffer_load_dwordx4 v5, s[8:11], s31 offen offset:3072 lds
    v_mfma_f32_16x16x32_bf16 v[96:99], v[32:35], a[112:115], v[96:99]
    ds_read_b128 v[64:67], v2 offset:22528
    v_fma_f32 v228, v228, s30, s30
    v_mfma_f32_16x16x32_bf16 v[96:99], v[36:39], a[120:123], v[96:99]
    v_rcp_f32 v228, v228
    v_mfma_f32_16x16x32_bf16 v[100:103], v[32:35], a[116:119], v[100:103]
    ds_read_b128 v[68:71], v2 offset:23552
    s_add_u32 m0, s28, 114688
    v_mfma_f32_16x16x32_bf16 v[100:103], v[36:39], a[124:127], v[100:103]
    s_mov_b32 s31, 606208
    s_waitcnt lgkmcnt(4)
    v_mfma_f32_16x16x32_bf16 v[72:75], v[40:43], a[128:131], v[72:75]
    ds_read_b128 v[24:27], v2 offset:24576
    v_mul_f32 v228, v228, v244
    v_mfma_f32_16x16x32_bf16 v[72:75], v[44:47], a[136:139], v[72:75]
    v_exp_f32 v229, v229
    v_mfma_f32_16x16x32_bf16 v[76:79], v[40:43], a[132:135], v[76:79]
    ds_read_b128 v[28:31], v2 offset:25600
    v_mfma_f32_16x16x32_bf16 v[76:79], v[44:47], a[140:143], v[76:79]
    buffer_load_dwordx4 v5, s[8:11], s31 offen offset:0 lds
    v_mfma_f32_16x16x32_bf16 v[80:83], v[48:51], a[128:131], v[80:83]
    ds_read_b128 v[32:35], v2 offset:26624
    v_fma_f32 v229, v229, s30, s30
    v_mfma_f32_16x16x32_bf16 v[80:83], v[52:55], a[136:139], v[80:83]
    v_rcp_f32 v229, v229
    v_mfma_f32_16x16x32_bf16 v[84:87], v[48:51], a[132:135], v[84:87]
    ds_read_b128 v[36:39], v2 offset:27648
    v_mfma_f32_16x16x32_bf16 v[84:87], v[52:55], a[140:143], v[84:87]
    v_mul_f32 v229, v229, v245
    s_waitcnt lgkmcnt(4)
    v_mfma_f32_16x16x32_bf16 v[88:91], v[56:59], a[128:131], v[88:91]
    ds_read_b128 v[40:43], v2 offset:28672
    v_cvt_pk_bf16_f32 v190, v228, v229
    v_mfma_f32_16x16x32_bf16 v[88:91], v[60:63], a[136:139], v[88:91]
    s_waitcnt vmcnt(5)
k4_kernel_f0a:
    v_and_b32 v20, v16, v17
    v_and_b32 v21, v18, v19
    v_and_b32 v20, v20, v21
    v_cmp_ne_u32 vcc, 0, v20
    s_cbranch_vccnz k4_kernel_f0b
    s_sub_u32 s34, s34, 1
    s_cmp_lt_i32 s34, 0
    s_cbranch_scc1 k4_kernel_f0b
    buffer_load_dwordx4 v[16:19], v9, s[8:11], 0 offen sc1
    s_waitcnt vmcnt(0)
    s_branch k4_kernel_f0a
k4_kernel_f0b:
    v_mfma_f32_16x16x32_bf16 v[92:95], v[56:59], a[132:135], v[92:95]
    ds_read_b128 v[44:47], v2 offset:29696
    v_mfma_f32_16x16x32_bf16 v[92:95], v[60:63], a[140:143], v[92:95]
    buffer_load_dwordx4 v5, s[8:11], s31 offen offset:1024 lds
    v_mfma_f32_16x16x32_bf16 v[96:99], v[64:67], a[128:131], v[96:99]
    ds_read_b128 v[48:51], v2 offset:30720
    v_mfma_f32_16x16x32_bf16 v[96:99], v[68:71], a[136:139], v[96:99]
    s_mov_b32 s48, 0
    buffer_load_dwordx4 a[144:147], v10, s[8:11], s48 offen offset:0 sc1
    v_mfma_f32_16x16x32_bf16 v[100:103], v[64:67], a[132:135], v[100:103]
    ds_read_b128 v[52:55], v2 offset:31744
    v_mfma_f32_16x16x32_bf16 v[100:103], v[68:71], a[140:143], v[100:103]
    s_waitcnt lgkmcnt(4)
    v_mfma_f32_16x16x32_bf16 v[104:107], v[24:27], a[0:3], 0
    ds_read_b128 v[56:59], v2 offset:32768
    v_mfma_f32_16x16x32_bf16 v[104:107], v[28:31], a[8:11], v[104:107]
    v_exp_f32 v230, v230
    v_mfma_f32_16x16x32_bf16 v[108:111], v[24:27], a[4:7], 0
    ds_read_b128 v[60:63], v2 offset:33792
    v_mfma_f32_16x16x32_bf16 v[108:111], v[28:31], a[12:15], v[108:111]
    buffer_load_dwordx4 v5, s[8:11], s31 offen offset:2048 lds
    v_mfma_f32_16x16x32_bf16 v[112:115], v[32:35], a[0:3], 0
    ds_read_b128 v[64:67], v2 offset:34816
    v_fma_f32 v230, v230, s30, s30
    v_mfma_f32_16x16x32_bf16 v[112:115], v[36:39], a[8:11], v[112:115]
    v_rcp_f32 v230, v230
    v_mfma_f32_16x16x32_bf16 v[116:119], v[32:35], a[4:7], 0
    ds_read_b128 v[68:71], v2 offset:35840
    v_mfma_f32_16x16x32_bf16 v[116:119], v[36:39], a[12:15], v[116:119]
    v_mul_f32 v230, v230, v246
    s_waitcnt lgkmcnt(4)
    v_mfma_f32_16x16x32_bf16 v[120:123], v[40:43], a[0:3], 0
    ds_read_b128 v[24:27], v2 offset:36864
    v_mfma_f32_16x16x32_bf16 v[120:123], v[44:47], a[8:11], v[120:123]
    buffer_load_dwordx4 a[148:151], v10, s[8:11], s48 offen offset:1024 sc1
    v_mfma_f32_16x16x32_bf16 v[124:127], v[40:43], a[4:7], 0
    ds_read_b128 v[28:31], v2 offset:37888
    v_mfma_f32_16x16x32_bf16 v[124:127], v[44:47], a[12:15], v[124:127]
    buffer_load_dwordx4 v5, s[8:11], s31 offen offset:3072 lds
    v_mfma_f32_16x16x32_bf16 v[128:131], v[48:51], a[0:3], 0
    ds_read_b128 v[32:35], v2 offset:38912
    v_mfma_f32_16x16x32_bf16 v[128:131], v[52:55], a[8:11], v[128:131]
    v_exp_f32 v231, v231
    v_mfma_f32_16x16x32_bf16 v[132:135], v[48:51], a[4:7], 0
    ds_read_b128 v[36:39], v2 offset:39936
    s_add_u32 m0, s28, 131072
    v_mfma_f32_16x16x32_bf16 v[132:135], v[52:55], a[12:15], v[132:135]
    s_mov_b32 s31, 622592
    s_waitcnt lgkmcnt(4)
    v_mfma_f32_16x16x32_bf16 v[104:107], v[56:59], a[16:19], v[104:107]
    ds_read_b128 v[40:43], v2 offset:40960
    v_fma_f32 v231, v231, s30, s30
    v_mfma_f32_16x16x32_bf16 v[104:107], v[60:63], a[24:27], v[104:107]
    v_rcp_f32 v231, v231
    v_mfma_f32_16x16x32_bf16 v[108:111], v[56:59], a[20:23], v[108:111]
    ds_read_b128 v[44:47], v2 offset:41984
    v_mfma_f32_16x16x32_bf16 v[108:111], v[60:63], a[28:31], v[108:111]
    buffer_load_dwordx4 v5, s[8:11], s31 offen offset:0 lds
    v_mfma_f32_16x16x32_bf16 v[112:115], v[64:67], a[16:19], v[112:115]
    ds_read_b128 v[48:51], v2 offset:43008
    v_mul_f32 v231, v231, v247
    v_mfma_f32_16x16x32_bf16 v[112:115], v[68:71], a[24:27], v[112:115]
    s_mov_b32 s48, 2048
    buffer_load_dwordx4 a[152:155], v10, s[8:11], s48 offen offset:0 sc1
    v_mfma_f32_16x16x32_bf16 v[116:119], v[64:67], a[20:23], v[116:119]
    ds_read_b128 v[52:55], v2 offset:44032
    v_cvt_pk_bf16_f32 v191, v230, v231
    v_mfma_f32_16x16x32_bf16 v[116:119], v[68:71], a[28:31], v[116:119]
    s_mov_b32 s29, 10240
    s_waitcnt lgkmcnt(4)
    v_mfma_f32_16x16x32_bf16 v[120:123], v[24:27], a[16:19], v[120:123]
    ds_read_b128 v[56:59], v2 offset:45056
    v_mfma_f32_16x16x32_bf16 v[120:123], v[28:31], a[24:27], v[120:123]
    buffer_store_dwordx4 v[188:191], v8, s[8:11], s29 offen offset:1024 sc1
    v_mfma_f32_16x16x32_bf16 v[124:127], v[24:27], a[20:23], v[124:127]
    ds_read_b128 v[60:63], v2 offset:46080
    v_exp_f32 v72, v72
    v_mfma_f32_16x16x32_bf16 v[124:127], v[28:31], a[28:31], v[124:127]
    buffer_load_dwordx4 v5, s[8:11], s31 offen offset:1024 lds
    v_mfma_f32_16x16x32_bf16 v[128:131], v[32:35], a[16:19], v[128:131]
    ds_read_b128 v[64:67], v2 offset:47104
    v_exp_f32 v73, v73
    v_mfma_f32_16x16x32_bf16 v[128:131], v[36:39], a[24:27], v[128:131]
    v_exp_f32 v74, v74
    v_mfma_f32_16x16x32_bf16 v[132:135], v[32:35], a[20:23], v[132:135]
    ds_read_b128 v[68:71], v2 offset:48128
    v_exp_f32 v75, v75
    v_mfma_f32_16x16x32_bf16 v[132:135], v[36:39], a[28:31], v[132:135]
    v_exp_f32 v80, v80
    s_waitcnt lgkmcnt(4)
    v_mfma_f32_16x16x32_bf16 v[104:107], v[40:43], a[32:35], v[104:107]
    s_barrier
    ds_read_b128 v[24:27], v2 offset:49152
    v_mfma_f32_16x16x32_bf16 v[104:107], v[44:47], a[40:43], v[104:107]
    buffer_load_dwordx4 a[156:159], v10, s[8:11], s48 offen offset:1024 sc1
    v_mfma_f32_16x16x32_bf16 v[108:111], v[40:43], a[36:39], v[108:111]
    ds_read_b128 v[28:31], v2 offset:50176
    v_exp_f32 v81, v81
    v_mfma_f32_16x16x32_bf16 v[108:111], v[44:47], a[44:47], v[108:111]
    buffer_load_dwordx4 v5, s[8:11], s31 offen offset:2048 lds
    v_mfma_f32_16x16x32_bf16 v[112:115], v[48:51], a[32:35], v[112:115]
    ds_read_b128 v[32:35], v2 offset:51200
    v_exp_f32 v82, v82
    v_mfma_f32_16x16x32_bf16 v[112:115], v[52:55], a[40:43], v[112:115]
    v_exp_f32 v83, v83
    v_mfma_f32_16x16x32_bf16 v[116:119], v[48:51], a[36:39], v[116:119]
    ds_read_b128 v[36:39], v2 offset:52224
    v_fma_f32 v72, v72, s30, s30
    v_mfma_f32_16x16x32_bf16 v[116:119], v[52:55], a[44:47], v[116:119]
    v_fma_f32 v73, v73, s30, s30
    s_waitcnt lgkmcnt(4)
    v_mfma_f32_16x16x32_bf16 v[120:123], v[56:59], a[32:35], v[120:123]
    ds_read_b128 v[40:43], v2 offset:53248
    v_fma_f32 v74, v74, s30, s30
    v_mfma_f32_16x16x32_bf16 v[120:123], v[60:63], a[40:43], v[120:123]
    v_rcp_f32 v72, v72
    v_mfma_f32_16x16x32_bf16 v[124:127], v[56:59], a[36:39], v[124:127]
    ds_read_b128 v[44:47], v2 offset:54272
    v_fma_f32 v75, v75, s30, s30
    v_mfma_f32_16x16x32_bf16 v[124:127], v[60:63], a[44:47], v[124:127]
    buffer_load_dwordx4 v5, s[8:11], s31 offen offset:3072 lds
    v_mfma_f32_16x16x32_bf16 v[128:131], v[64:67], a[32:35], v[128:131]
    ds_read_b128 v[48:51], v2 offset:55296
    v_mul_f32 v72, v72, v88
    v_mfma_f32_16x16x32_bf16 v[128:131], v[68:71], a[40:43], v[128:131]
    s_mov_b32 s48, 4096
    buffer_load_dwordx4 a[160:163], v10, s[8:11], s48 offen offset:0 sc1
    v_mfma_f32_16x16x32_bf16 v[132:135], v[64:67], a[36:39], v[132:135]
    ds_read_b128 v[52:55], v2 offset:56320
    s_add_u32 m0, s28, 147456
    v_mfma_f32_16x16x32_bf16 v[132:135], v[68:71], a[44:47], v[132:135]
    s_mov_b32 s31, 638976
    s_waitcnt lgkmcnt(4)
    v_mfma_f32_16x16x32_bf16 v[104:107], v[24:27], a[48:51], v[104:107]
    ds_read_b128 v[56:59], v2 offset:57344
    v_fma_f32 v80, v80, s30, s30
    v_mfma_f32_16x16x32_bf16 v[104:107], v[28:31], a[56:59], v[104:107]
    v_rcp_f32 v73, v73
    v_mfma_f32_16x16x32_bf16 v[108:111], v[24:27], a[52:55], v[108:111]
    ds_read_b128 v[60:63], v2 offset:58368
    v_fma_f32 v81, v81, s30, s30
    v_mfma_f32_16x16x32_bf16 v[108:111], v[28:31], a[60:63], v[108:111]
    buffer_load_dwordx4 v5, s[8:11], s31 offen offset:0 lds
    v_mfma_f32_16x16x32_bf16 v[112:115], v[32:35], a[48:51], v[112:115]
    ds_read_b128 v[64:67], v2 offset:59392
    v_mul_f32 v73, v73, v89
    v_mfma_f32_16x16x32_bf16 v[112:115], v[36:39], a[56:59], v[112:115]
    v_rcp_f32 v74, v74
    v_mfma_f32_16x16x32_bf16 v[116:119], v[32:35], a[52:55], v[116:119]
    ds_read_b128 v[68:71], v2 offset:60416
    v_cvt_pk_bf16_f32 v192, v72, v73
    v_mfma_f32_16x16x32_bf16 v[116:119], v[36:39], a[60:63], v[116:119]
    v_mul_f32 v74, v74, v90
    s_waitcnt lgkmcnt(4)
    v_mfma_f32_16x16x32_bf16 v[120:123], v[40:43], a[48:51], v[120:123]
    ds_read_b128 v[24:27], v2 offset:61440
    v_fma_f32 v82, v82, s30, s30
    v_mfma_f32_16x16x32_bf16 v[120:123], v[44:47], a[56:59], v[120:123]
    buffer_load_dwordx4 a[164:167], v10, s[8:11], s48 offen offset:1024 sc1
    v_mfma_f32_16x16x32_bf16 v[124:127], v[40:43], a[52:55], v[124:127]
    ds_read_b128 v[28:31], v2 offset:62464
    v_fma_f32 v83, v83, s30, s30
    v_mfma_f32_16x16x32_bf16 v[124:127], v[44:47], a[60:63], v[124:127]
    buffer_load_dwordx4 v5, s[8:11], s31 offen offset:1024 lds
    v_mfma_f32_16x16x32_bf16 v[128:131], v[48:51], a[48:51], v[128:131]
    ds_read_b128 v[32:35], v2 offset:63488
    v_rcp_f32 v75, v75
    v_mfma_f32_16x16x32_bf16 v[128:131], v[52:55], a[56:59], v[128:131]
    v_rcp_f32 v80, v80
    v_mfma_f32_16x16x32_bf16 v[132:135], v[48:51], a[52:55], v[132:135]
    ds_read_b128 v[36:39], v2 offset:64512
    v_mul_f32 v75, v75, v91
    v_mfma_f32_16x16x32_bf16 v[132:135], v[52:55], a[60:63], v[132:135]
    v_cvt_pk_bf16_f32 v193, v74, v75
    s_waitcnt lgkmcnt(4)
    v_mfma_f32_16x16x32_bf16 v[104:107], v[56:59], a[64:67], v[104:107]
    ds_read_b128 v[40:43], v3 offset:0
    v_mul_f32 v80, v80, v96
    v_mfma_f32_16x16x32_bf16 v[104:107], v[60:63], a[72:75], v[104:107]
    v_rcp_f32 v81, v81
    v_mfma_f32_16x16x32_bf16 v[108:111], v[56:59], a[68:71], v[108:111]
    ds_read_b128 v[44:47], v3 offset:1024
    v_rcp_f32 v82, v82
    v_mfma_f32_16x16x32_bf16 v[108:111], v[60:63], a[76:79], v[108:111]
    buffer_load_dwordx4 v5, s[8:11], s31 offen offset:2048 lds
    v_mfma_f32_16x16x32_bf16 v[112:115], v[64:67], a[64:67], v[112:115]
    ds_read_b128 v[48:51], v3 offset:2048
    v_mul_f32 v81, v81, v97
    v_mfma_f32_16x16x32_bf16 v[112:115], v[68:71], a[72:75], v[112:115]
    s_mov_b32 s48, 6144
    buffer_load_dwordx4 a[168:171], v10, s[8:11], s48 offen offset:0 sc1
    v_mfma_f32_16x16x32_bf16 v[116:119], v[64:67], a[68:71], v[116:119]
    ds_read_b128 v[52:55], v3 offset:3072
    v_mul_f32 v82, v82, v98
    v_mfma_f32_16x16x32_bf16 v[116:119], v[68:71], a[76:79], v[116:119]
    v_cvt_pk_bf16_f32 v194, v80, v81
    s_waitcnt lgkmcnt(4)
    v_mfma_f32_16x16x32_bf16 v[120:123], v[24:27], a[64:67], v[120:123]
    ds_read_b128 v[56:59], v3 offset:4096
    v_rcp_f32 v83, v83
    v_mfma_f32_16x16x32_bf16 v[120:123], v[28:31], a[72:75], v[120:123]
    v_exp_f32 v76, v76
    v_mfma_f32_16x16x32_bf16 v[124:127], v[24:27], a[68:71], v[124:127]
    ds_read_b128 v[60:63], v3 offset:5120
    v_mul_f32 v83, v83, v99
    v_mfma_f32_16x16x32_bf16 v[124:127], v[28:31], a[76:79], v[124:127]
    buffer_load_dwordx4 v5, s[8:11], s31 offen offset:3072 lds
    v_mfma_f32_16x16x32_bf16 v[128:131], v[32:35], a[64:67], v[128:131]
    ds_read_b128 v[64:67], v3 offset:6144
    v_cvt_pk_bf16_f32 v195, v82, v83
    v_mfma_f32_16x16x32_bf16 v[128:131], v[36:39], a[72:75], v[128:131]
    v_exp_f32 v77, v77
    v_mfma_f32_16x16x32_bf16 v[132:135], v[32:35], a[68:71], v[132:135]
    ds_read_b128 v[68:71], v3 offset:7168
    s_add_u32 m0, s28, 0
    v_mfma_f32_16x16x32_bf16 v[132:135], v[36:39], a[76:79], v[132:135]
    s_mov_b32 s31, 655360
    s_waitcnt lgkmcnt(4)
    v_mfma_f32_16x16x32_bf16 v[104:107], v[40:43], a[80:83], v[104:107]
    ds_read_b128 v[24:27], v3 offset:8192
    s_mov_b32 s29, 12288
    v_mfma_f32_16x16x32_bf16 v[104:107], v[44:47], a[88:91], v[104:107]
    buffer_load_dwordx4 a[172:175], v10, s[8:11], s48 offen offset:1024 sc1
    v_mfma_f32_16x16x32_bf16 v[108:111], v[40:43], a[84:87], v[108:111]
    ds_read_b128 v[28:31], v3 offset:9216
    v_fma_f32 v76, v76, s30, s30
    v_mfma_f32_16x16x32_bf16 v[108:111], v[44:47], a[92:95], v[108:111]
    buffer_load_dwordx4 v5, s[8:11], s31 offen offset:0 lds
    v_mfma_f32_16x16x32_bf16 v[112:115], v[48:51], a[80:83], v[112:115]
    ds_read_b128 v[32:35], v3 offset:10240
    v_fma_f32 v77, v77, s30, s30
    v_mfma_f32_16x16x32_bf16 v[112:115], v[52:55], a[88:91], v[112:115]
    buffer_store_dwordx4 v[192:195], v8, s[8:11], s29 offen offset:0 sc1
    v_mfma_f32_16x16x32_bf16 v[116:119], v[48:51], a[84:87], v[116:119]
    ds_read_b128 v[36:39], v3 offset:11264
    v_rcp_f32 v76, v76
    v_mfma_f32_16x16x32_bf16 v[116:119], v[52:55], a[92:95], v[116:119]
    v_rcp_f32 v77, v77
    s_waitcnt lgkmcnt(4)
    v_mfma_f32_16x16x32_bf16 v[120:123], v[56:59], a[80:83], v[120:123]
    ds_read_b128 v[40:43], v3 offset:12288
    v_mul_f32 v76, v76, v92
    v_mfma_f32_16x16x32_bf16 v[120:123], v[60:63], a[88:91], v[120:123]
    v_exp_f32 v78, v78
    v_mfma_f32_16x16x32_bf16 v[124:127], v[56:59], a[84:87], v[124:127]
    ds_read_b128 v[44:47], v3 offset:13312
    v_mul_f32 v77, v77, v93
    v_mfma_f32_16x16x32_bf16 v[124:127], v[60:63], a[92:95], v[124:127]
    buffer_load_dwordx4 v5, s[8:11], s31 offen offset:1024 lds
    v_mfma_f32_16x16x32_bf16 v[128:131], v[64:67], a[80:83], v[128:131]
    ds_read_b128 v[48:51], v3 offset:14336
    v_fma_f32 v78, v78, s30, s30
    v_mfma_f32_16x16x32_bf16 v[128:131], v[68:71], a[88:91], v[128:131]
    s_mov_b32 s48, 0
    buffer_load_dwordx4 a[176:179], v11, s[8:11], s48 offen offset:0 sc1
    v_mfma_f32_16x16x32_bf16 v[132:135], v[64:67], a[84:87], v[132:135]
    ds_read_b128 v[52:55], v3 offset:15360
    v_cvt_pk_bf16_f32 v196, v76, v77
    v_mfma_f32_16x16x32_bf16 v[132:135], v[68:71], a[92:95], v[132:135]
    s_waitcnt lgkmcnt(4)
    v_mfma_f32_16x16x32_bf16 v[104:107], v[24:27], a[96:99], v[104:107]
    ds_read_b128 v[56:59], v3 offset:16384
    v_rcp_f32 v78, v78
    v_mfma_f32_16x16x32_bf16 v[104:107], v[28:31], a[104:107], v[104:107]
    v_exp_f32 v79, v79
    v_mfma_f32_16x16x32_bf16 v[108:111], v[24:27], a[100:103], v[108:111]
    ds_read_b128 v[60:63], v3 offset:17408
    v_mul_f32 v78, v78, v94
    v_mfma_f32_16x16x32_bf16 v[108:111], v[28:31], a[108:111], v[108:111]
    buffer_load_dwordx4 v5, s[8:11], s31 offen offset:2048 lds
    v_mfma_f32_16x16x32_bf16 v[112:115], v[32:35], a[96:99], v[112:115]
    ds_read_b128 v[64:67], v3 offset:18432
    v_fma_f32 v79, v79, s30, s30
    v_mfma_f32_16x16x32_bf16 v[112:115], v[36:39], a[104:107], v[112:115]
    v_rcp_f32 v79, v79
    v_mfma_f32_16x16x32_bf16 v[116:119], v[32:35], a[100:103], v[116:119]
    ds_read_b128 v[68:71], v3 offset:19456
    v_mfma_f32_16x16x32_bf16 v[116:119], v[36:39], a[108:111], v[116:119]
    v_mul_f32 v79, v79, v95
    s_waitcnt lgkmcnt(4)
    v_mfma_f32_16x16x32_bf16 v[120:123], v[40:43], a[96:99], v[120:123]
    ds_read_b128 v[24:27], v3 offset:20480
    v_cvt_pk_bf16_f32 v197, v78, v79
    v_mfma_f32_16x16x32_bf16 v[120:123], v[44:47], a[104:107], v[120:123]
    buffer_load_dwordx4 a[180:183], v11, s[8:11], s48 offen offset:1024 sc1
    v_mfma_f32_16x16x32_bf16 v[124:127], v[40:43], a[100:103], v[124:127]
    ds_read_b128 v[28:31], v3 offset:21504
    v_mfma_f32_16x16x32_bf16 v[124:127], v[44:47], a[108:111], v[124:127]
    buffer_load_dwordx4 v5, s[8:11], s31 offen offset:3072 lds
    v_mfma_f32_16x16x32_bf16 v[128:131], v[48:51], a[96:99], v[128:131]
    ds_read_b128 v[32:35], v3 offset:22528
    v_mfma_f32_16x16x32_bf16 v[128:131], v[52:55], a[104:107], v[128:131]
    v_exp_f32 v84, v84
    v_mfma_f32_16x16x32_bf16 v[132:135], v[48:51], a[100:103], v[132:135]
    ds_read_b128 v[36:39], v3 offset:23552
    s_add_u32 m0, s28, 16384
    v_mfma_f32_16x16x32_bf16 v[132:135], v[52:55], a[108:111], v[132:135]
    s_mov_b32 s31, 671744
    s_waitcnt lgkmcnt(4)
    v_mfma_f32_16x16x32_bf16 v[104:107], v[56:59], a[112:115], v[104:107]
    ds_read_b128 v[40:43], v3 offset:24576
    v_fma_f32 v84, v84, s30, s30
    v_mfma_f32_16x16x32_bf16 v[104:107], v[60:63], a[120:123], v[104:107]
    v_rcp_f32 v84, v84
    v_mfma_f32_16x16x32_bf16 v[108:111], v[56:59], a[116:119], v[108:111]
    ds_read_b128 v[44:47], v3 offset:25600
    v_mfma_f32_16x16x32_bf16 v[108:111], v[60:63], a[124:127], v[108:111]
    buffer_load_dwordx4 v5, s[8:11], s31 offen offset:0 lds
    v_mfma_f32_16x16x32_bf16 v[112:115], v[64:67], a[112:115], v[112:115]
    ds_read_b128 v[48:51], v3 offset:26624
    v_mul_f32 v84, v84, v100
    v_mfma_f32_16x16x32_bf16 v[112:115], v[68:71], a[120:123], v[112:115]
    s_mov_b32 s48, 2048
    buffer_load_dwordx4 a[184:187], v11, s[8:11], s48 offen offset:0 sc1
    v_mfma_f32_16x16x32_bf16 v[116:119], v[64:67], a[116:119], v[116:119]
    ds_read_b128 v[52:55], v3 offset:27648
    v_mfma_f32_16x16x32_bf16 v[116:119], v[68:71], a[124:127], v[116:119]
    s_waitcnt lgkmcnt(4)
    v_mfma_f32_16x16x32_bf16 v[120:123], v[24:27], a[112:115], v[120:123]
    ds_read_b128 v[56:59], v3 offset:28672
    v_mfma_f32_16x16x32_bf16 v[120:123], v[28:31], a[120:123], v[120:123]
    v_exp_f32 v85, v85
    v_mfma_f32_16x16x32_bf16 v[124:127], v[24:27], a[116:119], v[124:127]
    ds_read_b128 v[60:63], v3 offset:29696
    v_mfma_f32_16x16x32_bf16 v[124:127], v[28:31], a[124:127], v[124:127]
    buffer_load_dwordx4 v5, s[8:11], s31 offen offset:1024 lds
    v_mfma_f32_16x16x32_bf16 v[128:131], v[32:35], a[112:115], v[128:131]
    ds_read_b128 v[64:67], v3 offset:30720
    v_fma_f32 v85, v85, s30, s30
    v_mfma_f32_16x16x32_bf16 v[128:131], v[36:39], a[120:123], v[128:131]
    v_rcp_f32 v85, v85
    v_mfma_f32_16x16x32_bf16 v[132:135], v[32:35], a[116:119], v[132:135]
    ds_read_b128 v[68:71], v3 offset:31744
    v_mfma_f32_16x16x32_bf16 v[132:135], v[36:39], a[124:127], v[132:135]
    v_mul_f32 v85, v85, v101
    s_waitcnt lgkmcnt(4)
    v_mfma_f32_16x16x32_bf16 v[104:107], v[40:43], a[128:131], v[104:107]
    s_waitcnt vmcnt(18)
    s_barrier
    ds_read_b128 v[24:27], v3 offset:32768
    v_mfma_f32_16x16x32_bf16 v[104:107], v[44:47], a[136:139], v[104:107]
    buffer_load_dwordx4 a[188:191], v11, s[8:11], s48 offen offset:1024 sc1
    v_mfma_f32_16x16x32_bf16 v[108:111], v[40:43], a[132:135], v[108:111]
    ds_read_b128 v[28:31], v3 offset:33792
    v_cvt_pk_bf16_f32 v198, v84, v85
    v_mfma_f32_16x16x32_bf16 v[108:111], v[44:47], a[140:143], v[108:111]
    buffer_load_dwordx4 v5, s[8:11], s31 offen offset:2048 lds
    v_mfma_f32_16x16x32_bf16 v[112:115], v[48:51], a[128:131], v[112:115]
    ds_read_b128 v[32:35], v3 offset:34816
    v_mfma_f32_16x16x32_bf16 v[112:115], v[52:55], a[136:139], v[112:115]
    v_exp_f32 v86, v86
    v_mfma_f32_16x16x32_bf16 v[116:119], v[48:51], a[132:135], v[116:119]
    ds_read_b128 v[36:39], v3 offset:35840
    v_mfma_f32_16x16x32_bf16 v[116:119], v[52:55], a[140:143], v[116:119]
    v_fma_f32 v86, v86, s30, s30
    s_waitcnt lgkmcnt(4)
    v_mfma_f32_16x16x32_bf16 v[120:123], v[56:59], a[128:131], v[120:123]
    ds_read_b128 v[40:43], v3 offset:36864
    v_mfma_f32_16x16x32_bf16 v[120:123], v[60:63], a[136:139], v[120:123]
    v_rcp_f32 v86, v86
    v_mfma_f32_16x16x32_bf16 v[124:127], v[56:59], a[132:135], v[124:127]
    ds_read_b128 v[44:47], v3 offset:37888
    v_mfma_f32_16x16x32_bf16 v[124:127], v[60:63], a[140:143], v[124:127]
    buffer_load_dwordx4 v5, s[8:11], s31 offen offset:3072 lds
    v_mfma_f32_16x16x32_bf16 v[128:131], v[64:67], a[128:131], v[128:131]
    ds_read_b128 v[48:51], v3 offset:38912
    v_mul_f32 v86, v86, v102
    v_mfma_f32_16x16x32_bf16 v[128:131], v[68:71], a[136:139], v[128:131]
    s_mov_b32 s48, 4096
    buffer_load_dwordx4 a[192:195], v11, s[8:11], s48 offen offset:0 sc1
    v_mfma_f32_16x16x32_bf16 v[132:135], v[64:67], a[132:135], v[132:135]
    ds_read_b128 v[52:55], v3 offset:39936
    s_add_u32 m0, s28, 32768
    v_mfma_f32_16x16x32_bf16 v[132:135], v[68:71], a[140:143], v[132:135]
    s_mov_b32 s31, 688128
    s_waitcnt lgkmcnt(4)
    v_mfma_f32_16x16x32_bf16 v[216:219], v[24:27], a[0:3], 0
    ds_read_b128 v[56:59], v3 offset:40960
    v_exp_f32 v87, v87
    v_mfma_f32_16x16x32_bf16 v[216:219], v[28:31], a[8:11], v[216:219]
    v_mfma_f32_16x16x32_bf16 v[220:223], v[24:27], a[4:7], 0
    ds_read_b128 v[60:63], v3 offset:41984
    v_fma_f32 v87, v87, s30, s30
    v_mfma_f32_16x16x32_bf16 v[220:223], v[28:31], a[12:15], v[220:223]
    buffer_load_dwordx4 v5, s[8:11], s31 offen offset:0 lds
    v_mfma_f32_16x16x32_bf16 v[224:227], v[32:35], a[0:3], 0
    ds_read_b128 v[64:67], v3 offset:43008
    v_mfma_f32_16x16x32_bf16 v[224:227], v[36:39], a[8:11], v[224:227]
    v_rcp_f32 v87, v87
    v_mfma_f32_16x16x32_bf16 v[228:231], v[32:35], a[4:7], 0
    ds_read_b128 v[68:71], v3 offset:44032
    v_mfma_f32_16x16x32_bf16 v[228:231], v[36:39], a[12:15], v[228:231]
    v_mul_f32 v87, v87, v103
    s_waitcnt lgkmcnt(4)
    v_mfma_f32_16x16x32_bf16 v[232:235], v[40:43], a[0:3], 0
    ds_read_b128 v[24:27], v3 offset:45056
    v_cvt_pk_bf16_f32 v199, v86, v87
    v_mfma_f32_16x16x32_bf16 v[232:235], v[44:47], a[8:11], v[232:235]
    buffer_load_dwordx4 a[196:199], v11, s[8:11], s48 offen offset:1024 sc1
    v_mfma_f32_16x16x32_bf16 v[236:239], v[40:43], a[4:7], 0
    ds_read_b128 v[28:31], v3 offset:46080
    s_mov_b32 s29, 12288
    v_mfma_f32_16x16x32_bf16 v[236:239], v[44:47], a[12:15], v[236:239]
    buffer_load_dwordx4 v5, s[8:11], s31 offen offset:1024 lds
    v_mfma_f32_16x16x32_bf16 v[240:243], v[48:51], a[0:3], 0
    ds_read_b128 v[32:35], v3 offset:47104
    v_mfma_f32_16x16x32_bf16 v[240:243], v[52:55], a[8:11], v[240:243]
    buffer_store_dwordx4 v[196:199], v8, s[8:11], s29 offen offset:1024 sc1
    v_mfma_f32_16x16x32_bf16 v[244:247], v[48:51], a[4:7], 0
    ds_read_b128 v[36:39], v3 offset:48128
    v_exp_f32 v104, v104
    v_mfma_f32_16x16x32_bf16 v[244:247], v[52:55], a[12:15], v[244:247]
    v_exp_f32 v105, v105
    s_waitcnt lgkmcnt(4)
    v_mfma_f32_16x16x32_bf16 v[216:219], v[56:59], a[16:19], v[216:219]
    ds_read_b128 v[40:43], v3 offset:49152
    v_fma_f32 v104, v104, s30, s30
    v_mfma_f32_16x16x32_bf16 v[216:219], v[60:63], a[24:27], v[216:219]
    v_rcp_f32 v104, v104
    v_mfma_f32_16x16x32_bf16 v[220:223], v[56:59], a[20:23], v[220:223]
    ds_read_b128 v[44:47], v3 offset:50176
    v_fma_f32 v105, v105, s30, s30
    v_mfma_f32_16x16x32_bf16 v[220:223], v[60:63], a[28:31], v[220:223]
    buffer_load_dwordx4 v5, s[8:11], s31 offen offset:2048 lds
    v_mfma_f32_16x16x32_bf16 v[224:227], v[64:67], a[16:19], v[224:227]
    ds_read_b128 v[48:51], v3 offset:51200
    v_mul_f32 v104, v104, v120
    v_mfma_f32_16x16x32_bf16 v[224:227], v[68:71], a[24:27], v[224:227]
    s_mov_b32 s48, 6144
    buffer_load_dwordx4 a[200:203], v11, s[8:11], s48 offen offset:0 sc1
    v_mfma_f32_16x16x32_bf16 v[228:231], v[64:67], a[20:23], v[228:231]
    ds_read_b128 v[52:55], v3 offset:52224
    v_rcp_f32 v105, v105
    v_mfma_f32_16x16x32_bf16 v[228:231], v[68:71], a[28:31], v[228:231]
    v_exp_f32 v106, v106
    s_waitcnt lgkmcnt(4)
    v_mfma_f32_16x16x32_bf16 v[232:235], v[24:27], a[16:19], v[232:235]
    ds_read_b128 v[56:59], v3 offset:53248
    v_mul_f32 v105, v105, v121
    v_mfma_f32_16x16x32_bf16 v[232:235], v[28:31], a[24:27], v[232:235]
    v_exp_f32 v107, v107
    v_mfma_f32_16x16x32_bf16 v[236:239], v[24:27], a[20:23], v[236:239]
    ds_read_b128 v[60:63], v3 offset:54272
    v_fma_f32 v106, v106, s30, s30
    v_mfma_f32_16x16x32_bf16 v[236:239], v[28:31], a[28:31], v[236:239]
    buffer_load_dwordx4 v5, s[8:11], s31 offen offset:3072 lds
    v_mfma_f32_16x16x32_bf16 v[240:243], v[32:35], a[16:19], v[240:243]
    ds_read_b128 v[64:67], v3 offset:55296
    v_fma_f32 v107, v107, s30, s30
    v_mfma_f32_16x16x32_bf16 v[240:243], v[36:39], a[24:27], v[240:243]
    v_rcp_f32 v106, v106
    v_mfma_f32_16x16x32_bf16 v[244:247], v[32:35], a[20:23], v[244:247]
    ds_read_b128 v[68:71], v3 offset:56320
    s_add_u32 m0, s28, 49152
    v_mfma_f32_16x16x32_bf16 v[244:247], v[36:39], a[28:31], v[244:247]
    s_mov_b32 s31, 704512
    s_waitcnt lgkmcnt(4)
    v_mfma_f32_16x16x32_bf16 v[216:219], v[40:43], a[32:35], v[216:219]
    ds_read_b128 v[24:27], v3 offset:57344
    v_mul_f32 v106, v106, v122
    v_mfma_f32_16x16x32_bf16 v[216:219], v[44:47], a[40:43], v[216:219]
    buffer_load_dwordx4 a[204:207], v11, s[8:11], s48 offen offset:1024 sc1
    v_mfma_f32_16x16x32_bf16 v[220:223], v[40:43], a[36:39], v[220:223]
    ds_read_b128 v[28:31], v3 offset:58368
    v_cvt_pk_bf16_f32 v200, v104, v105
    v_mfma_f32_16x16x32_bf16 v[220:223], v[44:47], a[44:47], v[220:223]
    buffer_load_dwordx4 v5, s[8:11], s31 offen offset:0 lds
    v_mfma_f32_16x16x32_bf16 v[224:227], v[48:51], a[32:35], v[224:227]
    ds_read_b128 v[32:35], v3 offset:59392
    v_rcp_f32 v107, v107
    v_mfma_f32_16x16x32_bf16 v[224:227], v[52:55], a[40:43], v[224:227]
    v_exp_f32 v112, v112
    v_mfma_f32_16x16x32_bf16 v[228:231], v[48:51], a[36:39], v[228:231]
    ds_read_b128 v[36:39], v3 offset:60416
    v_mul_f32 v107, v107, v123
    v_mfma_f32_16x16x32_bf16 v[228:231], v[52:55], a[44:47], v[228:231]
    v_cvt_pk_bf16_f32 v201, v106, v107
    s_waitcnt lgkmcnt(4)
    v_mfma_f32_16x16x32_bf16 v[232:235], v[56:59], a[32:35], v[232:235]
    ds_read_b128 v[40:43], v3 offset:61440
    v_fma_f32 v112, v112, s30, s30
    v_mfma_f32_16x16x32_bf16 v[232:235], v[60:63], a[40:43], v[232:235]
    v_rcp_f32 v112, v112
    v_mfma_f32_16x16x32_bf16 v[236:239], v[56:59], a[36:39], v[236:239]
    ds_read_b128 v[44:47], v3 offset:62464
    v_exp_f32 v113, v113
    v_mfma_f32_16x16x32_bf16 v[236:239], v[60:63], a[44:47], v[236:239]
    buffer_load_dwordx4 v5, s[8:11], s31 offen offset:1024 lds
    v_mfma_f32_16x16x32_bf16 v[240:243], v[64:67], a[32:35], v[240:243]
    ds_read_b128 v[48:51], v3 offset:63488
    v_mul_f32 v112, v112, v128
    v_mfma_f32_16x16x32_bf16 v[240:243], v[68:71], a[40:43], v[240:243]
    s_mov_b32 s48, 0
    buffer_load_dwordx4 a[208:211], v12, s[8:11], s48 offen offset:0 sc1
    v_mfma_f32_16x16x32_bf16 v[244:247], v[64:67], a[36:39], v[244:247]
    ds_read_b128 v[52:55], v3 offset:64512
    v_fma_f32 v113, v113, s30, s30
    v_mfma_f32_16x16x32_bf16 v[244:247], v[68:71], a[44:47], v[244:247]
    v_rcp_f32 v113, v113
    s_waitcnt lgkmcnt(4)
    v_mfma_f32_16x16x32_bf16 v[216:219], v[24:27], a[48:51], v[216:219]
    ds_read_b128 v[56:59], v4 offset:0
    v_mfma_f32_16x16x32_bf16 v[216:219], v[28:31], a[56:59], v[216:219]
    v_exp_f32 v114, v114
    v_mfma_f32_16x16x32_bf16 v[220:223], v[24:27], a[52:55], v[220:223]
    ds_read_b128 v[60:63], v4 offset:1024
    v_mul_f32 v113, v113, v129
    v_mfma_f32_16x16x32_bf16 v[220:223], v[28:31], a[60:63], v[220:223]
    buffer_load_dwordx4 v5, s[8:11], s31 offen offset:2048 lds
    v_mfma_f32_16x16x32_bf16 v[224:227], v[32:35], a[48:51], v[224:227]
    ds_read_b128 v[64:67], v4 offset:2048
    v_fma_f32 v114, v114, s30, s30
k4_kernel_j905:
    v_mfma_f32_16x16x32_bf16 v[224:227], v[36:39], a[56:59], v[224:227]
    v_rcp_f32 v114, v114
    v_mfma_f32_16x16x32_bf16 v[228:231], v[32:35], a[52:55], v[228:231]
    ds_read_b128 v[68:71], v4 offset:3072
    v_cvt_pk_bf16_f32 v202, v112, v113
    v_mfma_f32_16x16x32_bf16 v[228:231], v[36:39], a[60:63], v[228:231]
    v_mul_f32 v114, v114, v130
    s_waitcnt lgkmcnt(4)
    v_mfma_f32_16x16x32_bf16 v[232:235], v[40:43], a[48:51], v[232:235]
    ds_read_b128 v[24:27], v4 offset:4096
    v_mfma_f32_16x16x32_bf16 v[232:235], v[44:47], a[56:59], v[232:235]
    buffer_load_dwordx4 a[212:215], v12, s[8:11], s48 offen offset:1024 sc1
    v_mfma_f32_16x16x32_bf16 v[236:239], v[40:43], a[52:55], v[236:239]
    ds_read_b128 v[28:31], v4 offset:5120
    v_mfma_f32_16x16x32_bf16 v[236:239], v[44:47], a[60:63], v[236:239]
    buffer_load_dwordx4 v5, s[8:11], s31 offen offset:3072 lds
    v_mfma_f32_16x16x32_bf16 v[240:243], v[48:51], a[48:51], v[240:243]
    ds_read_b128 v[32:35], v4 offset:6144
    v_mfma_f32_16x16x32_bf16 v[240:243], v[52:55], a[56:59], v[240:243]
    v_exp_f32 v115, v115
    v_mfma_f32_16x16x32_bf16 v[244:247], v[48:51], a[52:55], v[244:247]
    ds_read_b128 v[36:39], v4 offset:7168
    s_add_u32 m0, s28, 65536
    v_mfma_f32_16x16x32_bf16 v[244:247], v[52:55], a[60:63], v[244:247]
    s_mov_b32 s31, 720896
    s_waitcnt lgkmcnt(4)
    v_mfma_f32_16x16x32_bf16 v[216:219], v[56:59], a[64:67], v[216:219]
    ds_read_b128 v[40:43], v4 offset:8192
    v_fma_f32 v115, v115, s30, s30
    v_mfma_f32_16x16x32_bf16 v[216:219], v[60:63], a[72:75], v[216:219]
    v_rcp_f32 v115, v115
    v_mfma_f32_16x16x32_bf16 v[220:223], v[56:59], a[68:71], v[220:223]
    ds_read_b128 v[44:47], v4 offset:9216
    v_mfma_f32_16x16x32_bf16 v[220:223], v[60:63], a[76:79], v[220:223]
    buffer_load_dwordx4 v5, s[8:11], s31 offen offset:0 lds
    v_mfma_f32_16x16x32_bf16 v[224:227], v[64:67], a[64:67], v[224:227]
    ds_read_b128 v[48:51], v4 offset:10240
    v_mul_f32 v115, v115, v131
    v_mfma_f32_16x16x32_bf16 v[224:227], v[68:71], a[72:75], v[224:227]
    s_mov_b32 s48, 2048
    buffer_load_dwordx4 a[216:219], v12, s[8:11], s48 offen offset:0 sc1
    v_mfma_f32_16x16x32_bf16 v[228:231], v[64:67], a[68:71], v[228:231]
    ds_read_b128 v[52:55], v4 offset:11264
    v_cvt_pk_bf16_f32 v203, v114, v115
    v_mfma_f32_16x16x32_bf16 v[228:231], v[68:71], a[76:79], v[228:231]
    s_mov_b32 s29, 14336
    s_waitcnt lgkmcnt(4)
    v_mfma_f32_16x16x32_bf16 v[232:235], v[24:27], a[64:67], v[232:235]
    ds_read_b128 v[56:59], v4 offset:12288
    buffer_store_dwordx4 v[200:203], v8, s[8:11], s29 offen offset:0 sc1
    v_mfma_f32_16x16x32_bf16 v[232:235], v[28:31], a[72:75], v[232:235]
    v_exp_f32 v108, v108
    v_mfma_f32_16x16x32_bf16 v[236:239], v[24:27], a[68:71], v[236:239]
    ds_read_b128 v[60:63], v4 offset:13312
    v_mfma_f32_16x16x32_bf16 v[236:239], v[28:31], a[76:79], v[236:239]
    buffer_load_dwordx4 v5, s[8:11], s31 offen offset:1024 lds
    v_mfma_f32_16x16x32_bf16 v[240:243], v[32:35], a[64:67], v[240:243]
    ds_read_b128 v[64:67], v4 offset:14336
    v_fma_f32 v108, v108, s30, s30
    v_mfma_f32_16x16x32_bf16 v[240:243], v[36:39], a[72:75], v[240:243]
    v_rcp_f32 v108, v108
    v_mfma_f32_16x16x32_bf16 v[244:247], v[32:35], a[68:71], v[244:247]
    ds_read_b128 v[68:71], v4 offset:15360
    v_mfma_f32_16x16x32_bf16 v[244:247], v[36:39], a[76:79], v[244:247]
    v_mul_f32 v108, v108, v124
    s_waitcnt lgkmcnt(4)
    v_mfma_f32_16x16x32_bf16 v[216:219], v[40:43], a[80:83], v[216:219]
    s_waitcnt vmcnt(19)
    s_barrier
    ds_read_b128 v[24:27], v4 offset:16384
    v_mfma_f32_16x16x32_bf16 v[216:219], v[44:47], a[88:91], v[216:219]
    buffer_load_dwordx4 a[220:223], v12, s[8:11], s48 offen offset:1024 sc1
    v_mfma_f32_16x16x32_bf16 v[220:223], v[40:43], a[84:87], v[220:223]
    ds_read_b128 v[28:31], v4 offset:17408
    v_exp_f32 v109, v109
    v_mfma_f32_16x16x32_bf16 v[220:223], v[44:47], a[92:95], v[220:223]
    buffer_load_dwordx4 v5, s[8:11], s31 offen offset:2048 lds
    v_mfma_f32_16x16x32_bf16 v[224:227], v[48:51], a[80:83], v[224:227]
    ds_read_b128 v[32:35], v4 offset:18432
    v_fma_f32 v109, v109, s30, s30
    v_mfma_f32_16x16x32_bf16 v[224:227], v[52:55], a[88:91], v[224:227]
    v_rcp_f32 v109, v109
    v_mfma_f32_16x16x32_bf16 v[228:231], v[48:51], a[84:87], v[228:231]
    ds_read_b128 v[36:39], v4 offset:19456
    v_mfma_f32_16x16x32_bf16 v[228:231], v[52:55], a[92:95], v[228:231]
    v_mul_f32 v109, v109, v125
    s_waitcnt lgkmcnt(4)
    v_mfma_f32_16x16x32_bf16 v[232:235], v[56:59], a[80:83], v[232:235]
    ds_read_b128 v[40:43], v4 offset:20480
    v_cvt_pk_bf16_f32 v204, v108, v109
    v_mfma_f32_16x16x32_bf16 v[232:235], v[60:63], a[88:91], v[232:235]
    s_waitcnt vmcnt(16)
    buffer_store_dword v13, v14, s[8:11], s47 offen sc1
    v_mfma_f32_16x16x32_bf16 v[236:239], v[56:59], a[84:87], v[236:239]
    ds_read_b128 v[44:47], v4 offset:21504
    v_mfma_f32_16x16x32_bf16 v[236:239], v[60:63], a[92:95], v[236:239]
    buffer_load_dwordx4 v5, s[8:11], s31 offen offset:3072 lds
    v_mfma_f32_16x16x32_bf16 v[240:243], v[64:67], a[80:83], v[240:243]
    ds_read_b128 v[48:51], v4 offset:22528
    v_mfma_f32_16x16x32_bf16 v[240:243], v[68:71], a[88:91], v[240:243]
    s_mov_b32 s48, 4096
    buffer_load_dwordx4 a[224:227], v12, s[8:11], s48 offen offset:0 sc1
    v_mfma_f32_16x16x32_bf16 v[244:247], v[64:67], a[84:87], v[244:247]
    ds_read_b128 v[52:55], v4 offset:23552
    v_exp_f32 v110, v110
    v_mfma_f32_16x16x32_bf16 v[244:247], v[68:71], a[92:95], v[244:247]
    s_add_u32 m0, s28, 81920
    s_waitcnt lgkmcnt(4)
    v_mfma_f32_16x16x32_bf16 v[216:219], v[24:27], a[96:99], v[216:219]
    ds_read_b128 v[56:59], v4 offset:24576
    s_mov_b32 s31, 737280
    v_mfma_f32_16x16x32_bf16 v[216:219], v[28:31], a[104:107], v[216:219]
    v_exp_f32 v111, v111
    v_mfma_f32_16x16x32_bf16 v[220:223], v[24:27], a[100:103], v[220:223]
    ds_read_b128 v[60:63], v4 offset:25600
    v_fma_f32 v110, v110, s30, s30
    v_mfma_f32_16x16x32_bf16 v[220:223], v[28:31], a[108:111], v[220:223]
    buffer_load_dwordx4 v5, s[8:11], s31 offen offset:0 lds
    v_mfma_f32_16x16x32_bf16 v[224:227], v[32:35], a[96:99], v[224:227]
    ds_read_b128 v[64:67], v4 offset:26624
    v_fma_f32 v111, v111, s30, s30
    v_mfma_f32_16x16x32_bf16 v[224:227], v[36:39], a[104:107], v[224:227]
    v_rcp_f32 v110, v110
    v_mfma_f32_16x16x32_bf16 v[228:231], v[32:35], a[100:103], v[228:231]
    ds_read_b128 v[68:71], v4 offset:27648
    v_mfma_f32_16x16x32_bf16 v[228:231], v[36:39], a[108:111], v[228:231]
    v_mul_f32 v110, v110, v126
    s_waitcnt lgkmcnt(4)
    v_mfma_f32_16x16x32_bf16 v[232:235], v[40:43], a[96:99], v[232:235]
    ds_read_b128 v[24:27], v4 offset:28672
    v_mfma_f32_16x16x32_bf16 v[232:235], v[44:47], a[104:107], v[232:235]
    buffer_load_dwordx4 a[228:231], v12, s[8:11], s48 offen offset:1024 sc1
    v_mfma_f32_16x16x32_bf16 v[236:239], v[40:43], a[100:103], v[236:239]
    ds_read_b128 v[28:31], v4 offset:29696
    v_mfma_f32_16x16x32_bf16 v[236:239], v[44:47], a[108:111], v[236:239]
    buffer_load_dwordx4 v5, s[8:11], s31 offen offset:1024 lds
    v_mfma_f32_16x16x32_bf16 v[240:243], v[48:51], a[96:99], v[240:243]
    ds_read_b128 v[32:35], v4 offset:30720
    v_mfma_f32_16x16x32_bf16 v[240:243], v[52:55], a[104:107], v[240:243]
    v_rcp_f32 v111, v111
    v_mfma_f32_16x16x32_bf16 v[244:247], v[48:51], a[100:103], v[244:247]
    ds_read_b128 v[36:39], v4 offset:31744
    v_mfma_f32_16x16x32_bf16 v[244:247], v[52:55], a[108:111], v[244:247]
    v_mul_f32 v111, v111, v127
    s_waitcnt lgkmcnt(4)
    v_mfma_f32_16x16x32_bf16 v[216:219], v[56:59], a[112:115], v[216:219]
    ds_read_b128 v[40:43], v2 offset:0
    v_cvt_pk_bf16_f32 v205, v110, v111
    v_mfma_f32_16x16x32_bf16 v[216:219], v[60:63], a[120:123], v[216:219]
    v_exp_f32 v116, v116
    v_mfma_f32_16x16x32_bf16 v[220:223], v[56:59], a[116:119], v[220:223]
    ds_read_b128 v[44:47], v2 offset:1024
    v_mfma_f32_16x16x32_bf16 v[220:223], v[60:63], a[124:127], v[220:223]
    buffer_load_dwordx4 v5, s[8:11], s31 offen offset:2048 lds
    v_mfma_f32_16x16x32_bf16 v[224:227], v[64:67], a[112:115], v[224:227]
    ds_read_b128 v[48:51], v2 offset:2048
    v_fma_f32 v116, v116, s30, s30
    v_mfma_f32_16x16x32_bf16 v[224:227], v[68:71], a[120:123], v[224:227]
    s_mov_b32 s48, 6144
    buffer_load_dwordx4 a[232:235], v12, s[8:11], s48 offen offset:0 sc1
    v_mfma_f32_16x16x32_bf16 v[228:231], v[64:67], a[116:119], v[228:231]
    ds_read_b128 v[52:55], v2 offset:3072
    v_mfma_f32_16x16x32_bf16 v[228:231], v[68:71], a[124:127], v[228:231]
    v_rcp_f32 v116, v116
    s_waitcnt lgkmcnt(4)
    v_mfma_f32_16x16x32_bf16 v[232:235], v[24:27], a[112:115], v[232:235]
    ds_read_b128 v[56:59], v2 offset:4096
    v_mfma_f32_16x16x32_bf16 v[232:235], v[28:31], a[120:123], v[232:235]
    v_exp_f32 v117, v117
    v_mfma_f32_16x16x32_bf16 v[236:239], v[24:27], a[116:119], v[236:239]
    ds_read_b128 v[60:63], v2 offset:5120
    v_mul_f32 v116, v116, v132
    v_mfma_f32_16x16x32_bf16 v[236:239], v[28:31], a[124:127], v[236:239]
    buffer_load_dwordx4 v5, s[8:11], s31 offen offset:3072 lds
    v_mfma_f32_16x16x32_bf16 v[240:243], v[32:35], a[112:115], v[240:243]
    ds_read_b128 v[64:67], v2 offset:6144
    v_fma_f32 v117, v117, s30, s30
    v_mfma_f32_16x16x32_bf16 v[240:243], v[36:39], a[120:123], v[240:243]
    v_rcp_f32 v117, v117
    v_mfma_f32_16x16x32_bf16 v[244:247], v[32:35], a[116:119], v[244:247]
    ds_read_b128 v[68:71], v2 offset:7168
    s_add_u32 m0, s28, 98304
    v_mfma_f32_16x16x32_bf16 v[244:247], v[36:39], a[124:127], v[244:247]
    s_mov_b32 s31, 753664
    s_waitcnt lgkmcnt(4)
    v_mfma_f32_16x16x32_bf16 v[216:219], v[40:43], a[128:131], v[216:219]
    ds_read_b128 v[24:27], v2 offset:8192
    v_mul_f32 v117, v117, v133
    v_mfma_f32_16x16x32_bf16 v[216:219], v[44:47], a[136:139], v[216:219]
    buffer_load_dwordx4 a[236:239], v12, s[8:11], s48 offen offset:1024 sc1
    v_mfma_f32_16x16x32_bf16 v[220:223], v[40:43], a[132:135], v[220:223]
    ds_read_b128 v[28:31], v2 offset:9216
    v_cvt_pk_bf16_f32 v206, v116, v117
    v_mfma_f32_16x16x32_bf16 v[220:223], v[44:47], a[140:143], v[220:223]
    buffer_load_dwordx4 v5, s[8:11], s31 offen offset:0 lds
    v_mfma_f32_16x16x32_bf16 v[224:227], v[48:51], a[128:131], v[224:227]
    ds_read_b128 v[32:35], v2 offset:10240
    v_mfma_f32_16x16x32_bf16 v[224:227], v[52:55], a[136:139], v[224:227]
    v_exp_f32 v118, v118
    v_mfma_f32_16x16x32_bf16 v[228:231], v[48:51], a[132:135], v[228:231]
    ds_read_b128 v[36:39], v2 offset:11264
    v_mfma_f32_16x16x32_bf16 v[228:231], v[52:55], a[140:143], v[228:231]
    v_fma_f32 v118, v118, s30, s30
    s_waitcnt lgkmcnt(4)
    v_mfma_f32_16x16x32_bf16 v[232:235], v[56:59], a[128:131], v[232:235]
    ds_read_b128 v[40:43], v2 offset:12288
    v_mfma_f32_16x16x32_bf16 v[232:235], v[60:63], a[136:139], v[232:235]
    v_rcp_f32 v118, v118
    v_mfma_f32_16x16x32_bf16 v[236:239], v[56:59], a[132:135], v[236:239]
    ds_read_b128 v[44:47], v2 offset:13312
    v_mfma_f32_16x16x32_bf16 v[236:239], v[60:63], a[140:143], v[236:239]
    buffer_load_dwordx4 v5, s[8:11], s31 offen offset:1024 lds
    v_mfma_f32_16x16x32_bf16 v[240:243], v[64:67], a[128:131], v[240:243]
    ds_read_b128 v[48:51], v2 offset:14336
    v_mul_f32 v118, v118, v134
    v_mfma_f32_16x16x32_bf16 v[240:243], v[68:71], a[136:139], v[240:243]
    v_exp_f32 v119, v119
    v_mfma_f32_16x16x32_bf16 v[244:247], v[64:67], a[132:135], v[244:247]
    ds_read_b128 v[52:55], v2 offset:15360
    v_mfma_f32_16x16x32_bf16 v[244:247], v[68:71], a[140:143], v[244:247]
    v_fma_f32 v119, v119, s30, s30
    s_waitcnt lgkmcnt(4)
    v_mfma_f32_16x16x32_bf16 v[136:139], v[24:27], v[144:147], 0
    ds_read_b128 v[56:59], v2 offset:16384
    ds_read_b128 v[60:63], v2 offset:17408
    v_mfma_f32_16x16x32_bf16 v[136:139], v[28:31], v[152:155], v[136:139]
    buffer_load_dwordx4 v[16:19], v14, s[8:11], 0 offen sc1
    v_mfma_f32_16x16x32_bf16 v[140:143], v[24:27], v[148:151], 0
    v_rcp_f32 v119, v119
    v_mfma_f32_16x16x32_bf16 v[140:143], v[28:31], v[156:159], v[140:143]
    buffer_load_dwordx4 v5, s[8:11], s31 offen offset:2048 lds
    v_mfma_f32_16x16x32_bf16 v[72:75], v[32:35], v[144:147], 0
    ds_read_b128 v[64:67], v2 offset:18432
    ds_read_b128 v[68:71], v2 offset:19456
    v_mfma_f32_16x16x32_bf16 v[72:75], v[36:39], v[152:155], v[72:75]
    v_exp_f32 v216, v216
    v_mfma_f32_16x16x32_bf16 v[76:79], v[32:35], v[148:151], 0
    v_exp_f32 v217, v217
    v_mfma_f32_16x16x32_bf16 v[76:79], v[36:39], v[156:159], v[76:79]
    v_mul_f32 v119, v119, v135
    s_waitcnt lgkmcnt(4)
    v_mfma_f32_16x16x32_bf16 v[80:83], v[40:43], v[144:147], 0
    ds_read_b128 v[24:27], v2 offset:20480
    ds_read_b128 v[28:31], v2 offset:21504
    v_mfma_f32_16x16x32_bf16 v[80:83], v[44:47], v[152:155], v[80:83]
    v_add_u32 v251, k4_kernel_j1305-k4_kernel_pc, v250
    v_min_u32 v251, k4_kernel_end-k4_kernel_pc, v251
    global_load_dword v252, v251, s[40:41]
    v_mfma_f32_16x16x32_bf16 v[84:87], v[40:43], v[148:151], 0
    v_exp_f32 v218, v218
    v_mfma_f32_16x16x32_bf16 v[84:87], v[44:47], v[156:159], v[84:87]
    buffer_load_dwordx4 v5, s[8:11], s31 offen offset:3072 lds
    v_mfma_f32_16x16x32_bf16 v[88:91], v[48:51], v[144:147], 0
    ds_read_b128 v[32:35], v2 offset:22528
    ds_read_b128 v[36:39], v2 offset:23552
    v_mfma_f32_16x16x32_bf16 v[88:91], v[52:55], v[152:155], v[88:91]
    v_exp_f32 v219, v219
    v_mfma_f32_16x16x32_bf16 v[92:95], v[48:51], v[148:151], 0
    v_exp_f32 v224, v224
    v_mfma_f32_16x16x32_bf16 v[92:95], v[52:55], v[156:159], v[92:95]
    v_exp_f32 v225, v225
    s_waitcnt lgkmcnt(4)
    v_mfma_f32_16x16x32_bf16 v[96:99], v[56:59], v[144:147], 0
    ds_read_b128 v[40:43], v2 offset:24576
    ds_read_b128 v[44:47], v2 offset:25600
    v_mfma_f32_16x16x32_bf16 v[96:99], v[60:63], v[152:155], v[96:99]
    v_exp_f32 v226, v226
    v_mfma_f32_16x16x32_bf16 v[100:103], v[56:59], v[148:151], 0
    v_exp_f32 v227, v227
    s_nop 0
    v_cvt_pk_bf16_f32 v207, v118, v119
    v_mfma_f32_16x16x32_bf16 v[100:103], v[60:63], v[156:159], v[100:103]
    s_add_u32 m0, s28, 114688
    s_mov_b32 s31, 770048
    buffer_load_dwordx4 v5, s[8:11], s31 offen offset:0 lds
    v_mfma_f32_16x16x32_bf16 v[104:107], v[64:67], v[144:147], 0
    ds_read_b128 v[48:51], v2 offset:26624
    ds_read_b128 v[52:55], v2 offset:27648
    v_mfma_f32_16x16x32_bf16 v[104:107], v[68:71], v[152:155], v[104:107]
    v_exp_f32 v220, v220
    v_mfma_f32_16x16x32_bf16 v[108:111], v[64:67], v[148:151], 0
    v_exp_f32 v221, v221
    v_mfma_f32_16x16x32_bf16 v[108:111], v[68:71], v[156:159], v[108:111]
    s_mov_b32 s29, 14336
    s_waitcnt lgkmcnt(4)
    v_mfma_f32_16x16x32_bf16 v[112:115], v[24:27], v[144:147], 0
    ds_read_b128 v[56:59], v2 offset:28672
    ds_read_b128 v[60:63], v2 offset:29696
    v_mfma_f32_16x16x32_bf16 v[112:115], v[28:31], v[152:155], v[112:115]
    buffer_store_dwordx4 v[204:207], v8, s[8:11], s29 offen offset:1024 sc1
    v_mfma_f32_16x16x32_bf16 v[116:119], v[24:27], v[148:151], 0
    v_exp_f32 v222, v222
    v_mfma_f32_16x16x32_bf16 v[116:119], v[28:31], v[156:159], v[116:119]
    buffer_load_dwordx4 v5, s[8:11], s31 offen offset:1024 lds
    v_mfma_f32_16x16x32_bf16 v[136:139], v[32:35], v[160:163], v[136:139]
    ds_read_b128 v[64:67], v2 offset:30720
    ds_read_b128 v[68:71], v2 offset:31744
    v_mfma_f32_16x16x32_bf16 v[136:139], v[36:39], v[168:171], v[136:139]
    v_exp_f32 v223, v223
    v_mfma_f32_16x16x32_bf16 v[140:143], v[32:35], v[164:167], v[140:143]
    v_exp_f32 v228, v228
    v_mfma_f32_16x16x32_bf16 v[140:143], v[36:39], v[172:175], v[140:143]
    v_fma_f32 v216, v216, s30, s30
    s_waitcnt lgkmcnt(4)
    v_mfma_f32_16x16x32_bf16 v[72:75], v[40:43], v[160:163], v[72:75]
    s_waitcnt vmcnt(17)
    s_barrier
    ds_read_b128 v[24:27], v2 offset:32768
    ds_read_b128 v[28:31], v2 offset:33792
    v_mfma_f32_16x16x32_bf16 v[72:75], v[44:47], v[168:171], v[72:75]
    v_rcp_f32 v216, v216
    v_mfma_f32_16x16x32_bf16 v[76:79], v[40:43], v[164:167], v[76:79]
    v_exp_f32 v229, v229
    v_mfma_f32_16x16x32_bf16 v[76:79], v[44:47], v[172:175], v[76:79]
    buffer_load_dwordx4 v5, s[8:11], s31 offen offset:2048 lds
    v_mfma_f32_16x16x32_bf16 v[80:83], v[48:51], v[160:163], v[80:83]
    ds_read_b128 v[32:35], v2 offset:34816
    ds_read_b128 v[36:39], v2 offset:35840
    v_mfma_f32_16x16x32_bf16 v[80:83], v[52:55], v[168:171], v[80:83]
    v_mul_f32 v216, v216, v232
    v_fma_f32 v217, v217, s30, s30
    v_mfma_f32_16x16x32_bf16 v[84:87], v[48:51], v[164:167], v[84:87]
    v_rcp_f32 v217, v217
    v_mfma_f32_16x16x32_bf16 v[84:87], v[52:55], v[172:175], v[84:87]
    v_fma_f32 v218, v218, s30, s30
    s_waitcnt lgkmcnt(4)
    v_mfma_f32_16x16x32_bf16 v[88:91], v[56:59], v[160:163], v[88:91]
    ds_read_b128 v[40:43], v2 offset:36864
    ds_read_b128 v[44:47], v2 offset:37888
    v_mfma_f32_16x16x32_bf16 v[88:91], v[60:63], v[168:171], v[88:91]
    s_waitcnt vmcnt(7)
k4_kernel_f1a:
    v_and_b32 v20, v16, v17
    v_and_b32 v21, v18, v19
    v_and_b32 v20, v20, v21
    v_cmp_ne_u32 vcc, 0, v20
    s_cbranch_vccnz k4_kernel_f1b
    s_sub_u32 s34, s34, 1
    s_cmp_lt_i32 s34, 0
    s_cbranch_scc1 k4_kernel_f1b
    buffer_load_dwordx4 v[16:19], v14, s[8:11], 0 offen sc1
    s_waitcnt vmcnt(0)
    s_branch k4_kernel_f1a
k4_kernel_f1b:
    v_mfma_f32_16x16x32_bf16 v[92:95], v[56:59], v[164:167], v[92:95]
    v_rcp_f32 v218, v218
    v_mfma_f32_16x16x32_bf16 v[92:95], v[60:63], v[172:175], v[92:95]
    buffer_load_dwordx4 v5, s[8:11], s31 offen offset:3072 lds
    v_mfma_f32_16x16x32_bf16 v[96:99], v[64:67], v[160:163], v[96:99]
    ds_read_b128 v[48:51], v2 offset:38912
    ds_read_b128 v[52:55], v2 offset:39936
    v_mfma_f32_16x16x32_bf16 v[96:99], v[68:71], v[168:171], v[96:99]
    s_mov_b32 s48, 8192
    buffer_load_dwordx4 a[0:3], v10, s[8:11], s48 offen offset:0 sc1
    v_mfma_f32_16x16x32_bf16 v[100:103], v[64:67], v[164:167], v[100:103]
    s_add_u32 m0, s28, 131072
    s_mov_b32 s31, 786432
    v_mfma_f32_16x16x32_bf16 v[100:103], v[68:71], v[172:175], v[100:103]
    v_mul_f32 v217, v217, v233
    s_waitcnt lgkmcnt(4)
    v_mfma_f32_16x16x32_bf16 v[104:107], v[24:27], v[160:163], v[104:107]
    ds_read_b128 v[56:59], v2 offset:40960
    ds_read_b128 v[60:63], v2 offset:41984
    v_mfma_f32_16x16x32_bf16 v[104:107], v[28:31], v[168:171], v[104:107]
    v_mul_f32 v218, v218, v234
    v_fma_f32 v219, v219, s30, s30
    v_mfma_f32_16x16x32_bf16 v[108:111], v[24:27], v[164:167], v[108:111]
    v_rcp_f32 v219, v219
    v_mfma_f32_16x16x32_bf16 v[108:111], v[28:31], v[172:175], v[108:111]
    buffer_load_dwordx4 v5, s[8:11], s31 offen offset:0 lds
    v_mfma_f32_16x16x32_bf16 v[112:115], v[32:35], v[160:163], v[112:115]
    ds_read_b128 v[64:67], v2 offset:43008
    ds_read_b128 v[68:71], v2 offset:44032
    v_mfma_f32_16x16x32_bf16 v[112:115], v[36:39], v[168:171], v[112:115]
    v_mul_f32 v219, v219, v235
    v_cvt_pk_bf16_f32 v208, v216, v217
    v_mfma_f32_16x16x32_bf16 v[116:119], v[32:35], v[164:167], v[116:119]
    buffer_load_dwordx4 a[4:7], v10, s[8:11], s48 offen offset:1024 sc1
    v_mfma_f32_16x16x32_bf16 v[116:119], v[36:39], v[172:175], v[116:119]
    v_cvt_pk_bf16_f32 v209, v218, v219
    s_waitcnt lgkmcnt(4)
    v_mfma_f32_16x16x32_bf16 v[136:139], v[40:43], v[176:179], v[136:139]
    ds_read_b128 v[24:27], v2 offset:45056
    ds_read_b128 v[28:31], v2 offset:46080
    v_mfma_f32_16x16x32_bf16 v[136:139], v[44:47], v[184:187], v[136:139]
    v_fma_f32 v224, v224, s30, s30
    v_fma_f32 v225, v225, s30, s30
    v_mfma_f32_16x16x32_bf16 v[140:143], v[40:43], v[180:183], v[140:143]
    v_rcp_f32 v224, v224
    v_mfma_f32_16x16x32_bf16 v[140:143], v[44:47], v[188:191], v[140:143]
    buffer_load_dwordx4 v5, s[8:11], s31 offen offset:1024 lds
    v_mfma_f32_16x16x32_bf16 v[72:75], v[48:51], v[176:179], v[72:75]
    ds_read_b128 v[32:35], v2 offset:47104
    ds_read_b128 v[36:39], v2 offset:48128
    v_mfma_f32_16x16x32_bf16 v[72:75], v[52:55], v[184:187], v[72:75]
    v_rcp_f32 v225, v225
    v_mfma_f32_16x16x32_bf16 v[76:79], v[48:51], v[180:183], v[76:79]
    v_mul_f32 v224, v224, v240
    v_fma_f32 v226, v226, s30, s30
    v_mfma_f32_16x16x32_bf16 v[76:79], v[52:55], v[188:191], v[76:79]
    v_mul_f32 v225, v225, v241
    s_waitcnt lgkmcnt(4)
    v_mfma_f32_16x16x32_bf16 v[80:83], v[56:59], v[176:179], v[80:83]
    ds_read_b128 v[40:43], v2 offset:49152
    ds_read_b128 v[44:47], v2 offset:50176
    v_mfma_f32_16x16x32_bf16 v[80:83], v[60:63], v[184:187], v[80:83]
    v_rcp_f32 v226, v226
    v_mfma_f32_16x16x32_bf16 v[84:87], v[56:59], v[180:183], v[84:87]
    s_mov_b32 s48, 10240
    buffer_load_dwordx4 a[8:11], v10, s[8:11], s48 offen offset:0 sc1
    v_mfma_f32_16x16x32_bf16 v[84:87], v[60:63], v[188:191], v[84:87]
    buffer_load_dwordx4 v5, s[8:11], s31 offen offset:2048 lds
    v_mfma_f32_16x16x32_bf16 v[88:91], v[64:67], v[176:179], v[88:91]
    ds_read_b128 v[48:51], v2 offset:51200
    ds_read_b128 v[52:55], v2 offset:52224
    v_mfma_f32_16x16x32_bf16 v[88:91], v[68:71], v[184:187], v[88:91]
    v_mul_f32 v226, v226, v242
    v_fma_f32 v227, v227, s30, s30
    v_mfma_f32_16x16x32_bf16 v[92:95], v[64:67], v[180:183], v[92:95]
    v_rcp_f32 v227, v227
    v_mfma_f32_16x16x32_bf16 v[92:95], v[68:71], v[188:191], v[92:95]
    v_cvt_pk_bf16_f32 v210, v224, v225
    s_waitcnt lgkmcnt(4)
    v_mfma_f32_16x16x32_bf16 v[96:99], v[24:27], v[176:179], v[96:99]
    ds_read_b128 v[56:59], v2 offset:53248
    ds_read_b128 v[60:63], v2 offset:54272
    v_mfma_f32_16x16x32_bf16 v[96:99], v[28:31], v[184:187], v[96:99]
    v_mul_f32 v227, v227, v243
    v_fma_f32 v220, v220, s30, s30
    v_mfma_f32_16x16x32_bf16 v[100:103], v[24:27], v[180:183], v[100:103]
    v_rcp_f32 v220, v220
    v_mfma_f32_16x16x32_bf16 v[100:103], v[28:31], v[188:191], v[100:103]
    buffer_load_dwordx4 v5, s[8:11], s31 offen offset:3072 lds
    v_mfma_f32_16x16x32_bf16 v[104:107], v[32:35], v[176:179], v[104:107]
    ds_read_b128 v[64:67], v2 offset:55296
    ds_read_b128 v[68:71], v2 offset:56320
    v_mfma_f32_16x16x32_bf16 v[104:107], v[36:39], v[184:187], v[104:107]
    buffer_load_dwordx4 a[12:15], v10, s[8:11], s48 offen offset:1024 sc1
    v_mfma_f32_16x16x32_bf16 v[108:111], v[32:35], v[180:183], v[108:111]
    s_add_u32 m0, s28, 147456
    s_mov_b32 s31, 802816
    v_mfma_f32_16x16x32_bf16 v[108:111], v[36:39], v[188:191], v[108:111]
    v_cvt_pk_bf16_f32 v211, v226, v227
    s_waitcnt lgkmcnt(4)
    v_mfma_f32_16x16x32_bf16 v[112:115], v[40:43], v[176:179], v[112:115]
    ds_read_b128 v[24:27], v2 offset:57344
    ds_read_b128 v[28:31], v2 offset:58368
    v_mfma_f32_16x16x32_bf16 v[112:115], v[44:47], v[184:187], v[112:115]
    s_mov_b32 s29, 16384
    v_mul_f32 v220, v220, v236
    v_mfma_f32_16x16x32_bf16 v[116:119], v[40:43], v[180:183], v[116:119]
    buffer_store_dwordx4 v[208:211], v8, s[8:11], s29 offen offset:0 sc1
    v_mfma_f32_16x16x32_bf16 v[116:119], v[44:47], v[188:191], v[116:119]
    buffer_load_dwordx4 v5, s[8:11], s31 offen offset:0 lds
    v_mfma_f32_16x16x32_bf16 v[136:139], v[48:51], v[192:195], v[136:139]
    ds_read_b128 v[32:35], v2 offset:59392
    ds_read_b128 v[36:39], v2 offset:60416
    v_mfma_f32_16x16x32_bf16 v[136:139], v[52:55], v[200:203], v[136:139]
    v_fma_f32 v221, v221, s30, s30
    v_fma_f32 v222, v222, s30, s30
    v_mfma_f32_16x16x32_bf16 v[140:143], v[48:51], v[196:199], v[140:143]
    v_rcp_f32 v221, v221
    v_mfma_f32_16x16x32_bf16 v[140:143], v[52:55], v[204:207], v[140:143]
    v_fma_f32 v223, v223, s30, s30
    s_waitcnt lgkmcnt(4)
    v_mfma_f32_16x16x32_bf16 v[72:75], v[56:59], v[192:195], v[72:75]
    ds_read_b128 v[40:43], v2 offset:61440
    ds_read_b128 v[44:47], v2 offset:62464
    v_mfma_f32_16x16x32_bf16 v[72:75], v[60:63], v[200:203], v[72:75]
    v_rcp_f32 v222, v222
    v_mfma_f32_16x16x32_bf16 v[76:79], v[56:59], v[196:199], v[76:79]
    v_rcp_f32 v223, v223
    v_mfma_f32_16x16x32_bf16 v[76:79], v[60:63], v[204:207], v[76:79]
    buffer_load_dwordx4 v5, s[8:11], s31 offen offset:1024 lds
    v_mfma_f32_16x16x32_bf16 v[80:83], v[64:67], v[192:195], v[80:83]
    ds_read_b128 v[48:51], v2 offset:63488
    ds_read_b128 v[52:55], v2 offset:64512
    v_mfma_f32_16x16x32_bf16 v[80:83], v[68:71], v[200:203], v[80:83]
    s_mov_b32 s48, 12288
    buffer_load_dwordx4 a[16:19], v10, s[8:11], s48 offen offset:0 sc1
    v_mfma_f32_16x16x32_bf16 v[84:87], v[64:67], v[196:199], v[84:87]
    v_mul_f32 v221, v221, v237
    v_mul_f32 v222, v222, v238
    v_mfma_f32_16x16x32_bf16 v[84:87], v[68:71], v[204:207], v[84:87]
    v_mul_f32 v223, v223, v239
    s_waitcnt lgkmcnt(4)
    v_mfma_f32_16x16x32_bf16 v[88:91], v[24:27], v[192:195], v[88:91]
    ds_read_b128 v[56:59], v3 offset:0
    ds_read_b128 v[60:63], v3 offset:1024
    v_mfma_f32_16x16x32_bf16 v[88:91], v[28:31], v[200:203], v[88:91]
    v_cvt_pk_bf16_f32 v212, v220, v221
    v_cvt_pk_bf16_f32 v213, v222, v223
    v_mfma_f32_16x16x32_bf16 v[92:95], v[24:27], v[196:199], v[92:95]
    v_fma_f32 v228, v228, s30, s30
    v_fma_f32 v229, v229, s30, s30
    v_mfma_f32_16x16x32_bf16 v[92:95], v[28:31], v[204:207], v[92:95]
    buffer_load_dwordx4 v5, s[8:11], s31 offen offset:2048 lds
    v_mfma_f32_16x16x32_bf16 v[96:99], v[32:35], v[192:195], v[96:99]
    ds_read_b128 v[64:67], v3 offset:2048
    ds_read_b128 v[68:71], v3 offset:3072
    v_mfma_f32_16x16x32_bf16 v[96:99], v[36:39], v[200:203], v[96:99]
    v_rcp_f32 v228, v228
    v_mfma_f32_16x16x32_bf16 v[100:103], v[32:35], v[196:199], v[100:103]
    v_rcp_f32 v229, v229
    v_mfma_f32_16x16x32_bf16 v[100:103], v[36:39], v[204:207], v[100:103]
    v_mul_f32 v228, v228, v244
    s_waitcnt lgkmcnt(4)
    v_mfma_f32_16x16x32_bf16 v[104:107], v[40:43], v[192:195], v[104:107]
    ds_read_b128 v[24:27], v3 offset:4096
    ds_read_b128 v[28:31], v3 offset:5120
    v_mfma_f32_16x16x32_bf16 v[104:107], v[44:47], v[200:203], v[104:107]
    v_exp_f32 v230, v230
    v_mfma_f32_16x16x32_bf16 v[108:111], v[40:43], v[196:199], v[108:111]
    v_exp_f32 v231, v231
    v_mfma_f32_16x16x32_bf16 v[108:111], v[44:47], v[204:207], v[108:111]
    buffer_load_dwordx4 v5, s[8:11], s31 offen offset:3072 lds
    v_mfma_f32_16x16x32_bf16 v[112:115], v[48:51], v[192:195], v[112:115]
    ds_read_b128 v[32:35], v3 offset:6144
    ds_read_b128 v[36:39], v3 offset:7168
    v_mfma_f32_16x16x32_bf16 v[112:115], v[52:55], v[200:203], v[112:115]
    buffer_load_dwordx4 a[20:23], v10, s[8:11], s48 offen offset:1024 sc1
    v_mfma_f32_16x16x32_bf16 v[116:119], v[48:51], v[196:199], v[116:119]
    s_add_u32 m0, s28, 0
    s_mov_b32 s31, 819200
    v_mfma_f32_16x16x32_bf16 v[116:119], v[52:55], v[204:207], v[116:119]
    v_mul_f32 v229, v229, v245
    s_waitcnt lgkmcnt(4)
    v_mfma_f32_16x16x32_bf16 v[136:139], v[56:59], a[144:147], v[136:139]
    ds_read_b128 v[40:43], v3 offset:8192
    ds_read_b128 v[44:47], v3 offset:9216
    v_mfma_f32_16x16x32_bf16 v[136:139], v[60:63], a[152:155], v[136:139]
    v_fma_f32 v230, v230, s30, s30
    v_fma_f32 v231, v231, s30, s30
    v_mfma_f32_16x16x32_bf16 v[140:143], v[56:59], a[148:151], v[140:143]
    v_rcp_f32 v230, v230
    v_mfma_f32_16x16x32_bf16 v[140:143], v[60:63], a[156:159], v[140:143]
    buffer_load_dwordx4 v5, s[8:11], s31 offen offset:0 lds
    v_mfma_f32_16x16x32_bf16 v[72:75], v[64:67], a[144:147], v[72:75]
    ds_read_b128 v[48:51], v3 offset:10240
    ds_read_b128 v[52:55], v3 offset:11264
    v_mfma_f32_16x16x32_bf16 v[72:75], v[68:71], a[152:155], v[72:75]
    v_mul_f32 v230, v230, v246
    v_cvt_pk_bf16_f32 v214, v228, v229
    v_mfma_f32_16x16x32_bf16 v[76:79], v[64:67], a[148:151], v[76:79]
    v_rcp_f32 v231, v231
    v_mfma_f32_16x16x32_bf16 v[76:79], v[68:71], a[156:159], v[76:79]
    s_waitcnt lgkmcnt(4)
    v_mfma_f32_16x16x32_bf16 v[80:83], v[24:27], a[144:147], v[80:83]
    ds_read_b128 v[56:59], v3 offset:12288
    ds_read_b128 v[60:63], v3 offset:13312
    v_mfma_f32_16x16x32_bf16 v[80:83], v[28:31], a[152:155], v[80:83]
    s_mov_b32 s48, 8192
    buffer_load_dwordx4 a[24:27], v11, s[8:11], s48 offen offset:0 sc1
    v_mfma_f32_16x16x32_bf16 v[84:87], v[24:27], a[148:151], v[84:87]
    v_mul_f32 v231, v231, v247
    v_mfma_f32_16x16x32_bf16 v[84:87], v[28:31], a[156:159], v[84:87]
    buffer_load_dwordx4 v5, s[8:11], s31 offen offset:1024 lds
    v_mfma_f32_16x16x32_bf16 v[88:91], v[32:35], a[144:147], v[88:91]
    ds_read_b128 v[64:67], v3 offset:14336
    ds_read_b128 v[68:71], v3 offset:15360
    v_mfma_f32_16x16x32_bf16 v[88:91], v[36:39], a[152:155], v[88:91]
    v_cvt_pk_bf16_f32 v215, v230, v231
    v_mfma_f32_16x16x32_bf16 v[92:95], v[32:35], a[148:151], v[92:95]
    s_mov_b32 s29, 16384
    v_mfma_f32_16x16x32_bf16 v[92:95], v[36:39], a[156:159], v[92:95]
    s_waitcnt lgkmcnt(4)
    v_mfma_f32_16x16x32_bf16 v[96:99], v[40:43], a[144:147], v[96:99]
    s_waitcnt vmcnt(18)
    s_barrier
    ds_read_b128 v[24:27], v3 offset:16384
    ds_read_b128 v[28:31], v3 offset:17408
    v_mfma_f32_16x16x32_bf16 v[96:99], v[44:47], a[152:155], v[96:99]
    buffer_store_dwordx4 v[212:215], v8, s[8:11], s29 offen offset:1024 sc1
    v_mfma_f32_16x16x32_bf16 v[100:103], v[40:43], a[148:151], v[100:103]
    buffer_load_dwordx4 a[28:31], v11, s[8:11], s48 offen offset:1024 sc1
    v_mfma_f32_16x16x32_bf16 v[100:103], v[44:47], a[156:159], v[100:103]
    buffer_load_dwordx4 v5, s[8:11], s31 offen offset:2048 lds
    v_mfma_f32_16x16x32_bf16 v[104:107], v[48:51], a[144:147], v[104:107]
    ds_read_b128 v[32:35], v3 offset:18432
    ds_read_b128 v[36:39], v3 offset:19456
    v_mfma_f32_16x16x32_bf16 v[104:107], v[52:55], a[152:155], v[104:107]
    v_mfma_f32_16x16x32_bf16 v[108:111], v[48:51], a[148:151], v[108:111]
    v_mfma_f32_16x16x32_bf16 v[108:111], v[52:55], a[156:159], v[108:111]
    s_waitcnt lgkmcnt(4)
    v_mfma_f32_16x16x32_bf16 v[112:115], v[56:59], a[144:147], v[112:115]
    ds_read_b128 v[40:43], v3 offset:20480
    ds_read_b128 v[44:47], v3 offset:21504
    v_mfma_f32_16x16x32_bf16 v[112:115], v[60:63], a[152:155], v[112:115]
    v_mfma_f32_16x16x32_bf16 v[116:119], v[56:59], a[148:151], v[116:119]
    v_mfma_f32_16x16x32_bf16 v[116:119], v[60:63], a[156:159], v[116:119]
    buffer_load_dwordx4 v5, s[8:11], s31 offen offset:3072 lds
    v_mfma_f32_16x16x32_bf16 v[136:139], v[64:67], a[160:163], v[136:139]
    ds_read_b128 v[48:51], v3 offset:22528
    ds_read_b128 v[52:55], v3 offset:23552
    v_mfma_f32_16x16x32_bf16 v[136:139], v[68:71], a[168:171], v[136:139]
    s_mov_b32 s48, 10240
    buffer_load_dwordx4 a[32:35], v11, s[8:11], s48 offen offset:0 sc1
    v_mfma_f32_16x16x32_bf16 v[140:143], v[64:67], a[164:167], v[140:143]
    s_add_u32 m0, s28, 16384
    s_mov_b32 s31, 835584
    v_mfma_f32_16x16x32_bf16 v[140:143], v[68:71], a[172:175], v[140:143]
    s_waitcnt lgkmcnt(4)
    v_mfma_f32_16x16x32_bf16 v[72:75], v[24:27], a[160:163], v[72:75]
    ds_read_b128 v[56:59], v3 offset:24576
    ds_read_b128 v[60:63], v3 offset:25600
    v_mfma_f32_16x16x32_bf16 v[72:75], v[28:31], a[168:171], v[72:75]
    v_mfma_f32_16x16x32_bf16 v[76:79], v[24:27], a[164:167], v[76:79]
    v_mfma_f32_16x16x32_bf16 v[76:79], v[28:31], a[172:175], v[76:79]
    buffer_load_dwordx4 v5, s[8:11], s31 offen offset:0 lds
    v_mfma_f32_16x16x32_bf16 v[80:83], v[32:35], a[160:163], v[80:83]
    ds_read_b128 v[64:67], v3 offset:26624
    ds_read_b128 v[68:71], v3 offset:27648
    v_mfma_f32_16x16x32_bf16 v[80:83], v[36:39], a[168:171], v[80:83]
    v_mfma_f32_16x16x32_bf16 v[84:87], v[32:35], a[164:167], v[84:87]
    buffer_load_dwordx4 a[36:39], v11, s[8:11], s48 offen offset:1024 sc1
    v_mfma_f32_16x16x32_bf16 v[84:87], v[36:39], a[172:175], v[84:87]
    s_waitcnt lgkmcnt(4)
    v_mfma_f32_16x16x32_bf16 v[88:91], v[40:43], a[160:163], v[88:91]
    ds_read_b128 v[24:27], v3 offset:28672
    ds_read_b128 v[28:31], v3 offset:29696
    v_mfma_f32_16x16x32_bf16 v[88:91], v[44:47], a[168:171], v[88:91]
    v_mfma_f32_16x16x32_bf16 v[92:95], v[40:43], a[164:167], v[92:95]
    v_mfma_f32_16x16x32_bf16 v[92:95], v[44:47], a[172:175], v[92:95]
    buffer_load_dwordx4 v5, s[8:11], s31 offen offset:1024 lds
    v_mfma_f32_16x16x32_bf16 v[96:99], v[48:51], a[160:163], v[96:99]
    ds_read_b128 v[32:35], v3 offset:30720
    ds_read_b128 v[36:39], v3 offset:31744
    v_mfma_f32_16x16x32_bf16 v[96:99], v[52:55], a[168:171], v[96:99]
    v_mfma_f32_16x16x32_bf16 v[100:103], v[48:51], a[164:167], v[100:103]
    v_mfma_f32_16x16x32_bf16 v[100:103], v[52:55], a[172:175], v[100:103]
    s_waitcnt lgkmcnt(4)
    v_mfma_f32_16x16x32_bf16 v[104:107], v[56:59], a[160:163], v[104:107]
    ds_read_b128 v[40:43], v3 offset:32768
    ds_read_b128 v[44:47], v3 offset:33792
    v_mfma_f32_16x16x32_bf16 v[104:107], v[60:63], a[168:171], v[104:107]
    buffer_load_dwordx4 v[16:19], off, s[8:11], s32 sc1
    v_mfma_f32_16x16x32_bf16 v[108:111], v[56:59], a[164:167], v[108:111]
    s_mov_b32 s48, 12288
    buffer_load_dwordx4 a[40:43], v11, s[8:11], s48 offen offset:0 sc1
    v_mfma_f32_16x16x32_bf16 v[108:111], v[60:63], a[172:175], v[108:111]
    buffer_load_dwordx4 v5, s[8:11], s31 offen offset:2048 lds
    v_mfma_f32_16x16x32_bf16 v[112:115], v[64:67], a[160:163], v[112:115]
    ds_read_b128 v[48:51], v3 offset:34816
    ds_read_b128 v[52:55], v3 offset:35840
    v_mfma_f32_16x16x32_bf16 v[112:115], v[68:71], a[168:171], v[112:115]
    v_bfe_u32 v234, v0, 4, 1
    v_mfma_f32_16x16x32_bf16 v[116:119], v[64:67], a[164:167], v[116:119]
    v_bfe_u32 v235, v0, 5, 1
    v_mfma_f32_16x16x32_bf16 v[116:119], v[68:71], a[172:175], v[116:119]
    s_mul_i32 s52, s5, 18
    s_waitcnt lgkmcnt(4)
    v_mfma_f32_16x16x32_bf16 v[136:139], v[24:27], a[176:179], v[136:139]
    ds_read_b128 v[56:59], v3 offset:36864
    ds_read_b128 v[60:63], v3 offset:37888
    v_mfma_f32_16x16x32_bf16 v[136:139], v[28:31], a[184:187], v[136:139]
    s_lshl_b32 s53, s4, 2
    v_mfma_f32_16x16x32_bf16 v[140:143], v[24:27], a[180:183], v[140:143]
    s_add_u32 s53, s53, s52
    v_mfma_f32_16x16x32_bf16 v[140:143], v[28:31], a[188:191], v[140:143]
    buffer_load_dwordx4 v5, s[8:11], s31 offen offset:3072 lds
    v_mfma_f32_16x16x32_bf16 v[72:75], v[32:35], a[176:179], v[72:75]
    ds_read_b128 v[64:67], v3 offset:38912
    ds_read_b128 v[68:71], v3 offset:39936
    v_mfma_f32_16x16x32_bf16 v[72:75], v[36:39], a[184:187], v[72:75]
    buffer_load_dwordx4 a[44:47], v11, s[8:11], s48 offen offset:1024 sc1
    v_mfma_f32_16x16x32_bf16 v[76:79], v[32:35], a[180:183], v[76:79]
    s_add_u32 m0, s28, 32768
    s_mov_b32 s31, 851968
    v_mfma_f32_16x16x32_bf16 v[76:79], v[36:39], a[188:191], v[76:79]
    s_add_u32 s52, s52, 16
    s_waitcnt lgkmcnt(4)
    v_mfma_f32_16x16x32_bf16 v[80:83], v[40:43], a[176:179], v[80:83]
    ds_read_b128 v[24:27], v3 offset:40960
    ds_read_b128 v[28:31], v3 offset:41984
    v_mfma_f32_16x16x32_bf16 v[80:83], v[44:47], a[184:187], v[80:83]
    s_lshl_b32 s54, s43, 1
    v_mfma_f32_16x16x32_bf16 v[84:87], v[40:43], a[180:183], v[84:87]
    s_and_b32 s55, s54, 31
    v_mfma_f32_16x16x32_bf16 v[84:87], v[44:47], a[188:191], v[84:87]
    buffer_load_dwordx4 v5, s[8:11], s31 offen offset:0 lds
    v_mfma_f32_16x16x32_bf16 v[88:91], v[48:51], a[176:179], v[88:91]
    ds_read_b128 v[32:35], v3 offset:43008
    ds_read_b128 v[36:39], v3 offset:44032
    v_mfma_f32_16x16x32_bf16 v[88:91], v[52:55], a[184:187], v[88:91]
    s_lshr_b32 s54, s54, 5
    v_mfma_f32_16x16x32_bf16 v[92:95], v[48:51], a[180:183], v[92:95]
    s_mov_b32 s48, 8192
    buffer_load_dwordx4 a[48:51], v12, s[8:11], s48 offen offset:0 sc1
    v_mfma_f32_16x16x32_bf16 v[92:95], v[52:55], a[188:191], v[92:95]
    s_lshl_b32 s54, s54, 9
    s_waitcnt lgkmcnt(4)
    v_mfma_f32_16x16x32_bf16 v[96:99], v[56:59], a[176:179], v[96:99]
    ds_read_b128 v[40:43], v3 offset:45056
    ds_read_b128 v[44:47], v3 offset:46080
    v_mfma_f32_16x16x32_bf16 v[96:99], v[60:63], a[184:187], v[96:99]
    s_add_u32 s54, s54, s55
    v_mfma_f32_16x16x32_bf16 v[100:103], v[56:59], a[180:183], v[100:103]
    v_and_b32 v22, 15, v0
    v_mfma_f32_16x16x32_bf16 v[100:103], v[60:63], a[188:191], v[100:103]
    buffer_load_dwordx4 v5, s[8:11], s31 offen offset:1024 lds
    v_mfma_f32_16x16x32_bf16 v[104:107], v[64:67], a[176:179], v[104:107]
    ds_read_b128 v[48:51], v3 offset:47104
    ds_read_b128 v[52:55], v3 offset:48128
    v_mfma_f32_16x16x32_bf16 v[104:107], v[68:71], a[184:187], v[104:107]
    v_lshlrev_b32 v229, 5, v22
    v_mfma_f32_16x16x32_bf16 v[108:111], v[64:67], a[180:183], v[108:111]
    v_add_u32 v229, s54, v229
    v_mfma_f32_16x16x32_bf16 v[108:111], v[68:71], a[188:191], v[108:111]
    v_mul_u32_u24 v229, 1152, v229
    s_waitcnt lgkmcnt(4)
    v_mfma_f32_16x16x32_bf16 v[112:115], v[24:27], a[176:179], v[112:115]
    ds_read_b128 v[56:59], v3 offset:49152
    ds_read_b128 v[60:63], v3 offset:50176
    v_mfma_f32_16x16x32_bf16 v[112:115], v[28:31], a[184:187], v[112:115]
    buffer_load_dwordx4 a[52:55], v12, s[8:11], s48 offen offset:1024 sc1
    v_mfma_f32_16x16x32_bf16 v[116:119], v[24:27], a[180:183], v[116:119]
    v_lshl_add_u32 v233, v234, 1, v235
    v_mfma_f32_16x16x32_bf16 v[116:119], v[28:31], a[188:191], v[116:119]
    buffer_load_dwordx4 v5, s[8:11], s31 offen offset:2048 lds
    v_mfma_f32_16x16x32_bf16 v[136:139], v[32:35], a[192:195], v[136:139]
    ds_read_b128 v[64:67], v3 offset:51200
    ds_read_b128 v[68:71], v3 offset:52224
    v_mfma_f32_16x16x32_bf16 v[136:139], v[36:39], a[200:203], v[136:139]
    v_add_u32 v233, s53, v233
    v_mfma_f32_16x16x32_bf16 v[140:143], v[32:35], a[196:199], v[140:143]
    v_lshl_add_u32 v231, v233, 4, v229
    v_mfma_f32_16x16x32_bf16 v[140:143], v[36:39], a[204:207], v[140:143]
    v_add_u32 v233, s52, v235
    s_waitcnt lgkmcnt(4)
    v_mfma_f32_16x16x32_bf16 v[72:75], v[40:43], a[192:195], v[72:75]
    ds_read_b128 v[24:27], v3 offset:53248
    ds_read_b128 v[28:31], v3 offset:54272
    v_mfma_f32_16x16x32_bf16 v[72:75], v[44:47], a[200:203], v[72:75]
    v_lshl_add_u32 v232, v233, 4, v229
    v_mfma_f32_16x16x32_bf16 v[76:79], v[40:43], a[196:199], v[76:79]
    s_waitcnt vmcnt(17)
    buffer_store_dword v13, v15, s[8:11], s47 offen sc1
    v_mfma_f32_16x16x32_bf16 v[76:79], v[44:47], a[204:207], v[76:79]
    buffer_load_dwordx4 v5, s[8:11], s31 offen offset:3072 lds
    v_mfma_f32_16x16x32_bf16 v[80:83], v[48:51], a[192:195], v[80:83]
    ds_read_b128 v[32:35], v3 offset:55296
    ds_read_b128 v[36:39], v3 offset:56320
    v_mfma_f32_16x16x32_bf16 v[80:83], v[52:55], a[200:203], v[80:83]
    s_mov_b32 s48, 10240
    buffer_load_dwordx4 a[56:59], v12, s[8:11], s48 offen offset:0 sc1
    v_mfma_f32_16x16x32_bf16 v[84:87], v[48:51], a[196:199], v[84:87]
    s_add_u32 m0, s28, 49152
    s_mov_b32 s31, 868352
    v_mfma_f32_16x16x32_bf16 v[84:87], v[52:55], a[204:207], v[84:87]
    v_mul_u32_u24 v23, 1152, v234
    s_waitcnt lgkmcnt(4)
    v_mfma_f32_16x16x32_bf16 v[88:91], v[56:59], a[192:195], v[88:91]
    ds_read_b128 v[40:43], v3 offset:57344
    ds_read_b128 v[44:47], v3 offset:58368
    v_mfma_f32_16x16x32_bf16 v[88:91], v[60:63], a[200:203], v[88:91]
    s_waitcnt vmcnt(12)
k4_kernel_f4a:
    v_and_b32 v20, v16, v17
    v_and_b32 v21, v18, v19
    v_and_b32 v20, v20, v21
    v_cmp_eq_u32 vcc, 3, v20
    s_cbranch_vccnz k4_kernel_f4b
    s_sub_u32 s34, s34, 1
    s_cmp_lt_i32 s34, 0
    s_cbranch_scc1 k4_kernel_f4b
    buffer_load_dwordx4 v[16:19], off, s[8:11], s32 sc1
    s_waitcnt vmcnt(0)
    s_branch k4_kernel_f4a
k4_kernel_f4b:
    v_mfma_f32_16x16x32_bf16 v[92:95], v[56:59], a[196:199], v[92:95]
    v_add_u32 v232, v232, v23
    v_mfma_f32_16x16x32_bf16 v[92:95], v[60:63], a[204:207], v[92:95]
    buffer_load_dwordx4 v5, s[8:11], s31 offen offset:0 lds
    v_mfma_f32_16x16x32_bf16 v[96:99], v[64:67], a[192:195], v[96:99]
    ds_read_b128 v[48:51], v3 offset:59392
    ds_read_b128 v[52:55], v3 offset:60416
    v_mfma_f32_16x16x32_bf16 v[96:99], v[68:71], a[200:203], v[96:99]
    v_lshlrev_b32 v22, 4, v22
    v_mfma_f32_16x16x32_bf16 v[100:103], v[64:67], a[196:199], v[100:103]
    buffer_load_dwordx4 a[60:63], v12, s[8:11], s48 offen offset:1024 sc1
    v_mfma_f32_16x16x32_bf16 v[100:103], v[68:71], a[204:207], v[100:103]
    v_lshl_add_u32 v22, v234, 3, v22
    s_waitcnt lgkmcnt(4)
    v_mfma_f32_16x16x32_bf16 v[104:107], v[24:27], a[192:195], v[104:107]
    ds_read_b128 v[56:59], v3 offset:61440
    ds_read_b128 v[60:63], v3 offset:62464
    v_mfma_f32_16x16x32_bf16 v[104:107], v[28:31], a[200:203], v[104:107]
    v_add_u32 v233, s52, v235
    v_mfma_f32_16x16x32_bf16 v[108:111], v[24:27], a[196:199], v[108:111]
    v_lshrrev_b32 v230, 2, v233
    v_mfma_f32_16x16x32_bf16 v[108:111], v[28:31], a[204:207], v[108:111]
    buffer_load_dwordx4 v5, s[8:11], s31 offen offset:1024 lds
    v_mfma_f32_16x16x32_bf16 v[112:115], v[32:35], a[192:195], v[112:115]
    ds_read_b128 v[64:67], v3 offset:63488
    ds_read_b128 v[68:71], v3 offset:64512
    v_mfma_f32_16x16x32_bf16 v[112:115], v[36:39], a[200:203], v[112:115]
    v_lshl_add_u32 v230, v230, 11, v22
    v_mfma_f32_16x16x32_bf16 v[116:119], v[32:35], a[196:199], v[116:119]
    v_and_b32 v233, 3, v233
    v_mfma_f32_16x16x32_bf16 v[116:119], v[36:39], a[204:207], v[116:119]
    v_lshl_add_u32 v230, v233, 8, v230
    s_waitcnt lgkmcnt(4)
    v_mfma_f32_16x16x32_bf16 v[136:139], v[40:43], a[208:211], v[136:139]
    s_barrier
    ds_read_b128 v[24:27], v4 offset:0
    ds_read_b128 v[28:31], v4 offset:1024
    v_mfma_f32_16x16x32_bf16 v[136:139], v[44:47], a[216:219], v[136:139]
    s_mov_b32 s48, 12288
    buffer_load_dwordx4 a[64:67], v12, s[8:11], s48 offen offset:0 sc1
    v_mfma_f32_16x16x32_bf16 v[140:143], v[40:43], a[212:215], v[140:143]
    v_add_u32 v233, s53, v235
    v_mfma_f32_16x16x32_bf16 v[140:143], v[44:47], a[220:223], v[140:143]
    buffer_load_dwordx4 v5, s[8:11], s31 offen offset:2048 lds
    v_mfma_f32_16x16x32_bf16 v[72:75], v[48:51], a[208:211], v[72:75]
    ds_read_b128 v[32:35], v4 offset:2048
    ds_read_b128 v[36:39], v4 offset:3072
    v_mfma_f32_16x16x32_bf16 v[72:75], v[52:55], a[216:219], v[72:75]
    v_lshrrev_b32 v228, 2, v233
    v_mfma_f32_16x16x32_bf16 v[76:79], v[48:51], a[212:215], v[76:79]
    v_lshl_add_u32 v228, v228, 11, v22
    v_mfma_f32_16x16x32_bf16 v[76:79], v[52:55], a[220:223], v[76:79]
    v_and_b32 v233, 3, v233
    s_waitcnt lgkmcnt(4)
    v_mfma_f32_16x16x32_bf16 v[80:83], v[56:59], a[208:211], v[80:83]
    ds_read_b128 v[40:43], v4 offset:4096
    ds_read_b128 v[44:47], v4 offset:5120
    v_mfma_f32_16x16x32_bf16 v[80:83], v[60:63], a[216:219], v[80:83]
    v_lshl_add_u32 v228, v233, 8, v228
    v_mfma_f32_16x16x32_bf16 v[84:87], v[56:59], a[212:215], v[84:87]
    buffer_load_dwordx4 a[68:71], v12, s[8:11], s48 offen offset:1024 sc1
    v_mfma_f32_16x16x32_bf16 v[84:87], v[60:63], a[220:223], v[84:87]
    buffer_load_dwordx4 v5, s[8:11], s31 offen offset:3072 lds
    v_mfma_f32_16x16x32_bf16 v[88:91], v[64:67], a[208:211], v[88:91]
    ds_read_b128 v[48:51], v4 offset:6144
    ds_read_b128 v[52:55], v4 offset:7168
    v_mfma_f32_16x16x32_bf16 v[88:91], v[68:71], a[216:219], v[88:91]
    v_add_u32 v233, s53, v235
    v_mfma_f32_16x16x32_bf16 v[92:95], v[64:67], a[212:215], v[92:95]
    s_add_u32 m0, s28, 65536
    s_mov_b32 s31, 884736
    v_mfma_f32_16x16x32_bf16 v[92:95], v[68:71], a[220:223], v[92:95]
    v_add_u32 v233, 2, v233
    s_waitcnt lgkmcnt(4)
    v_mfma_f32_16x16x32_bf16 v[96:99], v[24:27], a[208:211], v[96:99]
    ds_read_b128 v[56:59], v4 offset:8192
    ds_read_b128 v[60:63], v4 offset:9216
    v_mfma_f32_16x16x32_bf16 v[96:99], v[28:31], a[216:219], v[96:99]
    v_lshrrev_b32 v229, 2, v233
    v_mfma_f32_16x16x32_bf16 v[100:103], v[24:27], a[212:215], v[100:103]
    v_lshl_add_u32 v229, v229, 11, v22
    v_mfma_f32_16x16x32_bf16 v[100:103], v[28:31], a[220:223], v[100:103]
    buffer_load_dwordx4 v5, s[8:11], s31 offen offset:0 lds
    v_mfma_f32_16x16x32_bf16 v[104:107], v[32:35], a[208:211], v[104:107]
    ds_read_b128 v[64:67], v4 offset:10240
    ds_read_b128 v[68:71], v4 offset:11264
    v_mfma_f32_16x16x32_bf16 v[104:107], v[36:39], a[216:219], v[104:107]
    v_and_b32 v233, 3, v233
    v_mfma_f32_16x16x32_bf16 v[108:111], v[32:35], a[212:215], v[108:111]
    v_lshl_add_u32 v229, v233, 8, v229
    v_mfma_f32_16x16x32_bf16 v[108:111], v[36:39], a[220:223], v[108:111]
    s_add_u32 s52, s45, 12582912
    s_waitcnt lgkmcnt(4)
    v_mfma_f32_16x16x32_bf16 v[112:115], v[40:43], a[208:211], v[112:115]
    ds_read_b128 v[24:27], v4 offset:12288
    ds_read_b128 v[28:31], v4 offset:13312
    v_mfma_f32_16x16x32_bf16 v[112:115], v[44:47], a[216:219], v[112:115]
    s_mov_b32 s20, 0xffff0000
    v_mfma_f32_16x16x32_bf16 v[116:119], v[40:43], a[212:215], v[116:119]
    buffer_load_dwordx2 v[236:237], v228, s[8:11], s52 offen offset:0 sc1
    v_mfma_f32_16x16x32_bf16 v[116:119], v[44:47], a[220:223], v[116:119]
    buffer_load_dwordx4 v5, s[8:11], s31 offen offset:1024 lds
    v_mfma_f32_16x16x32_bf16 v[136:139], v[48:51], a[224:227], v[136:139]
    ds_read_b128 v[32:35], v4 offset:14336
    ds_read_b128 v[36:39], v4 offset:15360
    v_mfma_f32_16x16x32_bf16 v[136:139], v[52:55], a[232:235], v[136:139]
    buffer_load_dwordx2 v[238:239], v229, s[8:11], s52 offen offset:0 sc1
    v_mfma_f32_16x16x32_bf16 v[140:143], v[48:51], a[228:231], v[140:143]
    buffer_load_dwordx2 v[240:241], v228, s[8:11], s52 offen offset:1024 sc1
    v_mfma_f32_16x16x32_bf16 v[140:143], v[52:55], a[236:239], v[140:143]
    s_sub_u32 s53, s4, 1
    s_waitcnt lgkmcnt(4)
    v_mfma_f32_16x16x32_bf16 v[72:75], v[56:59], a[224:227], v[72:75]
    ds_read_b128 v[40:43], v4 offset:16384
    ds_read_b128 v[44:47], v4 offset:17408
    v_mfma_f32_16x16x32_bf16 v[72:75], v[60:63], a[232:235], v[72:75]
    buffer_load_dwordx2 v[242:243], v229, s[8:11], s52 offen offset:1024 sc1
    v_mfma_f32_16x16x32_bf16 v[76:79], v[56:59], a[228:231], v[76:79]
    buffer_load_dwordx2 v[244:245], v230, s[8:11], s52 offen offset:0 sc1
    v_mfma_f32_16x16x32_bf16 v[76:79], v[60:63], a[236:239], v[76:79]
    buffer_load_dwordx4 v5, s[8:11], s31 offen offset:2048 lds
    v_mfma_f32_16x16x32_bf16 v[80:83], v[64:67], a[224:227], v[80:83]
    ds_read_b128 v[48:51], v4 offset:18432
    ds_read_b128 v[52:55], v4 offset:19456
    v_mfma_f32_16x16x32_bf16 v[80:83], v[68:71], a[232:235], v[80:83]
    buffer_load_dwordx2 v[246:247], v230, s[8:11], s52 offen offset:1024 sc1
    v_mfma_f32_16x16x32_bf16 v[84:87], v[64:67], a[228:231], v[84:87]
    s_and_b32 s53, s53, 3
    v_mfma_f32_16x16x32_bf16 v[84:87], v[68:71], a[236:239], v[84:87]
    s_mul_i32 s53, s53, 2359296
    s_waitcnt lgkmcnt(4)
    v_mfma_f32_16x16x32_bf16 v[88:91], v[24:27], a[224:227], v[88:91]
    ds_read_b128 v[56:59], v4 offset:20480
    ds_read_b128 v[60:63], v4 offset:21504
    v_mfma_f32_16x16x32_bf16 v[88:91], v[28:31], a[232:235], v[88:91]
    s_add_u32 s55, s53, s50
    v_mfma_f32_16x16x32_bf16 v[92:95], v[24:27], a[228:231], v[92:95]
    s_add_u32 s55, s55, 1024
    v_mfma_f32_16x16x32_bf16 v[92:95], v[28:31], a[236:239], v[92:95]
    buffer_load_dwordx4 v5, s[8:11], s31 offen offset:3072 lds
    v_mfma_f32_16x16x32_bf16 v[96:99], v[32:35], a[224:227], v[96:99]
    ds_read_b128 v[64:67], v4 offset:22528
    ds_read_b128 v[68:71], v4 offset:23552
    v_mfma_f32_16x16x32_bf16 v[96:99], v[36:39], a[232:235], v[96:99]
    s_sub_u32 s53, s4, 2
    v_mfma_f32_16x16x32_bf16 v[100:103], v[32:35], a[228:231], v[100:103]
    s_add_u32 m0, s28, 81920
    s_mov_b32 s31, 901120
    v_mfma_f32_16x16x32_bf16 v[100:103], v[36:39], a[236:239], v[100:103]
    s_and_b32 s53, s53, 3
    s_waitcnt lgkmcnt(4)
    v_mfma_f32_16x16x32_bf16 v[104:107], v[40:43], a[224:227], v[104:107]
    ds_read_b128 v[24:27], v4 offset:24576
    ds_read_b128 v[28:31], v4 offset:25600
    v_mfma_f32_16x16x32_bf16 v[104:107], v[44:47], a[232:235], v[104:107]
    buffer_load_dwordx4 v[16:19], v15, s[8:11], 0 offen sc1
    v_mfma_f32_16x16x32_bf16 v[108:111], v[40:43], a[228:231], v[108:111]
    s_mul_i32 s53, s53, 2359296
    v_mfma_f32_16x16x32_bf16 v[108:111], v[44:47], a[236:239], v[108:111]
    buffer_load_dwordx4 v5, s[8:11], s31 offen offset:0 lds
    v_mfma_f32_16x16x32_bf16 v[112:115], v[48:51], a[224:227], v[112:115]
    ds_read_b128 v[32:35], v4 offset:26624
    ds_read_b128 v[36:39], v4 offset:27648
    v_mfma_f32_16x16x32_bf16 v[112:115], v[52:55], a[232:235], v[112:115]
    s_add_u32 s56, s53, s50
    v_mfma_f32_16x16x32_bf16 v[116:119], v[48:51], a[228:231], v[116:119]
    s_add_u32 s56, s56, 3072
    v_mfma_f32_16x16x32_bf16 v[116:119], v[52:55], a[236:239], v[116:119]
    s_sub_u32 s53, s4, 3
    s_waitcnt lgkmcnt(4)
    v_mfma_f32_16x16x32_bf16 v[136:139], v[56:59], v[208:211], v[136:139]
    ds_read_b128 v[40:43], v4 offset:28672
    ds_read_b128 v[44:47], v4 offset:29696
    v_mfma_f32_16x16x32_bf16 v[136:139], v[60:63], a[0:3], v[136:139]
    s_and_b32 s53, s53, 3
    v_mfma_f32_16x16x32_bf16 v[140:143], v[56:59], v[212:215], v[140:143]
    s_mul_i32 s53, s53, 2359296
    v_mfma_f32_16x16x32_bf16 v[140:143], v[60:63], a[4:7], v[140:143]
    buffer_load_dwordx4 v5, s[8:11], s31 offen offset:1024 lds
    v_mfma_f32_16x16x32_bf16 v[72:75], v[64:67], v[208:211], v[72:75]
    ds_read_b128 v[48:51], v4 offset:30720
    ds_read_b128 v[52:55], v4 offset:31744
    v_mfma_f32_16x16x32_bf16 v[72:75], v[68:71], a[0:3], v[72:75]
    s_add_u32 s57, s53, s50
    v_mfma_f32_16x16x32_bf16 v[76:79], v[64:67], v[212:215], v[76:79]
    s_add_u32 s57, s57, 5120
    v_mfma_f32_16x16x32_bf16 v[76:79], v[68:71], a[4:7], v[76:79]
    s_cmp_eq_u32 s3, s4
    s_cselect_b32 s49, s50, 0x7ff00000
    s_waitcnt lgkmcnt(4)
    v_mfma_f32_16x16x32_bf16 v[80:83], v[24:27], v[208:211], v[80:83]
    ds_read_b128 v[56:59], v2 offset:0
    ds_read_b128 v[60:63], v2 offset:1024
    v_mfma_f32_16x16x32_bf16 v[80:83], v[28:31], a[0:3], v[80:83]
    s_cmp_eq_u32 s4, 0
    s_cselect_b32 s24, 1, 0
    v_mfma_f32_16x16x32_bf16 v[84:87], v[24:27], v[212:215], v[84:87]
    s_cmp_eq_u32 s4, 1
    s_cselect_b32 s25, 1, 0
    v_mfma_f32_16x16x32_bf16 v[84:87], v[28:31], a[4:7], v[84:87]
    buffer_load_dwordx4 v5, s[8:11], s31 offen offset:2048 lds
    v_mfma_f32_16x16x32_bf16 v[88:91], v[32:35], v[208:211], v[88:91]
    ds_read_b128 v[64:67], v2 offset:2048
    ds_read_b128 v[68:71], v2 offset:3072
    v_mfma_f32_16x16x32_bf16 v[88:91], v[36:39], a[0:3], v[88:91]
    s_cmp_eq_u32 s4, 2
    s_cselect_b32 s26, 1, 0
    v_mfma_f32_16x16x32_bf16 v[92:95], v[32:35], v[212:215], v[92:95]
    s_cmp_eq_u32 s4, 3
    s_cselect_b32 s27, 1, 0
    v_mfma_f32_16x16x32_bf16 v[92:95], v[36:39], a[4:7], v[92:95]
    s_waitcnt lgkmcnt(4)
    v_mfma_f32_16x16x32_bf16 v[96:99], v[40:43], v[208:211], v[96:99]
    ds_read_b128 v[24:27], v2 offset:4096
    ds_read_b128 v[28:31], v2 offset:5120
    v_mfma_f32_16x16x32_bf16 v[96:99], v[44:47], a[0:3], v[96:99]
    v_mfma_f32_16x16x32_bf16 v[100:103], v[40:43], v[212:215], v[100:103]
    v_mfma_f32_16x16x32_bf16 v[100:103], v[44:47], a[4:7], v[100:103]
    buffer_load_dwordx4 v5, s[8:11], s31 offen offset:3072 lds
    v_mfma_f32_16x16x32_bf16 v[104:107], v[48:51], v[208:211], v[104:107]
    ds_read_b128 v[32:35], v2 offset:6144
    ds_read_b128 v[36:39], v2 offset:7168
    v_mfma_f32_16x16x32_bf16 v[104:107], v[52:55], a[0:3], v[104:107]
    v_mfma_f32_16x16x32_bf16 v[108:111], v[48:51], v[212:215], v[108:111]
    s_add_u32 m0, s28, 98304
    s_mov_b32 s31, 917504
    v_mfma_f32_16x16x32_bf16 v[108:111], v[52:55], a[4:7], v[108:111]
    s_waitcnt lgkmcnt(4)
    v_mfma_f32_16x16x32_bf16 v[112:115], v[56:59], v[208:211], v[112:115]
    ds_read_b128 v[40:43], v2 offset:8192
    ds_read_b128 v[44:47], v2 offset:9216
    v_mfma_f32_16x16x32_bf16 v[112:115], v[60:63], a[0:3], v[112:115]
    v_mfma_f32_16x16x32_bf16 v[116:119], v[56:59], v[212:215], v[116:119]
    v_mfma_f32_16x16x32_bf16 v[116:119], v[60:63], a[4:7], v[116:119]
    buffer_load_dwordx4 v5, s[8:11], s31 offen offset:0 lds
    v_mfma_f32_16x16x32_bf16 v[136:139], v[64:67], a[8:11], v[136:139]
    ds_read_b128 v[48:51], v2 offset:10240
    ds_read_b128 v[52:55], v2 offset:11264
k4_kernel_j1305:
    v_mfma_f32_16x16x32_bf16 v[136:139], v[68:71], a[16:19], v[136:139]
    v_mfma_f32_16x16x32_bf16 v[140:143], v[64:67], a[12:15], v[140:143]
    v_mfma_f32_16x16x32_bf16 v[140:143], v[68:71], a[20:23], v[140:143]
    s_waitcnt lgkmcnt(4)
    v_mfma_f32_16x16x32_bf16 v[72:75], v[24:27], a[8:11], v[72:75]
    ds_read_b128 v[56:59], v2 offset:12288
    ds_read_b128 v[60:63], v2 offset:13312
    v_mfma_f32_16x16x32_bf16 v[72:75], v[28:31], a[16:19], v[72:75]
    s_waitcnt vmcnt(5)
k4_kernel_f2a:
    v_and_b32 v20, v16, v17
    v_and_b32 v21, v18, v19
    v_and_b32 v20, v20, v21
    v_cmp_ne_u32 vcc, 0, v20
    s_cbranch_vccnz k4_kernel_f2b
    s_sub_u32 s34, s34, 1
    s_cmp_lt_i32 s34, 0
    s_cbranch_scc1 k4_kernel_f2b
    buffer_load_dwordx4 v[16:19], v15, s[8:11], 0 offen sc1
    s_waitcnt vmcnt(0)
    s_branch k4_kernel_f2a
k4_kernel_f2b:
    v_mfma_f32_16x16x32_bf16 v[76:79], v[24:27], a[12:15], v[76:79]
    s_mov_b32 s48, 14336
    buffer_load_dwordx4 a[72:75], v10, s[8:11], s48 offen offset:0 sc1
    v_mfma_f32_16x16x32_bf16 v[76:79], v[28:31], a[20:23], v[76:79]
    buffer_load_dwordx4 v5, s[8:11], s31 offen offset:1024 lds
    v_mfma_f32_16x16x32_bf16 v[80:83], v[32:35], a[8:11], v[80:83]
    ds_read_b128 v[64:67], v2 offset:14336
    ds_read_b128 v[68:71], v2 offset:15360
    v_mfma_f32_16x16x32_bf16 v[80:83], v[36:39], a[16:19], v[80:83]
    v_mfma_f32_16x16x32_bf16 v[84:87], v[32:35], a[12:15], v[84:87]
    v_mfma_f32_16x16x32_bf16 v[84:87], v[36:39], a[20:23], v[84:87]
    s_waitcnt lgkmcnt(4)
    v_mfma_f32_16x16x32_bf16 v[88:91], v[40:43], a[8:11], v[88:91]
    s_barrier
    ds_read_b128 v[24:27], v2 offset:16384
    ds_read_b128 v[28:31], v2 offset:17408
    v_mfma_f32_16x16x32_bf16 v[88:91], v[44:47], a[16:19], v[88:91]
    v_mfma_f32_16x16x32_bf16 v[92:95], v[40:43], a[12:15], v[92:95]
    v_mfma_f32_16x16x32_bf16 v[92:95], v[44:47], a[20:23], v[92:95]
    buffer_load_dwordx4 v5, s[8:11], s31 offen offset:2048 lds
    v_mfma_f32_16x16x32_bf16 v[96:99], v[48:51], a[8:11], v[96:99]
    ds_read_b128 v[32:35], v2 offset:18432
    ds_read_b128 v[36:39], v2 offset:19456
    v_mfma_f32_16x16x32_bf16 v[96:99], v[52:55], a[16:19], v[96:99]
    buffer_load_dwordx4 a[76:79], v10, s[8:11], s48 offen offset:1024 sc1
    v_mfma_f32_16x16x32_bf16 v[100:103], v[48:51], a[12:15], v[100:103]
    v_mfma_f32_16x16x32_bf16 v[100:103], v[52:55], a[20:23], v[100:103]
    s_waitcnt lgkmcnt(4)
    v_mfma_f32_16x16x32_bf16 v[104:107], v[56:59], a[8:11], v[104:107]
    ds_read_b128 v[40:43], v2 offset:20480
    ds_read_b128 v[44:47], v2 offset:21504
    v_mfma_f32_16x16x32_bf16 v[104:107], v[60:63], a[16:19], v[104:107]
    v_mfma_f32_16x16x32_bf16 v[108:111], v[56:59], a[12:15], v[108:111]
    v_mfma_f32_16x16x32_bf16 v[108:111], v[60:63], a[20:23], v[108:111]
    buffer_load_dwordx4 v5, s[8:11], s31 offen offset:3072 lds
    v_mfma_f32_16x16x32_bf16 v[112:115], v[64:67], a[8:11], v[112:115]
    ds_read_b128 v[48:51], v2 offset:22528
    ds_read_b128 v[52:55], v2 offset:23552
    v_mfma_f32_16x16x32_bf16 v[112:115], v[68:71], a[16:19], v[112:115]
    v_mfma_f32_16x16x32_bf16 v[116:119], v[64:67], a[12:15], v[116:119]
    s_mov_b32 s48, 16384
    buffer_load_dwordx4 a[80:83], v10, s[8:11], s48 offen offset:0 sc1
    v_mfma_f32_16x16x32_bf16 v[116:119], v[68:71], a[20:23], v[116:119]
    s_add_u32 m0, s28, 114688
    s_waitcnt lgkmcnt(4)
    v_mfma_f32_16x16x32_bf16 v[136:139], v[24:27], a[24:27], v[136:139]
    ds_read_b128 v[56:59], v2 offset:24576
    ds_read_b128 v[60:63], v2 offset:25600
    v_mfma_f32_16x16x32_bf16 v[136:139], v[28:31], a[32:35], v[136:139]
    s_mov_b32 s31, 933888
    v_mfma_f32_16x16x32_bf16 v[140:143], v[24:27], a[28:31], v[140:143]
    v_mfma_f32_16x16x32_bf16 v[140:143], v[28:31], a[36:39], v[140:143]
    buffer_load_dwordx4 v5, s[8:11], s31 offen offset:0 lds
    v_mfma_f32_16x16x32_bf16 v[72:75], v[32:35], a[24:27], v[72:75]
    ds_read_b128 v[64:67], v2 offset:26624
    ds_read_b128 v[68:71], v2 offset:27648
    v_mfma_f32_16x16x32_bf16 v[72:75], v[36:39], a[32:35], v[72:75]
    v_mfma_f32_16x16x32_bf16 v[76:79], v[32:35], a[28:31], v[76:79]
    v_mfma_f32_16x16x32_bf16 v[76:79], v[36:39], a[36:39], v[76:79]
    s_waitcnt lgkmcnt(4)
    v_mfma_f32_16x16x32_bf16 v[80:83], v[40:43], a[24:27], v[80:83]
    ds_read_b128 v[24:27], v2 offset:28672
    ds_read_b128 v[28:31], v2 offset:29696
    v_mfma_f32_16x16x32_bf16 v[80:83], v[44:47], a[32:35], v[80:83]
    buffer_load_dwordx4 a[84:87], v10, s[8:11], s48 offen offset:1024 sc1
    v_mfma_f32_16x16x32_bf16 v[84:87], v[40:43], a[28:31], v[84:87]
    v_mfma_f32_16x16x32_bf16 v[84:87], v[44:47], a[36:39], v[84:87]
    buffer_load_dwordx4 v5, s[8:11], s31 offen offset:1024 lds
    v_mfma_f32_16x16x32_bf16 v[88:91], v[48:51], a[24:27], v[88:91]
    ds_read_b128 v[32:35], v2 offset:30720
    ds_read_b128 v[36:39], v2 offset:31744
    v_mfma_f32_16x16x32_bf16 v[88:91], v[52:55], a[32:35], v[88:91]
    v_mfma_f32_16x16x32_bf16 v[92:95], v[48:51], a[28:31], v[92:95]
    v_mfma_f32_16x16x32_bf16 v[92:95], v[52:55], a[36:39], v[92:95]
    s_waitcnt lgkmcnt(4)
    v_mfma_f32_16x16x32_bf16 v[96:99], v[56:59], a[24:27], v[96:99]
    ds_read_b128 v[40:43], v2 offset:32768
    ds_read_b128 v[44:47], v2 offset:33792
    v_mfma_f32_16x16x32_bf16 v[96:99], v[60:63], a[32:35], v[96:99]
    v_mfma_f32_16x16x32_bf16 v[100:103], v[56:59], a[28:31], v[100:103]
    s_mov_b32 s48, 14336
    buffer_load_dwordx4 a[88:91], v11, s[8:11], s48 offen offset:0 sc1
    v_mfma_f32_16x16x32_bf16 v[100:103], v[60:63], a[36:39], v[100:103]
    buffer_load_dwordx4 v5, s[8:11], s31 offen offset:2048 lds
    v_mfma_f32_16x16x32_bf16 v[104:107], v[64:67], a[24:27], v[104:107]
    ds_read_b128 v[48:51], v2 offset:34816
    ds_read_b128 v[52:55], v2 offset:35840
    v_mfma_f32_16x16x32_bf16 v[104:107], v[68:71], a[32:35], v[104:107]
    v_mfma_f32_16x16x32_bf16 v[108:111], v[64:67], a[28:31], v[108:111]
    v_mfma_f32_16x16x32_bf16 v[108:111], v[68:71], a[36:39], v[108:111]
    s_waitcnt lgkmcnt(4)
    v_mfma_f32_16x16x32_bf16 v[112:115], v[24:27], a[24:27], v[112:115]
    ds_read_b128 v[56:59], v2 offset:36864
    ds_read_b128 v[60:63], v2 offset:37888
    v_mfma_f32_16x16x32_bf16 v[112:115], v[28:31], a[32:35], v[112:115]
    v_mfma_f32_16x16x32_bf16 v[116:119], v[24:27], a[28:31], v[116:119]
    v_mfma_f32_16x16x32_bf16 v[116:119], v[28:31], a[36:39], v[116:119]
    buffer_load_dwordx4 v5, s[8:11], s31 offen offset:3072 lds
    v_mfma_f32_16x16x32_bf16 v[136:139], v[32:35], a[40:43], v[136:139]
    ds_read_b128 v[64:67], v2 offset:38912
    ds_read_b128 v[68:71], v2 offset:39936
    v_mfma_f32_16x16x32_bf16 v[136:139], v[36:39], a[48:51], v[136:139]
    buffer_load_dwordx4 a[92:95], v11, s[8:11], s48 offen offset:1024 sc1
    v_mfma_f32_16x16x32_bf16 v[140:143], v[32:35], a[44:47], v[140:143]
    s_mov_b32 s48, 16384
    buffer_load_dwordx4 a[96:99], v11, s[8:11], s48 offen offset:0 sc1
    v_mfma_f32_16x16x32_bf16 v[140:143], v[36:39], a[52:55], v[140:143]
    s_add_u32 m0, s28, 131072
    s_waitcnt lgkmcnt(4)
    v_mfma_f32_16x16x32_bf16 v[72:75], v[40:43], a[40:43], v[72:75]
    ds_read_b128 v[24:27], v2 offset:40960
    ds_read_b128 v[28:31], v2 offset:41984
    v_mfma_f32_16x16x32_bf16 v[72:75], v[44:47], a[48:51], v[72:75]
    buffer_load_dwordx4 a[100:103], v11, s[8:11], s48 offen offset:1024 sc1
    v_mfma_f32_16x16x32_bf16 v[76:79], v[40:43], a[44:47], v[76:79]
    s_mov_b32 s48, 14336
    buffer_load_dwordx4 a[104:107], v12, s[8:11], s48 offen offset:0 sc1
    v_mfma_f32_16x16x32_bf16 v[76:79], v[44:47], a[52:55], v[76:79]
    s_mov_b32 s31, 950272
    buffer_load_dwordx4 v5, s[8:11], s31 offen offset:0 lds
    v_mfma_f32_16x16x32_bf16 v[80:83], v[48:51], a[40:43], v[80:83]
    ds_read_b128 v[32:35], v2 offset:43008
    ds_read_b128 v[36:39], v2 offset:44032
    v_mfma_f32_16x16x32_bf16 v[80:83], v[52:55], a[48:51], v[80:83]
    buffer_load_dwordx4 a[108:111], v12, s[8:11], s48 offen offset:1024 sc1
    v_mfma_f32_16x16x32_bf16 v[84:87], v[48:51], a[44:47], v[84:87]
    s_mov_b32 s48, 16384
    buffer_load_dwordx4 a[112:115], v12, s[8:11], s48 offen offset:0 sc1
    v_mfma_f32_16x16x32_bf16 v[84:87], v[52:55], a[52:55], v[84:87]
    s_waitcnt lgkmcnt(4)
    v_mfma_f32_16x16x32_bf16 v[88:91], v[56:59], a[40:43], v[88:91]
    ds_read_b128 v[40:43], v2 offset:45056
    ds_read_b128 v[44:47], v2 offset:46080
    v_mfma_f32_16x16x32_bf16 v[88:91], v[60:63], a[48:51], v[88:91]
    buffer_load_dwordx4 a[116:119], v12, s[8:11], s48 offen offset:1024 sc1
    v_mfma_f32_16x16x32_bf16 v[92:95], v[56:59], a[44:47], v[92:95]
    v_mfma_f32_16x16x32_bf16 v[92:95], v[60:63], a[52:55], v[92:95]
    buffer_load_dwordx4 v5, s[8:11], s31 offen offset:1024 lds
    v_mfma_f32_16x16x32_bf16 v[96:99], v[64:67], a[40:43], v[96:99]
    ds_read_b128 v[48:51], v2 offset:47104
    ds_read_b128 v[52:55], v2 offset:48128
    v_mfma_f32_16x16x32_bf16 v[96:99], v[68:71], a[48:51], v[96:99]
    v_mfma_f32_16x16x32_bf16 v[100:103], v[64:67], a[44:47], v[100:103]
    v_mfma_f32_16x16x32_bf16 v[100:103], v[68:71], a[52:55], v[100:103]
    s_waitcnt lgkmcnt(4)
    v_mfma_f32_16x16x32_bf16 v[104:107], v[24:27], a[40:43], v[104:107]
    ds_read_b128 v[56:59], v2 offset:49152
    ds_read_b128 v[60:63], v2 offset:50176
    v_mfma_f32_16x16x32_bf16 v[104:107], v[28:31], a[48:51], v[104:107]
    v_mfma_f32_16x16x32_bf16 v[108:111], v[24:27], a[44:47], v[108:111]
    v_mfma_f32_16x16x32_bf16 v[108:111], v[28:31], a[52:55], v[108:111]
    buffer_load_dwordx4 v5, s[8:11], s31 offen offset:2048 lds
    v_mfma_f32_16x16x32_bf16 v[112:115], v[32:35], a[40:43], v[112:115]
    ds_read_b128 v[64:67], v2 offset:51200
    ds_read_b128 v[68:71], v2 offset:52224
    v_mfma_f32_16x16x32_bf16 v[112:115], v[36:39], a[48:51], v[112:115]
    v_mfma_f32_16x16x32_bf16 v[116:119], v[32:35], a[44:47], v[116:119]
    v_mfma_f32_16x16x32_bf16 v[116:119], v[36:39], a[52:55], v[116:119]
    s_waitcnt lgkmcnt(4)
    v_mfma_f32_16x16x32_bf16 v[136:139], v[40:43], a[56:59], v[136:139]
    ds_read_b128 v[24:27], v2 offset:53248
    ds_read_b128 v[28:31], v2 offset:54272
    v_mfma_f32_16x16x32_bf16 v[136:139], v[44:47], a[64:67], v[136:139]
    v_mfma_f32_16x16x32_bf16 v[140:143], v[40:43], a[60:63], v[140:143]
    s_nop 0
    v_mfma_f32_16x16x32_bf16 v[140:143], v[44:47], a[68:71], v[140:143]
    buffer_load_dwordx4 v5, s[8:11], s31 offen offset:3072 lds
    v_mfma_f32_16x16x32_bf16 v[72:75], v[48:51], a[56:59], v[72:75]
    ds_read_b128 v[32:35], v2 offset:55296
    ds_read_b128 v[36:39], v2 offset:56320
    v_mfma_f32_16x16x32_bf16 v[72:75], v[52:55], a[64:67], v[72:75]
    v_lshlrev_b32 v120, 16, v236
    v_lshlrev_b32 v122, 16, v237
    v_mfma_f32_16x16x32_bf16 v[76:79], v[48:51], a[60:63], v[76:79]
    s_add_u32 m0, s28, 147456
    s_mov_b32 s31, 966656
    v_mfma_f32_16x16x32_bf16 v[76:79], v[52:55], a[68:71], v[76:79]
    v_and_b32 v121, s20, v236
    s_waitcnt lgkmcnt(4)
    v_mfma_f32_16x16x32_bf16 v[80:83], v[56:59], a[56:59], v[80:83]
    ds_read_b128 v[40:43], v2 offset:57344
    ds_read_b128 v[44:47], v2 offset:58368
    v_mfma_f32_16x16x32_bf16 v[80:83], v[60:63], a[64:67], v[80:83]
    v_and_b32 v123, s20, v237
    v_lshlrev_b32 v128, 16, v238
    v_mfma_f32_16x16x32_bf16 v[84:87], v[56:59], a[60:63], v[84:87]
    v_and_b32 v129, s20, v238
    v_lshlrev_b32 v130, 16, v239
    v_mfma_f32_16x16x32_bf16 v[84:87], v[60:63], a[68:71], v[84:87]
    buffer_load_dwordx4 v5, s[8:11], s31 offen offset:0 lds
    v_mfma_f32_16x16x32_bf16 v[88:91], v[64:67], a[56:59], v[88:91]
    ds_read_b128 v[48:51], v2 offset:59392
    ds_read_b128 v[52:55], v2 offset:60416
    v_mfma_f32_16x16x32_bf16 v[88:91], v[68:71], a[64:67], v[88:91]
    v_and_b32 v131, s20, v239
    v_lshlrev_b32 v124, 16, v240
    v_mfma_f32_16x16x32_bf16 v[92:95], v[64:67], a[60:63], v[92:95]
    v_and_b32 v125, s20, v240
    v_lshlrev_b32 v126, 16, v241
    v_mfma_f32_16x16x32_bf16 v[92:95], v[68:71], a[68:71], v[92:95]
    v_and_b32 v127, s20, v241
    s_waitcnt lgkmcnt(4)
    v_mfma_f32_16x16x32_bf16 v[96:99], v[24:27], a[56:59], v[96:99]
    ds_read_b128 v[56:59], v2 offset:61440
    ds_read_b128 v[60:63], v2 offset:62464
    v_mfma_f32_16x16x32_bf16 v[96:99], v[28:31], a[64:67], v[96:99]
    v_lshlrev_b32 v132, 16, v242
    v_lshlrev_b32 v134, 16, v243
    v_mfma_f32_16x16x32_bf16 v[100:103], v[24:27], a[60:63], v[100:103]
    v_and_b32 v133, s20, v242
    v_and_b32 v135, s20, v243
    v_mfma_f32_16x16x32_bf16 v[100:103], v[28:31], a[68:71], v[100:103]
    buffer_load_dwordx4 v5, s[8:11], s31 offen offset:1024 lds
    v_mfma_f32_16x16x32_bf16 v[104:107], v[32:35], a[56:59], v[104:107]
    ds_read_b128 v[64:67], v2 offset:63488
    ds_read_b128 v[68:71], v2 offset:64512
    v_mfma_f32_16x16x32_bf16 v[104:107], v[36:39], a[64:67], v[104:107]
    v_mfma_f32_16x16x32_bf16 v[108:111], v[32:35], a[60:63], v[108:111]
    v_mfma_f32_16x16x32_bf16 v[108:111], v[36:39], a[68:71], v[108:111]
    s_waitcnt lgkmcnt(4)
    v_mfma_f32_16x16x32_bf16 v[112:115], v[40:43], a[56:59], v[112:115]
    s_waitcnt vmcnt(20)
    s_barrier
    ds_read_b128 v[24:27], v3 offset:0
    ds_read_b128 v[28:31], v3 offset:1024
    v_mfma_f32_16x16x32_bf16 v[112:115], v[44:47], a[64:67], v[112:115]
    v_mfma_f32_16x16x32_bf16 v[116:119], v[40:43], a[60:63], v[116:119]
    v_mfma_f32_16x16x32_bf16 v[116:119], v[44:47], a[68:71], v[116:119]
    buffer_load_dwordx4 v5, s[8:11], s31 offen offset:2048 lds
    s_waitcnt vmcnt(18)
    v_mfma_f32_16x16x32_bf16 v[136:139], v[48:51], a[72:75], v[136:139]
    ds_read_b128 v[32:35], v3 offset:2048
    ds_read_b128 v[36:39], v3 offset:3072
    v_mfma_f32_16x16x32_bf16 v[136:139], v[52:55], a[80:83], v[136:139]
    v_mfma_f32_16x16x32_bf16 v[140:143], v[48:51], a[76:79], v[140:143]
    v_mfma_f32_16x16x32_bf16 v[140:143], v[52:55], a[84:87], v[140:143]
    s_waitcnt vmcnt(11)
    s_waitcnt lgkmcnt(4)
    v_mfma_f32_16x16x32_bf16 v[136:139], v[56:59], a[88:91], v[136:139]
    ds_read_b128 v[40:43], v3 offset:4096
    ds_read_b128 v[44:47], v3 offset:5120
    v_mfma_f32_16x16x32_bf16 v[136:139], v[60:63], a[96:99], v[136:139]
    v_mfma_f32_16x16x32_bf16 v[140:143], v[56:59], a[92:95], v[140:143]
    v_mfma_f32_16x16x32_bf16 v[140:143], v[60:63], a[100:103], v[140:143]
    buffer_load_dwordx4 v5, s[8:11], s31 offen offset:3072 lds
    s_waitcnt vmcnt(7)
    v_mfma_f32_16x16x32_bf16 v[136:139], v[64:67], a[104:107], v[136:139]
    ds_read_b128 v[48:51], v3 offset:6144
    ds_read_b128 v[52:55], v3 offset:7168
    v_mfma_f32_16x16x32_bf16 v[136:139], v[68:71], a[112:115], v[136:139]
    v_mfma_f32_16x16x32_bf16 v[140:143], v[64:67], a[108:111], v[140:143]
    s_add_u32 m0, s28, 0
    s_mov_b32 s31, 983040
    v_mfma_f32_16x16x32_bf16 v[140:143], v[68:71], a[116:119], v[140:143]
    s_waitcnt lgkmcnt(4)
    v_mfma_f32_16x16x32_bf16 v[72:75], v[24:27], a[72:75], v[72:75]
    ds_read_b128 v[56:59], v3 offset:8192
    ds_read_b128 v[60:63], v3 offset:9216
    v_mfma_f32_16x16x32_bf16 v[72:75], v[28:31], a[80:83], v[72:75]
    v_mfma_f32_16x16x32_bf16 v[76:79], v[24:27], a[76:79], v[76:79]
    v_mfma_f32_16x16x32_bf16 v[76:79], v[28:31], a[84:87], v[76:79]
    buffer_load_dwordx4 v5, s[8:11], s31 offen offset:0 lds
    v_mfma_f32_16x16x32_bf16 v[72:75], v[32:35], a[88:91], v[72:75]
    ds_read_b128 v[64:67], v3 offset:10240
    ds_read_b128 v[68:71], v3 offset:11264
    v_mfma_f32_16x16x32_bf16 v[72:75], v[36:39], a[96:99], v[72:75]
    v_cvt_pk_bf16_f32 v216, v136, v137
    v_cvt_pk_bf16_f32 v217, v138, v139
    v_mfma_f32_16x16x32_bf16 v[76:79], v[32:35], a[92:95], v[76:79]
    v_cvt_pk_bf16_f32 v218, v140, v141
    v_cvt_pk_bf16_f32 v219, v142, v143
    v_mfma_f32_16x16x32_bf16 v[76:79], v[36:39], a[100:103], v[76:79]
    s_mov_b32 s29, 0
    s_waitcnt lgkmcnt(4)
    v_mfma_f32_16x16x32_bf16 v[72:75], v[40:43], a[104:107], v[72:75]
    ds_read_b128 v[24:27], v3 offset:12288
    ds_read_b128 v[28:31], v3 offset:13312
    v_mfma_f32_16x16x32_bf16 v[72:75], v[44:47], a[112:115], v[72:75]
    buffer_store_dwordx4 v[216:219], v7, s[8:11], s29 offen offset:0 sc1
    v_mfma_f32_16x16x32_bf16 v[76:79], v[40:43], a[108:111], v[76:79]
    v_mfma_f32_16x16x32_bf16 v[76:79], v[44:47], a[116:119], v[76:79]
    buffer_load_dwordx4 v5, s[8:11], s31 offen offset:1024 lds
    v_mfma_f32_16x16x32_bf16 v[80:83], v[48:51], a[72:75], v[80:83]
    ds_read_b128 v[32:35], v3 offset:14336
    ds_read_b128 v[36:39], v3 offset:15360
    v_mfma_f32_16x16x32_bf16 v[80:83], v[52:55], a[80:83], v[80:83]
    v_mfma_f32_16x16x32_bf16 v[84:87], v[48:51], a[76:79], v[84:87]
    v_mfma_f32_16x16x32_bf16 v[84:87], v[52:55], a[84:87], v[84:87]
    s_waitcnt lgkmcnt(4)
    v_mfma_f32_16x16x32_bf16 v[80:83], v[56:59], a[88:91], v[80:83]
    ds_read_b128 v[40:43], v3 offset:16384
    ds_read_b128 v[44:47], v3 offset:17408
    v_mfma_f32_16x16x32_bf16 v[80:83], v[60:63], a[96:99], v[80:83]
    v_mfma_f32_16x16x32_bf16 v[84:87], v[56:59], a[92:95], v[84:87]
    v_mfma_f32_16x16x32_bf16 v[84:87], v[60:63], a[100:103], v[84:87]
    buffer_load_dwordx4 v5, s[8:11], s31 offen offset:2048 lds
    v_mfma_f32_16x16x32_bf16 v[80:83], v[64:67], a[104:107], v[80:83]
    ds_read_b128 v[48:51], v3 offset:18432
    ds_read_b128 v[52:55], v3 offset:19456
    v_mfma_f32_16x16x32_bf16 v[80:83], v[68:71], a[112:115], v[80:83]
    v_mfma_f32_16x16x32_bf16 v[84:87], v[64:67], a[108:111], v[84:87]
    v_mfma_f32_16x16x32_bf16 v[84:87], v[68:71], a[116:119], v[84:87]
    s_waitcnt lgkmcnt(4)
    v_mfma_f32_16x16x32_bf16 v[88:91], v[24:27], a[72:75], v[88:91]
    ds_read_b128 v[56:59], v3 offset:20480
    ds_read_b128 v[60:63], v3 offset:21504
    v_mfma_f32_16x16x32_bf16 v[88:91], v[28:31], a[80:83], v[88:91]
    v_mfma_f32_16x16x32_bf16 v[92:95], v[24:27], a[76:79], v[92:95]
    v_mfma_f32_16x16x32_bf16 v[92:95], v[28:31], a[84:87], v[92:95]
    buffer_load_dwordx4 v5, s[8:11], s31 offen offset:3072 lds
    v_mfma_f32_16x16x32_bf16 v[88:91], v[32:35], a[88:91], v[88:91]
    ds_read_b128 v[64:67], v3 offset:22528
    ds_read_b128 v[68:71], v3 offset:23552
    v_mfma_f32_16x16x32_bf16 v[88:91], v[36:39], a[96:99], v[88:91]
    v_cvt_pk_bf16_f32 v220, v72, v73
    v_cvt_pk_bf16_f32 v221, v74, v75
    v_mfma_f32_16x16x32_bf16 v[92:95], v[32:35], a[92:95], v[92:95]
    v_cvt_pk_bf16_f32 v222, v80, v81
    v_cvt_pk_bf16_f32 v223, v82, v83
    v_mfma_f32_16x16x32_bf16 v[92:95], v[36:39], a[100:103], v[92:95]
    s_mov_b32 s29, 0
    s_waitcnt lgkmcnt(4)
    v_mfma_f32_16x16x32_bf16 v[88:91], v[40:43], a[104:107], v[88:91]
    ds_read_b128 v[24:27], v3 offset:24576
    ds_read_b128 v[28:31], v3 offset:25600
    v_mfma_f32_16x16x32_bf16 v[88:91], v[44:47], a[112:115], v[88:91]
    v_cvt_pk_bf16_f32 v224, v76, v77
    v_cvt_pk_bf16_f32 v225, v78, v79
    v_mfma_f32_16x16x32_bf16 v[92:95], v[40:43], a[108:111], v[92:95]
    v_cvt_pk_bf16_f32 v226, v84, v85
    v_cvt_pk_bf16_f32 v227, v86, v87
    v_mfma_f32_16x16x32_bf16 v[92:95], v[44:47], a[116:119], v[92:95]
    buffer_store_dwordx4 v[220:223], v7, s[8:11], s29 offen offset:1024 sc1
    v_mfma_f32_16x16x32_bf16 v[96:99], v[48:51], a[72:75], v[96:99]
    ds_read_b128 v[32:35], v3 offset:26624
    ds_read_b128 v[36:39], v3 offset:27648
    v_mfma_f32_16x16x32_bf16 v[96:99], v[52:55], a[80:83], v[96:99]
    s_mov_b32 s29, 0
    v_mfma_f32_16x16x32_bf16 v[100:103], v[48:51], a[76:79], v[100:103]
    buffer_store_dwordx4 v[224:227], v7, s[8:11], s29 offen offset:2048 sc1
    v_mfma_f32_16x16x32_bf16 v[100:103], v[52:55], a[84:87], v[100:103]
    s_waitcnt lgkmcnt(4)
    v_mfma_f32_16x16x32_bf16 v[96:99], v[56:59], a[88:91], v[96:99]
    ds_read_b128 v[40:43], v3 offset:28672
    ds_read_b128 v[44:47], v3 offset:29696
    v_mfma_f32_16x16x32_bf16 v[96:99], v[60:63], a[96:99], v[96:99]
    v_mfma_f32_16x16x32_bf16 v[100:103], v[56:59], a[92:95], v[100:103]
    v_mfma_f32_16x16x32_bf16 v[100:103], v[60:63], a[100:103], v[100:103]
    v_mfma_f32_16x16x32_bf16 v[96:99], v[64:67], a[104:107], v[96:99]
    ds_read_b128 v[48:51], v3 offset:30720
    ds_read_b128 v[52:55], v3 offset:31744
    v_mfma_f32_16x16x32_bf16 v[96:99], v[68:71], a[112:115], v[96:99]
    v_mfma_f32_16x16x32_bf16 v[100:103], v[64:67], a[108:111], v[100:103]
    v_mfma_f32_16x16x32_bf16 v[100:103], v[68:71], a[116:119], v[100:103]
    s_waitcnt lgkmcnt(4)
    v_mfma_f32_16x16x32_bf16 v[104:107], v[24:27], a[72:75], v[104:107]
    ds_read_b128 v[56:59], v3 offset:32768
    ds_read_b128 v[60:63], v3 offset:33792
    v_mfma_f32_16x16x32_bf16 v[104:107], v[28:31], a[80:83], v[104:107]
    v_mfma_f32_16x16x32_bf16 v[108:111], v[24:27], a[76:79], v[108:111]
    v_mfma_f32_16x16x32_bf16 v[108:111], v[28:31], a[84:87], v[108:111]
    v_cvt_pk_bf16_f32 v216, v88, v89
    v_cvt_pk_bf16_f32 v217, v90, v91
    v_mfma_f32_16x16x32_bf16 v[104:107], v[32:35], a[88:91], v[104:107]
    ds_read_b128 v[64:67], v3 offset:34816
    ds_read_b128 v[68:71], v3 offset:35840
    v_mfma_f32_16x16x32_bf16 v[104:107], v[36:39], a[96:99], v[104:107]
    v_cvt_pk_bf16_f32 v218, v96, v97
    v_cvt_pk_bf16_f32 v219, v98, v99
    v_mfma_f32_16x16x32_bf16 v[108:111], v[32:35], a[92:95], v[108:111]
    s_mov_b32 s29, 0
    v_cvt_pk_bf16_f32 v220, v92, v93
    v_mfma_f32_16x16x32_bf16 v[108:111], v[36:39], a[100:103], v[108:111]
    v_cvt_pk_bf16_f32 v221, v94, v95
    s_waitcnt lgkmcnt(4)
    v_mfma_f32_16x16x32_bf16 v[104:107], v[40:43], a[104:107], v[104:107]
    ds_read_b128 v[24:27], v3 offset:36864
    ds_read_b128 v[28:31], v3 offset:37888
    v_mfma_f32_16x16x32_bf16 v[104:107], v[44:47], a[112:115], v[104:107]
    v_cvt_pk_bf16_f32 v222, v100, v101
    v_cvt_pk_bf16_f32 v223, v102, v103
    v_mfma_f32_16x16x32_bf16 v[108:111], v[40:43], a[108:111], v[108:111]
    buffer_store_dwordx4 v[216:219], v7, s[8:11], s29 offen offset:3072 sc1
    v_mfma_f32_16x16x32_bf16 v[108:111], v[44:47], a[116:119], v[108:111]
    s_mov_b32 s29, 4096
    v_mfma_f32_16x16x32_bf16 v[112:115], v[48:51], a[72:75], v[112:115]
    ds_read_b128 v[32:35], v3 offset:38912
    ds_read_b128 v[36:39], v3 offset:39936
    v_mfma_f32_16x16x32_bf16 v[112:115], v[52:55], a[80:83], v[112:115]
    buffer_store_dwordx4 v[220:223], v7, s[8:11], s29 offen offset:0 sc1
    v_mfma_f32_16x16x32_bf16 v[116:119], v[48:51], a[76:79], v[116:119]
    v_mfma_f32_16x16x32_bf16 v[116:119], v[52:55], a[84:87], v[116:119]
    s_waitcnt lgkmcnt(4)
    v_mfma_f32_16x16x32_bf16 v[112:115], v[56:59], a[88:91], v[112:115]
    ds_read_b128 v[40:43], v3 offset:40960
    ds_read_b128 v[44:47], v3 offset:41984
    v_mfma_f32_16x16x32_bf16 v[112:115], v[60:63], a[96:99], v[112:115]
    v_mfma_f32_16x16x32_bf16 v[116:119], v[56:59], a[92:95], v[116:119]
    v_mfma_f32_16x16x32_bf16 v[116:119], v[60:63], a[100:103], v[116:119]
    v_mfma_f32_16x16x32_bf16 v[112:115], v[64:67], a[104:107], v[112:115]
    ds_read_b128 v[48:51], v3 offset:43008
    ds_read_b128 v[52:55], v3 offset:44032
    v_mfma_f32_16x16x32_bf16 v[112:115], v[68:71], a[112:115], v[112:115]
    v_mfma_f32_16x16x32_bf16 v[116:119], v[64:67], a[108:111], v[116:119]
    v_mfma_f32_16x16x32_bf16 v[116:119], v[68:71], a[116:119], v[116:119]
    s_waitcnt lgkmcnt(4)
    v_mfma_f32_16x16x32_bf16 v[120:123], v[24:27], v[144:147], v[120:123]
    ds_read_b128 v[56:59], v3 offset:45056
    ds_read_b128 v[60:63], v3 offset:46080
    v_mfma_f32_16x16x32_bf16 v[120:123], v[28:31], v[152:155], v[120:123]
    v_mfma_f32_16x16x32_bf16 v[124:127], v[24:27], v[148:151], v[124:127]
    v_mfma_f32_16x16x32_bf16 v[124:127], v[28:31], v[156:159], v[124:127]
    v_cvt_pk_bf16_f32 v224, v104, v105
    v_cvt_pk_bf16_f32 v225, v106, v107
    v_mfma_f32_16x16x32_bf16 v[128:131], v[32:35], v[144:147], v[128:131]
    ds_read_b128 v[64:67], v3 offset:47104
    ds_read_b128 v[68:71], v3 offset:48128
    v_mfma_f32_16x16x32_bf16 v[128:131], v[36:39], v[152:155], v[128:131]
    v_cvt_pk_bf16_f32 v226, v112, v113
    v_cvt_pk_bf16_f32 v227, v114, v115
    v_mfma_f32_16x16x32_bf16 v[132:135], v[32:35], v[148:151], v[132:135]
    s_mov_b32 s29, 4096
    v_cvt_pk_bf16_f32 v216, v108, v109
    v_mfma_f32_16x16x32_bf16 v[132:135], v[36:39], v[156:159], v[132:135]
    v_cvt_pk_bf16_f32 v217, v110, v111
    s_waitcnt lgkmcnt(4)
    v_mfma_f32_16x16x32_bf16 v[120:123], v[40:43], v[160:163], v[120:123]
    s_waitcnt vmcnt(9)
    s_barrier
    ds_read_b128 v[24:27], v3 offset:49152
    ds_read_b128 v[28:31], v3 offset:50176
    v_mfma_f32_16x16x32_bf16 v[120:123], v[44:47], v[168:171], v[120:123]
    v_cvt_pk_bf16_f32 v218, v116, v117
    v_cvt_pk_bf16_f32 v219, v118, v119
    v_mfma_f32_16x16x32_bf16 v[124:127], v[40:43], v[164:167], v[124:127]
    buffer_store_dwordx4 v[224:227], v7, s[8:11], s29 offen offset:1024 sc1
    v_mfma_f32_16x16x32_bf16 v[124:127], v[44:47], v[172:175], v[124:127]
    s_mov_b32 s29, 4096
    v_mfma_f32_16x16x32_bf16 v[128:131], v[48:51], v[160:163], v[128:131]
    ds_read_b128 v[32:35], v3 offset:51200
    ds_read_b128 v[36:39], v3 offset:52224
    v_mfma_f32_16x16x32_bf16 v[128:131], v[52:55], v[168:171], v[128:131]
    buffer_store_dwordx4 v[216:219], v7, s[8:11], s29 offen offset:2048 sc1
    v_mfma_f32_16x16x32_bf16 v[132:135], v[48:51], v[164:167], v[132:135]
    v_mfma_f32_16x16x32_bf16 v[132:135], v[52:55], v[172:175], v[132:135]
    v_lshlrev_b32 v216, 16, v244
    s_waitcnt lgkmcnt(4)
    v_mfma_f32_16x16x32_bf16 v[120:123], v[56:59], v[176:179], v[120:123]
    ds_read_b128 v[40:43], v3 offset:53248
    ds_read_b128 v[44:47], v3 offset:54272
    v_mfma_f32_16x16x32_bf16 v[120:123], v[60:63], v[184:187], v[120:123]
    v_and_b32 v217, s20, v244
    v_lshlrev_b32 v218, 16, v245
    v_mfma_f32_16x16x32_bf16 v[124:127], v[56:59], v[180:183], v[124:127]
    v_and_b32 v219, s20, v245
    v_lshlrev_b32 v220, 16, v246
    v_mfma_f32_16x16x32_bf16 v[124:127], v[60:63], v[188:191], v[124:127]
    v_and_b32 v221, s20, v246
    v_lshlrev_b32 v222, 16, v247
    v_mfma_f32_16x16x32_bf16 v[128:131], v[64:67], v[176:179], v[128:131]
    ds_read_b128 v[48:51], v3 offset:55296
    ds_read_b128 v[52:55], v3 offset:56320
    v_mfma_f32_16x16x32_bf16 v[128:131], v[68:71], v[184:187], v[128:131]
    v_and_b32 v223, s20, v247
    v_mfma_f32_16x16x32_bf16 v[132:135], v[64:67], v[180:183], v[132:135]
    v_mfma_f32_16x16x32_bf16 v[132:135], v[68:71], v[188:191], v[132:135]
    s_waitcnt lgkmcnt(4)
    v_mfma_f32_16x16x32_bf16 v[120:123], v[24:27], v[192:195], v[120:123]
    ds_read_b128 v[56:59], v3 offset:57344
    ds_read_b128 v[60:63], v3 offset:58368
    v_mfma_f32_16x16x32_bf16 v[120:123], v[28:31], v[200:203], v[120:123]
    v_mfma_f32_16x16x32_bf16 v[124:127], v[24:27], v[196:199], v[124:127]
    v_mfma_f32_16x16x32_bf16 v[124:127], v[28:31], v[204:207], v[124:127]
    v_mfma_f32_16x16x32_bf16 v[128:131], v[32:35], v[192:195], v[128:131]
    ds_read_b128 v[64:67], v3 offset:59392
    ds_read_b128 v[68:71], v3 offset:60416
    v_mfma_f32_16x16x32_bf16 v[128:131], v[36:39], v[200:203], v[128:131]
    v_mfma_f32_16x16x32_bf16 v[132:135], v[32:35], v[196:199], v[132:135]
    v_mfma_f32_16x16x32_bf16 v[132:135], v[36:39], v[204:207], v[132:135]
    s_waitcnt lgkmcnt(4)
    v_mfma_f32_16x16x32_bf16 v[120:123], v[40:43], a[144:147], v[120:123]
    ds_read_b128 v[24:27], v3 offset:61440
    ds_read_b128 v[28:31], v3 offset:62464
    v_mfma_f32_16x16x32_bf16 v[120:123], v[44:47], a[152:155], v[120:123]
    v_mfma_f32_16x16x32_bf16 v[124:127], v[40:43], a[148:151], v[124:127]
    v_mfma_f32_16x16x32_bf16 v[124:127], v[44:47], a[156:159], v[124:127]
    v_mfma_f32_16x16x32_bf16 v[128:131], v[48:51], a[144:147], v[128:131]
    ds_read_b128 v[32:35], v3 offset:63488
    ds_read_b128 v[36:39], v3 offset:64512
    v_mfma_f32_16x16x32_bf16 v[128:131], v[52:55], a[152:155], v[128:131]
    v_mfma_f32_16x16x32_bf16 v[132:135], v[48:51], a[148:151], v[132:135]
    v_mfma_f32_16x16x32_bf16 v[132:135], v[52:55], a[156:159], v[132:135]
    s_waitcnt lgkmcnt(4)
    v_mfma_f32_16x16x32_bf16 v[120:123], v[56:59], a[160:163], v[120:123]
    ds_read_b128 v[40:43], v4 offset:0
    ds_read_b128 v[44:47], v4 offset:1024
    v_mfma_f32_16x16x32_bf16 v[120:123], v[60:63], a[168:171], v[120:123]
    v_mfma_f32_16x16x32_bf16 v[124:127], v[56:59], a[164:167], v[124:127]
    v_mfma_f32_16x16x32_bf16 v[124:127], v[60:63], a[172:175], v[124:127]
    v_mfma_f32_16x16x32_bf16 v[128:131], v[64:67], a[160:163], v[128:131]
    ds_read_b128 v[48:51], v4 offset:2048
    ds_read_b128 v[52:55], v4 offset:3072
    v_mfma_f32_16x16x32_bf16 v[128:131], v[68:71], a[168:171], v[128:131]
    v_mfma_f32_16x16x32_bf16 v[132:135], v[64:67], a[164:167], v[132:135]
    v_mfma_f32_16x16x32_bf16 v[132:135], v[68:71], a[172:175], v[132:135]
    s_waitcnt lgkmcnt(4)
    v_mfma_f32_16x16x32_bf16 v[120:123], v[24:27], a[176:179], v[120:123]
    ds_read_b128 v[56:59], v4 offset:4096
    ds_read_b128 v[60:63], v4 offset:5120
    v_mfma_f32_16x16x32_bf16 v[120:123], v[28:31], a[184:187], v[120:123]
    v_mfma_f32_16x16x32_bf16 v[124:127], v[24:27], a[180:183], v[124:127]
    v_mfma_f32_16x16x32_bf16 v[124:127], v[28:31], a[188:191], v[124:127]
    v_mfma_f32_16x16x32_bf16 v[128:131], v[32:35], a[176:179], v[128:131]
    ds_read_b128 v[64:67], v4 offset:6144
    ds_read_b128 v[68:71], v4 offset:7168
    v_mfma_f32_16x16x32_bf16 v[128:131], v[36:39], a[184:187], v[128:131]
    v_mfma_f32_16x16x32_bf16 v[132:135], v[32:35], a[180:183], v[132:135]
    v_mfma_f32_16x16x32_bf16 v[132:135], v[36:39], a[188:191], v[132:135]
    s_waitcnt lgkmcnt(4)
    v_mfma_f32_16x16x32_bf16 v[120:123], v[40:43], a[192:195], v[120:123]
    ds_read_b128 v[24:27], v4 offset:8192
    ds_read_b128 v[28:31], v4 offset:9216
    v_mfma_f32_16x16x32_bf16 v[120:123], v[44:47], a[200:203], v[120:123]
    v_mfma_f32_16x16x32_bf16 v[124:127], v[40:43], a[196:199], v[124:127]
    v_mfma_f32_16x16x32_bf16 v[124:127], v[44:47], a[204:207], v[124:127]
    v_mfma_f32_16x16x32_bf16 v[128:131], v[48:51], a[192:195], v[128:131]
    ds_read_b128 v[32:35], v4 offset:10240
    ds_read_b128 v[36:39], v4 offset:11264
    v_mfma_f32_16x16x32_bf16 v[128:131], v[52:55], a[200:203], v[128:131]
    v_mfma_f32_16x16x32_bf16 v[132:135], v[48:51], a[196:199], v[132:135]
    s_waitcnt vmcnt(0)
    buffer_store_dword v13, v1, s[8:11], s51 offen sc1
    v_mfma_f32_16x16x32_bf16 v[132:135], v[52:55], a[204:207], v[132:135]
    s_waitcnt lgkmcnt(4)
    v_mfma_f32_16x16x32_bf16 v[120:123], v[56:59], a[208:211], v[120:123]
    ds_read_b128 v[40:43], v4 offset:12288
    ds_read_b128 v[44:47], v4 offset:13312
    v_mfma_f32_16x16x32_bf16 v[120:123], v[60:63], a[216:219], v[120:123]
    v_mfma_f32_16x16x32_bf16 v[124:127], v[56:59], a[212:215], v[124:127]
    v_mfma_f32_16x16x32_bf16 v[124:127], v[60:63], a[220:223], v[124:127]
    v_mfma_f32_16x16x32_bf16 v[128:131], v[64:67], a[208:211], v[128:131]
    ds_read_b128 v[48:51], v4 offset:14336
    ds_read_b128 v[52:55], v4 offset:15360
    v_mfma_f32_16x16x32_bf16 v[128:131], v[68:71], a[216:219], v[128:131]
    v_mfma_f32_16x16x32_bf16 v[132:135], v[64:67], a[212:215], v[132:135]
    v_mfma_f32_16x16x32_bf16 v[132:135], v[68:71], a[220:223], v[132:135]
    s_waitcnt lgkmcnt(4)
    v_mfma_f32_16x16x32_bf16 v[120:123], v[24:27], a[224:227], v[120:123]
    ds_read_b128 v[56:59], v4 offset:16384
    ds_read_b128 v[60:63], v4 offset:17408
    v_mfma_f32_16x16x32_bf16 v[120:123], v[28:31], a[232:235], v[120:123]
    v_mfma_f32_16x16x32_bf16 v[124:127], v[24:27], a[228:231], v[124:127]
    v_mfma_f32_16x16x32_bf16 v[124:127], v[28:31], a[236:239], v[124:127]
    v_mfma_f32_16x16x32_bf16 v[128:131], v[32:35], a[224:227], v[128:131]
    ds_read_b128 v[64:67], v4 offset:18432
    ds_read_b128 v[68:71], v4 offset:19456
    v_mfma_f32_16x16x32_bf16 v[128:131], v[36:39], a[232:235], v[128:131]
    v_mfma_f32_16x16x32_bf16 v[132:135], v[32:35], a[228:231], v[132:135]
    v_mfma_f32_16x16x32_bf16 v[132:135], v[36:39], a[236:239], v[132:135]
    s_waitcnt lgkmcnt(4)
    v_mfma_f32_16x16x32_bf16 v[120:123], v[40:43], v[208:211], v[120:123]
    ds_read_b128 v[24:27], v4 offset:20480
    ds_read_b128 v[28:31], v4 offset:21504
    v_mfma_f32_16x16x32_bf16 v[120:123], v[44:47], a[0:3], v[120:123]
    v_mfma_f32_16x16x32_bf16 v[124:127], v[40:43], v[212:215], v[124:127]
    v_mfma_f32_16x16x32_bf16 v[124:127], v[44:47], a[4:7], v[124:127]
    v_mfma_f32_16x16x32_bf16 v[128:131], v[48:51], v[208:211], v[128:131]
    ds_read_b128 v[32:35], v4 offset:22528
    ds_read_b128 v[36:39], v4 offset:23552
    v_mfma_f32_16x16x32_bf16 v[128:131], v[52:55], a[0:3], v[128:131]
    v_mfma_f32_16x16x32_bf16 v[132:135], v[48:51], v[212:215], v[132:135]
    v_mfma_f32_16x16x32_bf16 v[132:135], v[52:55], a[4:7], v[132:135]
    s_waitcnt lgkmcnt(4)
    v_mfma_f32_16x16x32_bf16 v[120:123], v[56:59], a[8:11], v[120:123]
    ds_read_b128 v[40:43], v4 offset:24576
    ds_read_b128 v[44:47], v4 offset:25600
    v_mfma_f32_16x16x32_bf16 v[120:123], v[60:63], a[16:19], v[120:123]
    v_mfma_f32_16x16x32_bf16 v[124:127], v[56:59], a[12:15], v[124:127]
    v_mfma_f32_16x16x32_bf16 v[124:127], v[60:63], a[20:23], v[124:127]
    v_mfma_f32_16x16x32_bf16 v[128:131], v[64:67], a[8:11], v[128:131]
    ds_read_b128 v[48:51], v4 offset:26624
    ds_read_b128 v[52:55], v4 offset:27648
    v_mfma_f32_16x16x32_bf16 v[128:131], v[68:71], a[16:19], v[128:131]
    v_mfma_f32_16x16x32_bf16 v[132:135], v[64:67], a[12:15], v[132:135]
    v_mfma_f32_16x16x32_bf16 v[132:135], v[68:71], a[20:23], v[132:135]
    s_waitcnt lgkmcnt(4)
    v_mfma_f32_16x16x32_bf16 v[120:123], v[24:27], a[24:27], v[120:123]
    ds_read_b128 v[56:59], v4 offset:28672
    ds_read_b128 v[60:63], v4 offset:29696
    v_mfma_f32_16x16x32_bf16 v[120:123], v[28:31], a[32:35], v[120:123]
    v_mfma_f32_16x16x32_bf16 v[124:127], v[24:27], a[28:31], v[124:127]
    v_mfma_f32_16x16x32_bf16 v[124:127], v[28:31], a[36:39], v[124:127]
    v_mfma_f32_16x16x32_bf16 v[128:131], v[32:35], a[24:27], v[128:131]
    ds_read_b128 v[64:67], v4 offset:30720
    ds_read_b128 v[68:71], v4 offset:31744
    v_mfma_f32_16x16x32_bf16 v[128:131], v[36:39], a[32:35], v[128:131]
    v_mfma_f32_16x16x32_bf16 v[132:135], v[32:35], a[28:31], v[132:135]
    v_mfma_f32_16x16x32_bf16 v[132:135], v[36:39], a[36:39], v[132:135]
    s_waitcnt lgkmcnt(4)
    v_mfma_f32_16x16x32_bf16 v[120:123], v[40:43], a[40:43], v[120:123]
    s_barrier
    ds_read_b128 v[24:27], v2 offset:0
    ds_read_b128 v[28:31], v2 offset:1024
    v_mfma_f32_16x16x32_bf16 v[120:123], v[44:47], a[48:51], v[120:123]
    buffer_load_dwordx4 v[16:19], v1, s[8:11], 0 offen sc1
    v_mfma_f32_16x16x32_bf16 v[124:127], v[40:43], a[44:47], v[124:127]
    v_mfma_f32_16x16x32_bf16 v[124:127], v[44:47], a[52:55], v[124:127]
    v_mfma_f32_16x16x32_bf16 v[128:131], v[48:51], a[40:43], v[128:131]
    ds_read_b128 v[32:35], v2 offset:2048
    ds_read_b128 v[36:39], v2 offset:3072
    v_mfma_f32_16x16x32_bf16 v[128:131], v[52:55], a[48:51], v[128:131]
    v_mfma_f32_16x16x32_bf16 v[132:135], v[48:51], a[44:47], v[132:135]
    v_mfma_f32_16x16x32_bf16 v[132:135], v[52:55], a[52:55], v[132:135]
    s_waitcnt lgkmcnt(4)
    v_mfma_f32_16x16x32_bf16 v[120:123], v[56:59], a[56:59], v[120:123]
    ds_read_b128 v[40:43], v2 offset:4096
    ds_read_b128 v[44:47], v2 offset:5120
    v_mfma_f32_16x16x32_bf16 v[120:123], v[60:63], a[64:67], v[120:123]
    v_mfma_f32_16x16x32_bf16 v[124:127], v[56:59], a[60:63], v[124:127]
    v_mfma_f32_16x16x32_bf16 v[124:127], v[60:63], a[68:71], v[124:127]
    v_mfma_f32_16x16x32_bf16 v[128:131], v[64:67], a[56:59], v[128:131]
    ds_read_b128 v[48:51], v2 offset:6144
    ds_read_b128 v[52:55], v2 offset:7168
    v_mfma_f32_16x16x32_bf16 v[128:131], v[68:71], a[64:67], v[128:131]
    v_mfma_f32_16x16x32_bf16 v[132:135], v[64:67], a[60:63], v[132:135]
    v_mfma_f32_16x16x32_bf16 v[132:135], v[68:71], a[68:71], v[132:135]
    s_waitcnt lgkmcnt(4)
    v_mfma_f32_16x16x32_bf16 v[120:123], v[24:27], a[72:75], v[120:123]
    ds_read_b128 v[56:59], v2 offset:8192
    ds_read_b128 v[60:63], v2 offset:9216
    v_mfma_f32_16x16x32_bf16 v[120:123], v[28:31], a[80:83], v[120:123]
    v_mfma_f32_16x16x32_bf16 v[124:127], v[24:27], a[76:79], v[124:127]
    v_mfma_f32_16x16x32_bf16 v[124:127], v[28:31], a[84:87], v[124:127]
    v_mfma_f32_16x16x32_bf16 v[128:131], v[32:35], a[72:75], v[128:131]
    ds_read_b128 v[64:67], v2 offset:10240
    ds_read_b128 v[68:71], v2 offset:11264
    v_mfma_f32_16x16x32_bf16 v[128:131], v[36:39], a[80:83], v[128:131]
    v_mfma_f32_16x16x32_bf16 v[132:135], v[32:35], a[76:79], v[132:135]
    v_mfma_f32_16x16x32_bf16 v[132:135], v[36:39], a[84:87], v[132:135]
    s_waitcnt lgkmcnt(4)
    v_mfma_f32_16x16x32_bf16 v[120:123], v[40:43], a[88:91], v[120:123]
    v_mfma_f32_16x16x32_bf16 v[120:123], v[44:47], a[96:99], v[120:123]
    v_mfma_f32_16x16x32_bf16 v[124:127], v[40:43], a[92:95], v[124:127]
    v_mfma_f32_16x16x32_bf16 v[124:127], v[44:47], a[100:103], v[124:127]
    v_mfma_f32_16x16x32_bf16 v[128:131], v[48:51], a[88:91], v[128:131]
    v_mfma_f32_16x16x32_bf16 v[128:131], v[52:55], a[96:99], v[128:131]
    v_mfma_f32_16x16x32_bf16 v[132:135], v[48:51], a[92:95], v[132:135]
    v_mfma_f32_16x16x32_bf16 v[132:135], v[52:55], a[100:103], v[132:135]
    s_waitcnt lgkmcnt(0)
    v_mfma_f32_16x16x32_bf16 v[120:123], v[56:59], a[104:107], v[120:123]
    v_mfma_f32_16x16x32_bf16 v[120:123], v[60:63], a[112:115], v[120:123]
    s_waitcnt vmcnt(0)
k4_kernel_f3a:
    v_or_b32 v16, s24, v16
    v_or_b32 v17, s25, v17
    v_or_b32 v18, s26, v18
    v_or_b32 v19, s27, v19
    v_and_b32 v20, v16, v17
    v_and_b32 v21, v18, v19
    v_and_b32 v20, v20, v21
    v_cmp_ne_u32 vcc, 0, v20
    s_cbranch_vccnz k4_kernel_f3b
    s_sub_u32 s34, s34, 1
    s_cmp_lt_i32 s34, 0
    s_cbranch_scc1 k4_kernel_f3b
    buffer_load_dwordx4 v[16:19], v1, s[8:11], 0 offen sc1
    s_waitcnt vmcnt(0)
    s_branch k4_kernel_f3a
k4_kernel_f3b:
    v_mfma_f32_16x16x32_bf16 v[124:127], v[56:59], a[108:111], v[124:127]
    buffer_load_dwordx4 v[72:75], v2, s[8:11], s55 offen offset:0 sc1
    v_mfma_f32_16x16x32_bf16 v[124:127], v[60:63], a[116:119], v[124:127]
    buffer_load_dwordx4 v[80:83], v2, s[8:11], s56 offen offset:0 sc1
    v_mfma_f32_16x16x32_bf16 v[128:131], v[64:67], a[104:107], v[128:131]
    buffer_load_dwordx4 v[88:91], v2, s[8:11], s57 offen offset:0 sc1
    v_mfma_f32_16x16x32_bf16 v[128:131], v[68:71], a[112:115], v[128:131]
    buffer_load_dwordx4 v[76:79], v2, s[8:11], s55 offen offset:1024 sc1
    v_mfma_f32_16x16x32_bf16 v[132:135], v[64:67], a[108:111], v[132:135]
    buffer_load_dwordx4 v[84:87], v2, s[8:11], s56 offen offset:1024 sc1
    v_mfma_f32_16x16x32_bf16 v[132:135], v[68:71], a[116:119], v[132:135]
    buffer_load_dwordx4 v[92:95], v2, s[8:11], s57 offen offset:1024 sc1
    s_add_u32 s53, s49, 0
    buffer_load_dwordx4 v[96:99], v2, s[8:11], s53 offen sc1
    s_add_u32 s53, s49, 2359296
    buffer_load_dwordx4 v[100:103], v2, s[8:11], s53 offen sc1
    s_add_u32 s53, s49, 4718592
    buffer_load_dwordx4 v[104:107], v2, s[8:11], s53 offen sc1
    s_add_u32 s53, s49, 7077888
    buffer_load_dwordx4 v[108:111], v2, s[8:11], s53 offen sc1
    s_nop 4
    s_waitcnt vmcnt(9)
    v_lshlrev_b32 v20, 16, v72
    v_and_b32 v21, s20, v72
    v_pk_add_f32 v[120:121], v[120:121], v[20:21]
    v_lshlrev_b32 v22, 16, v73
    v_and_b32 v23, s20, v73
    v_pk_add_f32 v[122:123], v[122:123], v[22:23]
    v_lshlrev_b32 v20, 16, v74
    v_and_b32 v21, s20, v74
    v_pk_add_f32 v[128:129], v[128:129], v[20:21]
    v_lshlrev_b32 v22, 16, v75
    v_and_b32 v23, s20, v75
    v_pk_add_f32 v[130:131], v[130:131], v[22:23]
    s_waitcnt vmcnt(8)
    v_lshlrev_b32 v20, 16, v80
    v_and_b32 v21, s20, v80
    v_pk_add_f32 v[120:121], v[120:121], v[20:21]
    v_lshlrev_b32 v22, 16, v81
    v_and_b32 v23, s20, v81
    v_pk_add_f32 v[122:123], v[122:123], v[22:23]
    v_lshlrev_b32 v20, 16, v82
    v_and_b32 v21, s20, v82
    v_pk_add_f32 v[128:129], v[128:129], v[20:21]
    v_lshlrev_b32 v22, 16, v83
    v_and_b32 v23, s20, v83
    v_pk_add_f32 v[130:131], v[130:131], v[22:23]
    s_waitcnt vmcnt(7)
    v_lshlrev_b32 v20, 16, v88
    v_and_b32 v21, s20, v88
    v_pk_add_f32 v[120:121], v[120:121], v[20:21]
    v_lshlrev_b32 v22, 16, v89
    v_and_b32 v23, s20, v89
    v_pk_add_f32 v[122:123], v[122:123], v[22:23]
    v_lshlrev_b32 v20, 16, v90
    v_and_b32 v21, s20, v90
    v_pk_add_f32 v[128:129], v[128:129], v[20:21]
    v_lshlrev_b32 v22, 16, v91
    v_and_b32 v23, s20, v91
    v_pk_add_f32 v[130:131], v[130:131], v[22:23]
    v_cvt_pk_bf16_f32 v72, v120, v121
    v_cvt_pk_bf16_f32 v73, v122, v123
    v_cvt_pk_bf16_f32 v74, v128, v129
    v_cvt_pk_bf16_f32 v75, v130, v131
    s_nop 1
    v_permlane16_swap_b32 v72, v74
    v_permlane16_swap_b32 v73, v75
    buffer_store_dwordx4 v[72:75], v231, s[12:15], 0 offen offset:0
    s_waitcnt vmcnt(7)
    v_lshlrev_b32 v20, 16, v76
    v_and_b32 v21, s20, v76
    v_pk_add_f32 v[124:125], v[124:125], v[20:21]
    v_lshlrev_b32 v22, 16, v77
    v_and_b32 v23, s20, v77
    v_pk_add_f32 v[126:127], v[126:127], v[22:23]
    v_lshlrev_b32 v20, 16, v78
    v_and_b32 v21, s20, v78
    v_pk_add_f32 v[132:133], v[132:133], v[20:21]
    v_lshlrev_b32 v22, 16, v79
    v_and_b32 v23, s20, v79
    v_pk_add_f32 v[134:135], v[134:135], v[22:23]
    s_waitcnt vmcnt(6)
    v_lshlrev_b32 v20, 16, v84
    v_and_b32 v21, s20, v84
    v_pk_add_f32 v[124:125], v[124:125], v[20:21]
    v_lshlrev_b32 v22, 16, v85
    v_and_b32 v23, s20, v85
    v_pk_add_f32 v[126:127], v[126:127], v[22:23]
    v_lshlrev_b32 v20, 16, v86
    v_and_b32 v21, s20, v86
    v_pk_add_f32 v[132:133], v[132:133], v[20:21]
    v_lshlrev_b32 v22, 16, v87
    v_and_b32 v23, s20, v87
    v_pk_add_f32 v[134:135], v[134:135], v[22:23]
    s_waitcnt vmcnt(5)
    v_lshlrev_b32 v20, 16, v92
    v_and_b32 v21, s20, v92
    v_pk_add_f32 v[124:125], v[124:125], v[20:21]
    v_lshlrev_b32 v22, 16, v93
    v_and_b32 v23, s20, v93
    v_pk_add_f32 v[126:127], v[126:127], v[22:23]
    v_lshlrev_b32 v20, 16, v94
    v_and_b32 v21, s20, v94
    v_pk_add_f32 v[132:133], v[132:133], v[20:21]
    v_lshlrev_b32 v22, 16, v95
    v_and_b32 v23, s20, v95
    v_pk_add_f32 v[134:135], v[134:135], v[22:23]
    v_cvt_pk_bf16_f32 v76, v124, v125
    v_cvt_pk_bf16_f32 v77, v126, v127
    v_cvt_pk_bf16_f32 v78, v132, v133
    v_cvt_pk_bf16_f32 v79, v134, v135
    s_nop 1
    v_permlane16_swap_b32 v76, v78
    v_permlane16_swap_b32 v77, v79
    buffer_store_dwordx4 v[76:79], v231, s[12:15], 0 offen offset:1152
    s_cmp_lg_u32 s3, s4
    s_cbranch_scc1 k4_kernel_n8
    s_waitcnt vmcnt(5)
    v_lshlrev_b32 v20, 16, v96
    v_and_b32 v21, s20, v96
    v_pk_add_f32 v[216:217], v[216:217], v[20:21]
    v_lshlrev_b32 v22, 16, v97
    v_and_b32 v23, s20, v97
    v_pk_add_f32 v[218:219], v[218:219], v[22:23]
    v_lshlrev_b32 v20, 16, v98
    v_and_b32 v21, s20, v98
    v_pk_add_f32 v[220:221], v[220:221], v[20:21]
    v_lshlrev_b32 v22, 16, v99
    v_and_b32 v23, s20, v99
    v_pk_add_f32 v[222:223], v[222:223], v[22:23]
    s_waitcnt vmcnt(4)
    v_lshlrev_b32 v20, 16, v100
    v_and_b32 v21, s20, v100
    v_pk_add_f32 v[216:217], v[216:217], v[20:21]
    v_lshlrev_b32 v22, 16, v101
    v_and_b32 v23, s20, v101
    v_pk_add_f32 v[218:219], v[218:219], v[22:23]
    v_lshlrev_b32 v20, 16, v102
    v_and_b32 v21, s20, v102
    v_pk_add_f32 v[220:221], v[220:221], v[20:21]
    v_lshlrev_b32 v22, 16, v103
    v_and_b32 v23, s20, v103
    v_pk_add_f32 v[222:223], v[222:223], v[22:23]
    s_waitcnt vmcnt(3)
    v_lshlrev_b32 v20, 16, v104
    v_and_b32 v21, s20, v104
    v_pk_add_f32 v[216:217], v[216:217], v[20:21]
    v_lshlrev_b32 v22, 16, v105
    v_and_b32 v23, s20, v105
    v_pk_add_f32 v[218:219], v[218:219], v[22:23]
    v_lshlrev_b32 v20, 16, v106
    v_and_b32 v21, s20, v106
    v_pk_add_f32 v[220:221], v[220:221], v[20:21]
    v_lshlrev_b32 v22, 16, v107
    v_and_b32 v23, s20, v107
    v_pk_add_f32 v[222:223], v[222:223], v[22:23]
    s_waitcnt vmcnt(2)
    v_lshlrev_b32 v20, 16, v108
    v_and_b32 v21, s20, v108
    v_pk_add_f32 v[216:217], v[216:217], v[20:21]
    v_lshlrev_b32 v22, 16, v109
    v_and_b32 v23, s20, v109
    v_pk_add_f32 v[218:219], v[218:219], v[22:23]
    v_lshlrev_b32 v20, 16, v110
    v_and_b32 v21, s20, v110
    v_pk_add_f32 v[220:221], v[220:221], v[20:21]
    v_lshlrev_b32 v22, 16, v111
    v_and_b32 v23, s20, v111
    v_pk_add_f32 v[222:223], v[222:223], v[22:23]
    v_cvt_pk_bf16_f32 v96, v216, v217
    v_cvt_pk_bf16_f32 v97, v218, v219
    v_cvt_pk_bf16_f32 v98, v220, v221
    v_cvt_pk_bf16_f32 v99, v222, v223
    s_nop 1
    v_permlane16_swap_b32 v96, v98
    v_permlane16_swap_b32 v97, v99
    buffer_store_dwordx4 v[96:99], v232, s[12:15], 0 offen offset:0
k4_kernel_n8:
k4_kernel_end:
    s_endpgm
.section .rodata,"a"
.p2align 6
.amdhsa_kernel kg_kernel
  .amdhsa_next_free_vgpr 256
  .amdhsa_next_free_sgpr 102
  .amdhsa_accum_offset 256
  .amdhsa_group_segment_fixed_size 0
  .amdhsa_kernarg_size 80
  .amdhsa_user_sgpr_count 2
  .amdhsa_user_sgpr_kernarg_segment_ptr 1
  .amdhsa_system_sgpr_workgroup_id_x 1
.end_amdhsa_kernel
.p2align 6
.amdhsa_kernel k4_kernel
  .amdhsa_next_free_vgpr 496
  .amdhsa_next_free_sgpr 102
  .amdhsa_accum_offset 256
  .amdhsa_group_segment_fixed_size 0
  .amdhsa_kernarg_size 80
  .amdhsa_user_sgpr_count 2
  .amdhsa_user_sgpr_kernarg_segment_ptr 1
  .amdhsa_system_sgpr_workgroup_id_x 1
.end_amdhsa_kernel
```
